```python
import torch

def _softmax(x, axis=-1):
    return torch.softmax(x, dim=axis)

def _gelu(x):
    return torch.nn.functional.gelu(x, approximate='tanh')

def _silu(x):
    return torch.nn.functional.silu(x)

def _sigmoid(x):
    return torch.sigmoid(x)

def _layernorm(x, axis=-1, eps=1e-05):
    m = x.mean(dim=axis, keepdim=True)
    v = x.var(dim=axis, keepdim=True, unbiased=False)
    return (x - m) / torch.sqrt(v + eps)

def _scatter_add(tgt, idx, src, axis=0):
    return tgt.clone().index_add_(axis, idx, src)

def _segment_sum(src, seg, n):
    out = torch.zeros((n,) + src.shape[1:], dtype=src.dtype)
    return out.index_add_(0, seg, src)

def _pad(x, pw):
    flat = tuple((v for pair in reversed(pw) for v in pair))
    return torch.nn.functional.pad(x, flat)
kernel_name = 'sequential_preLN__memory_aug_recurrent_mem_tr__geglu_ffn__prompt'

def setup_inputs():

    _w = lambda a: (lambda t: t.to(torch.bfloat16) if t.is_floating_point() else t)(torch.as_tensor(a))

    def _A_setup():
        B, S, Dm = (1, 2048, 1024)
        H, Dh = (32, 128)
        M, seg = (8, 32)
        seg = min(seg, S)
        S = S // seg * seg
        return {'x': _w((lambda *s: torch.randn(*s, dtype=torch.bfloat16) * 0.05)(B, S, Dm)), 'mem0': _w((lambda *s: torch.randn(*s, dtype=torch.bfloat16) * 0.2)(B, M, Dm)), 'Wq': _w((lambda *s: torch.randn(*s, dtype=torch.bfloat16) * 1.6)(Dm, H, Dh) * Dm ** (-0.5)), 'Wk': _w((lambda *s: torch.randn(*s, dtype=torch.bfloat16) * 1.6)(Dm, H, Dh) * Dm ** (-0.5)), 'Wv': _w((lambda *s: torch.randn(*s, dtype=torch.bfloat16) * 0.2)(Dm, H, Dh) * Dm ** (-0.5)), 'Wo': _w((lambda *s: torch.randn(*s, dtype=torch.bfloat16) * 0.2)(H, Dh, Dm) * (H * Dh) ** (-0.5)), 'seg_len': seg}
    _A_in = _A_setup()

    def _B_setup():
        B, S, D, F = (1, 2048, 1024, 3584)
        return {'x': _w((lambda *s: torch.randn(*s, dtype=torch.bfloat16) * 0.05)(B, S, D)), 'w_gate': _w((lambda *s: torch.randn(*s, dtype=torch.bfloat16) * 0.05)(D, F)), 'w_up': _w((lambda *s: torch.randn(*s, dtype=torch.bfloat16) * 0.05)(D, F)), 'w_down': _w((lambda *s: torch.randn(*s, dtype=torch.bfloat16) * 0.05)(F, D))}
    _B_in = _B_setup()
    return {'A_x': _A_in['x'], 'A_mem0': _A_in['mem0'], 'A_Wq': _A_in['Wq'], 'A_Wk': _A_in['Wk'], 'A_Wv': _A_in['Wv'], 'A_Wo': _A_in['Wo'], 'A_seg_len': _A_in['seg_len'], 'B_x': _B_in['x'], 'B_w_gate': _B_in['w_gate'], 'B_w_up': _B_in['w_up'], 'B_w_down': _B_in['w_down']}

def reference(A_x, A_mem0, A_Wq, A_Wk, A_Wv, A_Wo, A_seg_len, B_x, B_w_gate, B_w_up, B_w_down):

    def _A_ref(x, mem0, Wq, Wk, Wv, Wo, seg_len):
        B, S, Dm = x.shape
        H, Dh = (Wq.shape[1], Wq.shape[2])
        M = mem0.shape[1]
        scale = Dh ** (-0.5)
        n_seg = S // seg_len
        L = M + seg_len
        idx = torch.arange(L)
        mask = (idx[:, None] < M) | (idx[:, None] >= idx[None, :])
        mem = mem0
        outs = []
        for s in range(n_seg):
            xs = x[:, s * seg_len:(s + 1) * seg_len, :].clone()
            h = torch.concatenate([mem, xs], axis=1)
            q = torch.einsum('btd,dhe->bhte', h, Wq)
            k = torch.einsum('btd,dhe->bhte', h, Wk)
            v = torch.einsum('btd,dhe->bhte', h, Wv)
            scores = torch.einsum('bhqe,bhke->bhqk', q, k) * scale
            scores = torch.where(mask[None, None], scores, -1000000000.0)
            p = _softmax(scores, axis=-1)
            o = torch.einsum('bhqk,bhke->bhqe', p, v)
            o = torch.einsum('bhte,hed->btd', o, Wo)
            mem = o[:, :M, :].clone()
            outs.append(o[:, M:, :])
        return torch.concatenate(outs, axis=1)

    def _B_ref(x, w_gate, w_up, w_down):
        return _gelu(x @ w_gate) * (x @ w_up) @ w_down
    x = A_x
    h = x + _A_ref(_layernorm(x, axis=-1), A_mem0, A_Wq, A_Wk, A_Wv, A_Wo, A_seg_len)
    h2 = h + _B_ref(_layernorm(h, axis=-1), B_w_gate, B_w_up, B_w_down)
    return h2
```

```asm
; @launch grid=(256,1,1) block=(256,1,1) lds=163840
.amdgcn_target "amdgcn-amd-amdhsa--gfx950"
.text
.globl sequential_preLN__memory_aug_recurrent_mem_tr__geglu_ffn__prompt_kernel
.p2align 8
.type sequential_preLN__memory_aug_recurrent_mem_tr__geglu_ffn__prompt_kernel,@function
sequential_preLN__memory_aug_recurrent_mem_tr__geglu_ffn__prompt_kernel:
s_cmp_ge_u32 s2, 256
s_cbranch_scc1 L_end
s_load_dwordx16 s[8:23], s[0:1], 0
s_load_dwordx8 s[24:31], s[0:1], 64
s_load_dwordx4 s[32:35], s[0:1], 96
s_getreg_b32 s60, hwreg(HW_REG_XCC_ID)
v_lshrrev_b32 v1, 6, v0
s_and_b32 s60, s60, 7
v_readfirstlane_b32 s56, v1
s_mov_b32 s52, 0x05040100
s_mov_b32 s53, 0x07060302
s_mov_b32 s54, -2
s_mov_b32 s63, 0
s_mov_b32 s62, 0
s_mov_b32 s58, 0
s_mov_b32 s59, 0
s_and_b32 s64, s60, 3
s_lshl_b32 s64, s64, 6
s_lshr_b32 s65, s60, 2
s_lshl_b32 s65, s65, 4
s_add_u32 s64, s64, s65
v_mov_b32 v3, s64
v_mov_b32 v2, 1
s_lshr_b32 s65, s2, 7
s_lshl_b32 s65, s65, 16
s_add_u32 s64, s65, 0x3c000
s_cmp_eq_u32 s56, 1
s_cselect_b32 s64, 0xbc000, s64
s_cmp_eq_u32 s56, 2
s_cselect_b32 s64, 0xfc000, s64
s_lshl_b32 s65, s2, 10
s_add_u32 s64, s64, s65
v_and_b32 v8, 63, v0
v_lshl_add_u32 v8, v8, 4, s64
s_lshl_b32 s65, s2, 7
s_sub_u32 s65, s65, 3072
v_lshl_add_u32 v9, v0, 4, s65
v_mov_b32 v10, 0x7fff0000
v_cmp_gt_u32 vcc, 200, v0
s_nop 1
v_cndmask_b32 v9, v10, v9, vcc
v_cmp_gt_u32 vcc, 192, v0
s_nop 1
v_cndmask_b32 v8, v9, v8, vcc
v_cndmask_b32 v4, 0, -1, vcc
v_cndmask_b32 v5, 0, -1, vcc
v_cndmask_b32 v6, 0, -1, vcc
v_cndmask_b32 v7, 0, -1, vcc
s_waitcnt lgkmcnt(0)
s_mov_b32 s36, s34
s_and_b32 s37, s35, 0xffff
s_mov_b32 s38, 0xfdfa000
s_mov_b32 s39, 0x20000
s_add_u32 s36, s34, 0x6000
s_addc_u32 s37, s35, 0
s_and_b32 s37, s37, 0xffff
s_mov_b32 s40, s32
s_and_b32 s41, s33, 0xffff
s_mov_b32 s42, 0x100
s_mov_b32 s43, 0x20000
s_cmp_lg_u32 s56, 0
s_cbranch_scc1 L_notick
s_mov_b64 exec, 1
buffer_atomic_add v2, v3, s[40:43], 0 offen sc0
s_mov_b64 exec, -1
L_notick:
buffer_store_dwordx4 v[4:7], v8, s[36:39], 0 offen sc1
s_mov_b32 s64, 0x200000
buffer_store_dwordx4 v[4:7], v8, s[36:39], s64 offen sc1
v_mov_b32 v3, 0x27ff8
s_and_b32 s64, s2, 3
s_lshl_b32 s65, s64, 6
s_add_u32 s65, s65, 48
v_mov_b32 v29, s65
v_mov_b32 v28, 1
s_cmp_lg_u32 s56, 0
s_cbranch_scc1 L_notick2
s_waitcnt vmcnt(2)
s_mov_b64 exec, 1
ds_write_b32 v3, v2
s_mov_b64 exec, -1
s_waitcnt lgkmcnt(0)
L_notick2:
s_barrier
ds_read_b32 v2, v3
s_waitcnt lgkmcnt(0)
v_readfirstlane_b32 s61, v2
s_waitcnt vmcnt(0)
s_barrier
s_or_b32 s64, s62, s56
s_cbranch_scc1 L_ce_1
s_mov_b64 exec, 1
buffer_atomic_add v28, v29, s[40:43], 0 offen
s_mov_b64 exec, -1
L_ce_1:
s_lshl_b32 s57, s60, 5
s_add_u32 s57, s57, s61
s_cmp_lt_u32 s61, 32
s_cbranch_scc1 L_dispatch
s_cmp_lg_u32 s62, 0
s_cbranch_scc1 L_cd_2
v_mbcnt_lo_u32_b32 v17, -1, 0
v_mbcnt_hi_u32_b32 v17, -1, v17
v_lshlrev_b32 v17, 2, v17
L_ct_3:
buffer_load_dword v18, v17, s[40:43], 0 offen sc1
s_mov_b32 s64, 0x10001000
s_mov_b32 s65, 0x10001000
s_waitcnt vmcnt(0)
v_cmp_ne_u32 vcc, 64, v18
s_nop 0
s_and_b64 s[64:65], s[64:65], vcc
s_cbranch_scc0 L_co_4
s_sleep 12
s_add_u32 s63, s63, 1
s_cmp_lt_u32 s63, 0x20000
s_cbranch_scc1 L_ct_3
s_branch L_giveup
L_co_4:
v_cmp_ne_u32 vcc, 32, v18
s_mov_b32 s64, 0x110011
s_mov_b32 s65, 0x110011
s_and_b64 s[64:65], s[64:65], vcc
s_cbranch_scc1 L_recensus
L_sd_5:
v_readlane_b32 s64, v18, 2
s_nop 0
s_cmp_lg_u32 s64, 0
s_cbranch_scc1 L_sk_6
s_sleep 4
buffer_load_dword v18, v17, s[40:43], 0 offen sc1
s_waitcnt vmcnt(0)
s_add_u32 s63, s63, 1
s_cmp_lt_u32 s63, 0x20000
s_cbranch_scc1 L_sd_5
s_branch L_giveup
L_sk_6:
s_cmp_eq_u32 s64, 2
s_cselect_b32 s64, 0x200000, 0
s_add_u32 s64, s64, 0x6000
s_add_u32 s36, s34, s64
s_addc_u32 s37, s35, 0
s_and_b32 s37, s37, 0xffff
L_cd_2:
L_recensus:
s_mov_b32 s57, s61
v_readlane_b32 s64, v18, 0
s_cmp_gt_u32 s60, 0
s_cselect_b32 s64, s64, 0
s_add_u32 s57, s57, s64
v_readlane_b32 s64, v18, 16
s_cmp_gt_u32 s60, 1
s_cselect_b32 s64, s64, 0
s_add_u32 s57, s57, s64
v_readlane_b32 s64, v18, 32
s_cmp_gt_u32 s60, 2
s_cselect_b32 s64, s64, 0
s_add_u32 s57, s57, s64
v_readlane_b32 s64, v18, 48
s_cmp_gt_u32 s60, 3
s_cselect_b32 s64, s64, 0
s_add_u32 s57, s57, s64
v_readlane_b32 s64, v18, 4
s_cmp_gt_u32 s60, 4
s_cselect_b32 s64, s64, 0
s_add_u32 s57, s57, s64
v_readlane_b32 s64, v18, 20
s_cmp_gt_u32 s60, 5
s_cselect_b32 s64, s64, 0
s_add_u32 s57, s57, s64
v_readlane_b32 s64, v18, 36
s_cmp_gt_u32 s60, 6
s_cselect_b32 s64, s64, 0
s_add_u32 s57, s57, s64
s_mov_b32 s58, 1
s_mov_b32 s62, 1
s_waitcnt vmcnt(0) lgkmcnt(0)
s_barrier
L_dispatch:
v_mbcnt_lo_u32_b32 v0, -1, 0
v_mbcnt_hi_u32_b32 v0, -1, v0
s_cmp_ge_u32 s57, 64
s_cbranch_scc1 L_disp2
s_bitcmp1_b32 s57, 4
s_cbranch_scc1 L_role_vo
s_branch L_role_qk
L_disp2:
s_and_b32 s64, s57, 31
s_cmp_ge_u32 s57, 192
s_cbranch_scc1 L_disp3
s_cmp_ge_u32 s64, 16
s_cbranch_scc1 L_role_qkv
s_cmp_lt_u32 s57, 128
s_cbranch_scc1 L_role_wo
s_branch L_role_f2
L_disp3:
s_cmp_lt_u32 s64, 28
s_cbranch_scc1 L_role_f1
s_branch L_role_aux
L_giveup:
L_end:
s_endpgm
L_role_qk:
s_lshr_b32 s80, s57, 5
s_and_b32 s81, s57, 15
s_lshl_b32 s82, s80, 4
s_add_u32 s82, s82, s81
s_mov_b32 s98, 0xffff0000
v_and_b32 v1, 63, v0
s_mov_b32 s2, 0x10001
s_mov_b32 s3, 0x10001
s_cmp_lt_u32 s56, 2
s_cselect_b32 s44, s12, s14
s_cselect_b32 s45, s13, s15
s_and_b32 s45, s45, 0xffff
s_mov_b32 s46, 0x800000
s_mov_b32 s47, 0x20000
v_lshrrev_b32 v20, 5, v1
v_lshlrev_b32 v20, 6, v20
v_bfe_u32 v21, v1, 4, 1
v_lshl_add_u32 v20, v21, 2, v20
v_lshlrev_b32 v20, 13, v20
v_and_b32 v21, 15, v1
v_lshl_add_u32 v20, v21, 3, v20
s_and_b32 s64, s56, 1
s_lshl_b32 s64, s64, 7
s_lshl_b32 s65, s82, 8
s_add_u32 s64, s64, s65
v_add_u32 v20, s64, v20
v_and_b32 v21, 3, v1
v_and_b32 v23, 15, v1
v_cmp_eq_u32 vcc, 0, v21
s_nop 1
v_cndmask_b32 v24, 0, 1.0, vcc
v_cmp_eq_u32 vcc, 1, v21
s_nop 1
v_cndmask_b32 v25, 0, 1.0, vcc
v_perm_b32 v26, v25, v24, s53
v_cmp_eq_u32 vcc, 2, v21
s_nop 1
v_cndmask_b32 v24, 0, 1.0, vcc
v_cmp_eq_u32 vcc, 3, v21
s_nop 1
v_cndmask_b32 v25, 0, 1.0, vcc
v_perm_b32 v27, v25, v24, s53
v_lshlrev_b32 v21, 3, v1
v_add_u32 v21, 161024, v21
ds_write_b64 v21, v[26:27]
s_lshl_b32 s64, s57, 7
s_lshl_b32 s65, s56, 2
s_add_u32 s64, s64, s65
v_mov_b32 v22, 0x7fff0000
v_mov_b32 v255, s64
v_cmp_eq_u32 vcc, 0, v1
s_nop 1
v_cndmask_b32 v22, v22, v255, vcc
v_and_b32 v21, 8, v1
v_mov_b32 v3, 0x4444
v_mov_b32 v255, 0xeeee
v_cmp_ne_u32 vcc, 0, v21
s_nop 1
v_cndmask_b32 v3, v3, v255, vcc
v_lshlrev_b32 v5, 4, v1
v_lshrrev_b32 v21, 4, v1
v_lshlrev_b32 v21, 10, v21
v_bfe_u32 v23, v1, 3, 1
v_lshl_add_u32 v21, v23, 8, v21
v_and_b32 v23, 7, v1
v_lshl_add_u32 v21, v23, 4, v21
v_and_b32 v23, 15, v1
s_lshl_b32 s64, s56, 12
v_add_u32 v2, s64, v21
v_add_u32 v4, s64, v5
s_and_b32 s64, s64, 0x2000
v_add_u32 v2, s64, v2
s_mul_i32 s64, s56, 28672
s_add_u32 s64, s64, 46080
v_add_u32 v7, s64, v5
s_and_b32 s66, s56, 1
s_lshr_b32 s67, s56, 1
v_lshrrev_b32 v21, 5, v1
v_bfe_u32 v24, v1, 4, 1
v_lshl_add_u32 v21, v24, 1, v21
v_mul_u32_u24 v21, 576, v21
v_lshl_add_u32 v21, v23, 3, v21
s_lshl_b32 s64, s66, 7
s_mul_i32 s65, s67, 2304
s_add_u32 s64, s64, s65
s_add_u32 s64, s64, 40960
v_add_u32 v8, s64, v21
v_mul_u32_u24 v21, 288, v23
v_lshrrev_b32 v24, 4, v1
v_lshl_add_u32 v9, v24, 4, v21
s_lshl_b32 s64, s56, 9
s_sub_u32 s65, s64, 512
v_add_u32 v21, s65, v5
v_mov_b32 v25, 0x7fff0000
v_cmp_le_u32 vcc, 32, v1
s_nop 1
v_cndmask_b32 v10, v25, v21, vcc
v_mov_b32 v26, 0xff800000
v_cndmask_b32 v15, v26, 0, vcc
v_lshlrev_b32 v21, 7, v24
v_lshl_add_u32 v21, v23, 4, v21
v_add_u32 v21, s64, v21
v_cmp_gt_u32 vcc, 8, v23
s_nop 1
v_cndmask_b32 v11, v25, v21, vcc
v_lshlrev_b32 v21, 9, v24
v_lshl_add_u32 v21, v23, 4, v21
s_lshl_b32 s64, s56, 11
s_lshl_b32 s65, s66, 8
s_add_u32 s65, s65, s64
v_add_u32 v12, s65, v21
s_add_u32 s64, s64, 24576
v_add_u32 v13, s64, v5
s_lshl_b32 s64, s66, 12
s_add_u32 s64, s64, 32768
v_add_u32 v14, s64, v5
s_lshl_b32 s64, s66, 4
v_add_u32 v21, s64, v23
v_lshlrev_b32 v24, 2, v24
v_sub_u32 v6, v21, v24
s_and_b32 s64, s82, 28
s_lshl_b32 s64, s64, 1
s_lshr_b32 s65, s64, 4
s_lshl_b32 s65, s65, 5
s_and_b32 s64, s64, 15
s_add_u32 s64, s64, s65
s_add_u32 s64, s64, 80
s_lshl_b32 s64, s64, 7
v_bfe_u32 v21, v1, 2, 3
v_lshlrev_b32 v21, 7, v21
v_and_b32 v23, 3, v1
v_lshl_add_u32 v21, v23, 2, v21
v_add_u32 v1, s64, v21
v_mov_b32 v0, v22
s_mov_b32 s99, 0x3e0293ee
s_lshl_b32 s86, s80, 15
s_lshl_b32 s64, s81, 11
s_add_u32 s86, s86, s64
s_add_u32 s86, s86, 0xbc000
s_lshl_b32 s87, s82, 11
s_add_u32 s87, s87, 0xfc000
s_mul_i32 s90, s56, 2048
s_mul_i32 s88, s82, 49152
s_add_u32 s88, s88, s90
s_add_u32 s88, s88, 0xbfc000
s_add_u32 s90, s90, 16384
s_lshl_b32 s83, s82, 14
s_add_u32 s83, s83, 0x8ffc000
s_sub_u32 s89, s83, 0x80000
s_mov_b32 s64, 0x0
buffer_load_dwordx2 v[252:253], v20, s[44:47], s64 offen nt
s_mov_b32 s64, 0x2000
buffer_load_dwordx2 v[254:255], v20, s[44:47], s64 offen nt
s_mov_b32 s64, 0x20000
buffer_load_dwordx2 v[248:249], v20, s[44:47], s64 offen nt
s_mov_b32 s64, 0x22000
buffer_load_dwordx2 v[250:251], v20, s[44:47], s64 offen nt
s_mov_b32 s64, 0x4000
buffer_load_dwordx2 v[244:245], v20, s[44:47], s64 offen nt
s_mov_b32 s64, 0x6000
buffer_load_dwordx2 v[246:247], v20, s[44:47], s64 offen nt
s_mov_b32 s64, 0x24000
buffer_load_dwordx2 v[240:241], v20, s[44:47], s64 offen nt
s_mov_b32 s64, 0x26000
buffer_load_dwordx2 v[242:243], v20, s[44:47], s64 offen nt
s_mov_b32 s64, 0x100000
buffer_load_dwordx2 v[236:237], v20, s[44:47], s64 offen nt
s_mov_b32 s64, 0x102000
buffer_load_dwordx2 v[238:239], v20, s[44:47], s64 offen nt
s_mov_b32 s64, 0x120000
buffer_load_dwordx2 v[232:233], v20, s[44:47], s64 offen nt
s_mov_b32 s64, 0x122000
buffer_load_dwordx2 v[234:235], v20, s[44:47], s64 offen nt
s_mov_b32 s64, 0x104000
buffer_load_dwordx2 v[228:229], v20, s[44:47], s64 offen nt
s_mov_b32 s64, 0x106000
buffer_load_dwordx2 v[230:231], v20, s[44:47], s64 offen nt
s_mov_b32 s64, 0x124000
buffer_load_dwordx2 v[224:225], v20, s[44:47], s64 offen nt
s_mov_b32 s64, 0x126000
buffer_load_dwordx2 v[226:227], v20, s[44:47], s64 offen nt
s_mov_b32 s64, 0x40000
buffer_load_dwordx2 v[220:221], v20, s[44:47], s64 offen nt
s_mov_b32 s64, 0x42000
buffer_load_dwordx2 v[222:223], v20, s[44:47], s64 offen nt
s_mov_b32 s64, 0x60000
buffer_load_dwordx2 v[216:217], v20, s[44:47], s64 offen nt
s_mov_b32 s64, 0x62000
buffer_load_dwordx2 v[218:219], v20, s[44:47], s64 offen nt
s_mov_b32 s64, 0x44000
buffer_load_dwordx2 v[212:213], v20, s[44:47], s64 offen nt
s_mov_b32 s64, 0x46000
buffer_load_dwordx2 v[214:215], v20, s[44:47], s64 offen nt
s_mov_b32 s64, 0x64000
buffer_load_dwordx2 v[208:209], v20, s[44:47], s64 offen nt
s_mov_b32 s64, 0x66000
buffer_load_dwordx2 v[210:211], v20, s[44:47], s64 offen nt
s_mov_b32 s64, 0x140000
buffer_load_dwordx2 v[204:205], v20, s[44:47], s64 offen nt
s_mov_b32 s64, 0x142000
buffer_load_dwordx2 v[206:207], v20, s[44:47], s64 offen nt
s_mov_b32 s64, 0x160000
buffer_load_dwordx2 v[200:201], v20, s[44:47], s64 offen nt
s_mov_b32 s64, 0x162000
buffer_load_dwordx2 v[202:203], v20, s[44:47], s64 offen nt
s_mov_b32 s64, 0x144000
buffer_load_dwordx2 v[196:197], v20, s[44:47], s64 offen nt
s_mov_b32 s64, 0x146000
buffer_load_dwordx2 v[198:199], v20, s[44:47], s64 offen nt
s_mov_b32 s64, 0x164000
buffer_load_dwordx2 v[192:193], v20, s[44:47], s64 offen nt
s_mov_b32 s64, 0x166000
buffer_load_dwordx2 v[194:195], v20, s[44:47], s64 offen nt
s_mov_b32 s64, 0x10000
buffer_load_dwordx2 v[188:189], v20, s[44:47], s64 offen nt
s_mov_b32 s64, 0x12000
buffer_load_dwordx2 v[190:191], v20, s[44:47], s64 offen nt
s_mov_b32 s64, 0x30000
buffer_load_dwordx2 v[184:185], v20, s[44:47], s64 offen nt
s_mov_b32 s64, 0x32000
buffer_load_dwordx2 v[186:187], v20, s[44:47], s64 offen nt
s_mov_b32 s64, 0x14000
buffer_load_dwordx2 v[180:181], v20, s[44:47], s64 offen nt
s_mov_b32 s64, 0x16000
buffer_load_dwordx2 v[182:183], v20, s[44:47], s64 offen nt
s_mov_b32 s64, 0x34000
buffer_load_dwordx2 v[176:177], v20, s[44:47], s64 offen nt
s_mov_b32 s64, 0x36000
buffer_load_dwordx2 v[178:179], v20, s[44:47], s64 offen nt
s_mov_b32 s64, 0x110000
buffer_load_dwordx2 v[172:173], v20, s[44:47], s64 offen nt
s_mov_b32 s64, 0x112000
buffer_load_dwordx2 v[174:175], v20, s[44:47], s64 offen nt
s_mov_b32 s64, 0x130000
buffer_load_dwordx2 v[168:169], v20, s[44:47], s64 offen nt
s_mov_b32 s64, 0x132000
buffer_load_dwordx2 v[170:171], v20, s[44:47], s64 offen nt
s_mov_b32 s64, 0x114000
buffer_load_dwordx2 v[164:165], v20, s[44:47], s64 offen nt
s_mov_b32 s64, 0x116000
buffer_load_dwordx2 v[166:167], v20, s[44:47], s64 offen nt
s_mov_b32 s64, 0x134000
buffer_load_dwordx2 v[160:161], v20, s[44:47], s64 offen nt
s_mov_b32 s64, 0x136000
buffer_load_dwordx2 v[162:163], v20, s[44:47], s64 offen nt
s_mov_b32 s64, 0x50000
buffer_load_dwordx2 v[156:157], v20, s[44:47], s64 offen nt
s_mov_b32 s64, 0x52000
buffer_load_dwordx2 v[158:159], v20, s[44:47], s64 offen nt
s_mov_b32 s64, 0x70000
buffer_load_dwordx2 v[152:153], v20, s[44:47], s64 offen nt
s_mov_b32 s64, 0x72000
buffer_load_dwordx2 v[154:155], v20, s[44:47], s64 offen nt
s_mov_b32 s64, 0x54000
buffer_load_dwordx2 v[148:149], v20, s[44:47], s64 offen nt
s_mov_b32 s64, 0x56000
buffer_load_dwordx2 v[150:151], v20, s[44:47], s64 offen nt
s_mov_b32 s64, 0x74000
buffer_load_dwordx2 v[144:145], v20, s[44:47], s64 offen nt
s_mov_b32 s64, 0x76000
buffer_load_dwordx2 v[146:147], v20, s[44:47], s64 offen nt
s_mov_b32 s64, 0x150000
buffer_load_dwordx2 v[140:141], v20, s[44:47], s64 offen nt
s_mov_b32 s64, 0x152000
buffer_load_dwordx2 v[142:143], v20, s[44:47], s64 offen nt
s_mov_b32 s64, 0x170000
buffer_load_dwordx2 v[136:137], v20, s[44:47], s64 offen nt
s_mov_b32 s64, 0x172000
buffer_load_dwordx2 v[138:139], v20, s[44:47], s64 offen nt
s_waitcnt vmcnt(56)
v_perm_b32 v16, v254, v252, s52
v_accvgpr_write_b32 a0, v16
v_perm_b32 v17, v254, v252, s53
v_accvgpr_write_b32 a8, v17
v_perm_b32 v18, v255, v253, s52
v_accvgpr_write_b32 a16, v18
v_perm_b32 v19, v255, v253, s53
v_accvgpr_write_b32 a24, v19
s_mov_b32 s64, 0x154000
buffer_load_dwordx2 v[252:253], v20, s[44:47], s64 offen nt
s_mov_b32 s64, 0x156000
buffer_load_dwordx2 v[254:255], v20, s[44:47], s64 offen nt
v_perm_b32 v16, v250, v248, s52
v_accvgpr_write_b32 a1, v16
v_perm_b32 v17, v250, v248, s53
v_accvgpr_write_b32 a9, v17
v_perm_b32 v18, v251, v249, s52
v_accvgpr_write_b32 a17, v18
v_perm_b32 v19, v251, v249, s53
v_accvgpr_write_b32 a25, v19
s_mov_b32 s64, 0x174000
buffer_load_dwordx2 v[248:249], v20, s[44:47], s64 offen nt
s_mov_b32 s64, 0x176000
buffer_load_dwordx2 v[250:251], v20, s[44:47], s64 offen nt
s_waitcnt vmcnt(56)
v_perm_b32 v16, v246, v244, s52
v_accvgpr_write_b32 a2, v16
v_perm_b32 v17, v246, v244, s53
v_accvgpr_write_b32 a10, v17
v_perm_b32 v18, v247, v245, s52
v_accvgpr_write_b32 a18, v18
v_perm_b32 v19, v247, v245, s53
v_accvgpr_write_b32 a26, v19
s_mov_b32 s64, 0x200000
buffer_load_dwordx2 v[244:245], v20, s[44:47], s64 offen nt
s_mov_b32 s64, 0x202000
buffer_load_dwordx2 v[246:247], v20, s[44:47], s64 offen nt
v_perm_b32 v16, v242, v240, s52
v_accvgpr_write_b32 a3, v16
v_perm_b32 v17, v242, v240, s53
v_accvgpr_write_b32 a11, v17
v_perm_b32 v18, v243, v241, s52
v_accvgpr_write_b32 a19, v18
v_perm_b32 v19, v243, v241, s53
v_accvgpr_write_b32 a27, v19
s_mov_b32 s64, 0x220000
buffer_load_dwordx2 v[240:241], v20, s[44:47], s64 offen nt
s_mov_b32 s64, 0x222000
buffer_load_dwordx2 v[242:243], v20, s[44:47], s64 offen nt
s_waitcnt vmcnt(56)
v_perm_b32 v16, v238, v236, s52
v_accvgpr_write_b32 a4, v16
v_perm_b32 v17, v238, v236, s53
v_accvgpr_write_b32 a12, v17
v_perm_b32 v18, v239, v237, s52
v_accvgpr_write_b32 a20, v18
v_perm_b32 v19, v239, v237, s53
v_accvgpr_write_b32 a28, v19
s_mov_b32 s64, 0x204000
buffer_load_dwordx2 v[236:237], v20, s[44:47], s64 offen nt
s_mov_b32 s64, 0x206000
buffer_load_dwordx2 v[238:239], v20, s[44:47], s64 offen nt
v_perm_b32 v16, v234, v232, s52
v_accvgpr_write_b32 a5, v16
v_perm_b32 v17, v234, v232, s53
v_accvgpr_write_b32 a13, v17
v_perm_b32 v18, v235, v233, s52
v_accvgpr_write_b32 a21, v18
v_perm_b32 v19, v235, v233, s53
v_accvgpr_write_b32 a29, v19
s_mov_b32 s64, 0x224000
buffer_load_dwordx2 v[232:233], v20, s[44:47], s64 offen nt
s_mov_b32 s64, 0x226000
buffer_load_dwordx2 v[234:235], v20, s[44:47], s64 offen nt
s_waitcnt vmcnt(56)
v_perm_b32 v16, v230, v228, s52
v_accvgpr_write_b32 a6, v16
v_perm_b32 v17, v230, v228, s53
v_accvgpr_write_b32 a14, v17
v_perm_b32 v18, v231, v229, s52
v_accvgpr_write_b32 a22, v18
v_perm_b32 v19, v231, v229, s53
v_accvgpr_write_b32 a30, v19
s_mov_b32 s64, 0x300000
buffer_load_dwordx2 v[228:229], v20, s[44:47], s64 offen nt
s_mov_b32 s64, 0x302000
buffer_load_dwordx2 v[230:231], v20, s[44:47], s64 offen nt
v_perm_b32 v16, v226, v224, s52
v_accvgpr_write_b32 a7, v16
v_perm_b32 v17, v226, v224, s53
v_accvgpr_write_b32 a15, v17
v_perm_b32 v18, v227, v225, s52
v_accvgpr_write_b32 a23, v18
v_perm_b32 v19, v227, v225, s53
v_accvgpr_write_b32 a31, v19
s_mov_b32 s64, 0x320000
buffer_load_dwordx2 v[224:225], v20, s[44:47], s64 offen nt
s_mov_b32 s64, 0x322000
buffer_load_dwordx2 v[226:227], v20, s[44:47], s64 offen nt
s_waitcnt vmcnt(56)
v_perm_b32 v16, v222, v220, s52
v_accvgpr_write_b32 a112, v16
v_perm_b32 v17, v222, v220, s53
v_accvgpr_write_b32 a120, v17
v_perm_b32 v18, v223, v221, s52
v_accvgpr_write_b32 a128, v18
v_perm_b32 v24, v223, v221, s53
s_mov_b32 s64, 0x304000
buffer_load_dwordx2 v[220:221], v20, s[44:47], s64 offen nt
s_mov_b32 s64, 0x306000
buffer_load_dwordx2 v[222:223], v20, s[44:47], s64 offen nt
v_perm_b32 v19, v218, v216, s52
v_accvgpr_write_b32 a113, v19
v_perm_b32 v16, v218, v216, s53
v_accvgpr_write_b32 a121, v16
v_perm_b32 v17, v219, v217, s52
v_accvgpr_write_b32 a129, v17
v_perm_b32 v25, v219, v217, s53
s_mov_b32 s64, 0x324000
buffer_load_dwordx2 v[216:217], v20, s[44:47], s64 offen nt
s_mov_b32 s64, 0x326000
buffer_load_dwordx2 v[218:219], v20, s[44:47], s64 offen nt
s_waitcnt vmcnt(56)
v_perm_b32 v18, v214, v212, s52
v_accvgpr_write_b32 a114, v18
v_perm_b32 v19, v214, v212, s53
v_accvgpr_write_b32 a122, v19
v_perm_b32 v16, v215, v213, s52
v_accvgpr_write_b32 a130, v16
v_perm_b32 v26, v215, v213, s53
s_mov_b32 s64, 0x240000
buffer_load_dwordx2 v[212:213], v20, s[44:47], s64 offen nt
s_mov_b32 s64, 0x242000
buffer_load_dwordx2 v[214:215], v20, s[44:47], s64 offen nt
v_perm_b32 v17, v210, v208, s52
v_accvgpr_write_b32 a115, v17
v_perm_b32 v18, v210, v208, s53
v_accvgpr_write_b32 a123, v18
v_perm_b32 v19, v211, v209, s52
v_accvgpr_write_b32 a131, v19
v_perm_b32 v27, v211, v209, s53
ds_write_b128 v7, v[24:27] offset:4096
s_mov_b32 s64, 0x260000
buffer_load_dwordx2 v[208:209], v20, s[44:47], s64 offen nt
s_mov_b32 s64, 0x262000
buffer_load_dwordx2 v[210:211], v20, s[44:47], s64 offen nt
s_waitcnt vmcnt(56)
v_perm_b32 v16, v206, v204, s52
v_accvgpr_write_b32 a116, v16
v_perm_b32 v17, v206, v204, s53
v_accvgpr_write_b32 a124, v17
v_perm_b32 v18, v207, v205, s52
v_accvgpr_write_b32 a132, v18
v_perm_b32 v28, v207, v205, s53
s_mov_b32 s64, 0x244000
buffer_load_dwordx2 v[204:205], v20, s[44:47], s64 offen nt
s_mov_b32 s64, 0x246000
buffer_load_dwordx2 v[206:207], v20, s[44:47], s64 offen nt
v_perm_b32 v19, v202, v200, s52
v_accvgpr_write_b32 a117, v19
v_perm_b32 v16, v202, v200, s53
v_accvgpr_write_b32 a125, v16
v_perm_b32 v17, v203, v201, s52
v_accvgpr_write_b32 a133, v17
v_perm_b32 v29, v203, v201, s53
s_mov_b32 s64, 0x264000
buffer_load_dwordx2 v[200:201], v20, s[44:47], s64 offen nt
s_mov_b32 s64, 0x266000
buffer_load_dwordx2 v[202:203], v20, s[44:47], s64 offen nt
s_waitcnt vmcnt(56)
v_perm_b32 v18, v198, v196, s52
v_accvgpr_write_b32 a118, v18
v_perm_b32 v19, v198, v196, s53
v_accvgpr_write_b32 a126, v19
v_perm_b32 v16, v199, v197, s52
v_accvgpr_write_b32 a134, v16
v_perm_b32 v30, v199, v197, s53
s_mov_b32 s64, 0x340000
buffer_load_dwordx2 v[196:197], v20, s[44:47], s64 offen nt
s_mov_b32 s64, 0x342000
buffer_load_dwordx2 v[198:199], v20, s[44:47], s64 offen nt
v_perm_b32 v17, v194, v192, s52
v_accvgpr_write_b32 a119, v17
v_perm_b32 v18, v194, v192, s53
v_accvgpr_write_b32 a127, v18
v_perm_b32 v19, v195, v193, s52
v_accvgpr_write_b32 a135, v19
v_perm_b32 v31, v195, v193, s53
ds_write_b128 v7, v[28:31] offset:5120
s_mov_b32 s64, 0x360000
buffer_load_dwordx2 v[192:193], v20, s[44:47], s64 offen nt
s_mov_b32 s64, 0x362000
buffer_load_dwordx2 v[194:195], v20, s[44:47], s64 offen nt
s_waitcnt vmcnt(56)
v_perm_b32 v16, v190, v188, s52
v_accvgpr_write_b32 a208, v16
v_perm_b32 v17, v190, v188, s53
v_accvgpr_write_b32 a216, v17
v_perm_b32 v18, v191, v189, s52
v_accvgpr_write_b32 a224, v18
v_perm_b32 v24, v191, v189, s53
s_mov_b32 s64, 0x344000
buffer_load_dwordx2 v[188:189], v20, s[44:47], s64 offen nt
s_mov_b32 s64, 0x346000
buffer_load_dwordx2 v[190:191], v20, s[44:47], s64 offen nt
v_perm_b32 v19, v186, v184, s52
v_accvgpr_write_b32 a209, v19
v_perm_b32 v16, v186, v184, s53
v_accvgpr_write_b32 a217, v16
v_perm_b32 v17, v187, v185, s52
v_accvgpr_write_b32 a225, v17
v_perm_b32 v25, v187, v185, s53
s_mov_b32 s64, 0x364000
buffer_load_dwordx2 v[184:185], v20, s[44:47], s64 offen nt
s_mov_b32 s64, 0x366000
buffer_load_dwordx2 v[186:187], v20, s[44:47], s64 offen nt
s_waitcnt vmcnt(56)
v_perm_b32 v18, v182, v180, s52
v_accvgpr_write_b32 a210, v18
v_perm_b32 v19, v182, v180, s53
v_accvgpr_write_b32 a218, v19
v_perm_b32 v16, v183, v181, s52
v_accvgpr_write_b32 a226, v16
v_perm_b32 v26, v183, v181, s53
s_mov_b32 s64, 0x210000
buffer_load_dwordx2 v[132:133], v20, s[44:47], s64 offen nt
s_mov_b32 s64, 0x212000
buffer_load_dwordx2 v[134:135], v20, s[44:47], s64 offen nt
v_perm_b32 v17, v178, v176, s52
v_accvgpr_write_b32 a211, v17
v_perm_b32 v18, v178, v176, s53
v_accvgpr_write_b32 a219, v18
v_perm_b32 v19, v179, v177, s52
v_accvgpr_write_b32 a227, v19
v_perm_b32 v27, v179, v177, s53
ds_write_b128 v7, v[24:27] offset:12288
s_mov_b32 s64, 0x230000
buffer_load_dwordx2 v[128:129], v20, s[44:47], s64 offen nt
s_mov_b32 s64, 0x232000
buffer_load_dwordx2 v[130:131], v20, s[44:47], s64 offen nt
s_waitcnt vmcnt(56)
v_perm_b32 v16, v174, v172, s52
v_accvgpr_write_b32 a212, v16
v_perm_b32 v17, v174, v172, s53
v_accvgpr_write_b32 a220, v17
v_perm_b32 v18, v175, v173, s52
v_accvgpr_write_b32 a228, v18
v_perm_b32 v28, v175, v173, s53
s_mov_b32 s64, 0x214000
buffer_load_dwordx2 v[124:125], v20, s[44:47], s64 offen nt
s_mov_b32 s64, 0x216000
buffer_load_dwordx2 v[126:127], v20, s[44:47], s64 offen nt
v_perm_b32 v19, v170, v168, s52
v_accvgpr_write_b32 a213, v19
v_perm_b32 v16, v170, v168, s53
v_accvgpr_write_b32 a221, v16
v_perm_b32 v17, v171, v169, s52
v_accvgpr_write_b32 a229, v17
v_perm_b32 v29, v171, v169, s53
s_mov_b32 s64, 0x234000
buffer_load_dwordx2 v[120:121], v20, s[44:47], s64 offen nt
s_mov_b32 s64, 0x236000
buffer_load_dwordx2 v[122:123], v20, s[44:47], s64 offen nt
s_waitcnt vmcnt(56)
v_perm_b32 v18, v166, v164, s52
v_accvgpr_write_b32 a214, v18
v_perm_b32 v19, v166, v164, s53
v_accvgpr_write_b32 a222, v19
v_perm_b32 v16, v167, v165, s52
v_accvgpr_write_b32 a230, v16
v_perm_b32 v30, v167, v165, s53
s_mov_b32 s64, 0x310000
buffer_load_dwordx2 v[116:117], v20, s[44:47], s64 offen nt
s_mov_b32 s64, 0x312000
buffer_load_dwordx2 v[118:119], v20, s[44:47], s64 offen nt
v_perm_b32 v17, v162, v160, s52
v_accvgpr_write_b32 a215, v17
v_perm_b32 v18, v162, v160, s53
v_accvgpr_write_b32 a223, v18
v_perm_b32 v19, v163, v161, s52
v_accvgpr_write_b32 a231, v19
v_perm_b32 v31, v163, v161, s53
ds_write_b128 v7, v[28:31] offset:13312
s_mov_b32 s64, 0x330000
buffer_load_dwordx2 v[112:113], v20, s[44:47], s64 offen nt
s_mov_b32 s64, 0x332000
buffer_load_dwordx2 v[114:115], v20, s[44:47], s64 offen nt
s_waitcnt vmcnt(56)
v_perm_b32 v160, v158, v156, s52
v_perm_b32 v168, v158, v156, s53
v_perm_b32 v176, v159, v157, s52
v_perm_b32 v24, v159, v157, s53
s_mov_b32 s64, 0x314000
buffer_load_dwordx2 v[156:157], v20, s[44:47], s64 offen nt
s_mov_b32 s64, 0x316000
buffer_load_dwordx2 v[158:159], v20, s[44:47], s64 offen nt
v_perm_b32 v161, v154, v152, s52
v_perm_b32 v169, v154, v152, s53
v_perm_b32 v177, v155, v153, s52
v_perm_b32 v25, v155, v153, s53
s_mov_b32 s64, 0x334000
buffer_load_dwordx2 v[152:153], v20, s[44:47], s64 offen nt
s_mov_b32 s64, 0x336000
buffer_load_dwordx2 v[154:155], v20, s[44:47], s64 offen nt
s_waitcnt vmcnt(56)
v_perm_b32 v162, v150, v148, s52
v_perm_b32 v170, v150, v148, s53
v_perm_b32 v178, v151, v149, s52
v_perm_b32 v26, v151, v149, s53
s_mov_b32 s64, 0x250000
buffer_load_dwordx2 v[148:149], v20, s[44:47], s64 offen nt
s_mov_b32 s64, 0x252000
buffer_load_dwordx2 v[150:151], v20, s[44:47], s64 offen nt
v_perm_b32 v163, v146, v144, s52
v_perm_b32 v171, v146, v144, s53
v_perm_b32 v179, v147, v145, s52
v_perm_b32 v27, v147, v145, s53
ds_write_b128 v7, v[24:27] offset:20480
s_mov_b32 s64, 0x270000
buffer_load_dwordx2 v[144:145], v20, s[44:47], s64 offen nt
s_mov_b32 s64, 0x272000
buffer_load_dwordx2 v[146:147], v20, s[44:47], s64 offen nt
s_waitcnt vmcnt(56)
v_perm_b32 v164, v142, v140, s52
v_perm_b32 v172, v142, v140, s53
v_perm_b32 v180, v143, v141, s52
v_perm_b32 v28, v143, v141, s53
s_mov_b32 s64, 0x254000
buffer_load_dwordx2 v[140:141], v20, s[44:47], s64 offen nt
s_mov_b32 s64, 0x256000
buffer_load_dwordx2 v[142:143], v20, s[44:47], s64 offen nt
v_perm_b32 v165, v138, v136, s52
v_perm_b32 v173, v138, v136, s53
v_perm_b32 v181, v139, v137, s52
v_perm_b32 v29, v139, v137, s53
s_mov_b32 s64, 0x274000
buffer_load_dwordx2 v[136:137], v20, s[44:47], s64 offen nt
s_mov_b32 s64, 0x276000
buffer_load_dwordx2 v[138:139], v20, s[44:47], s64 offen nt
s_waitcnt vmcnt(56)
v_perm_b32 v166, v254, v252, s52
v_perm_b32 v174, v254, v252, s53
v_perm_b32 v182, v255, v253, s52
v_perm_b32 v30, v255, v253, s53
s_mov_b32 s64, 0x350000
buffer_load_dwordx2 v[252:253], v20, s[44:47], s64 offen nt
s_mov_b32 s64, 0x352000
buffer_load_dwordx2 v[254:255], v20, s[44:47], s64 offen nt
v_perm_b32 v167, v250, v248, s52
v_perm_b32 v175, v250, v248, s53
v_perm_b32 v183, v251, v249, s52
v_perm_b32 v31, v251, v249, s53
ds_write_b128 v7, v[28:31] offset:21504
s_mov_b32 s64, 0x370000
buffer_load_dwordx2 v[248:249], v20, s[44:47], s64 offen nt
s_mov_b32 s64, 0x372000
buffer_load_dwordx2 v[250:251], v20, s[44:47], s64 offen nt
s_waitcnt vmcnt(56)
v_perm_b32 v16, v246, v244, s52
v_accvgpr_write_b32 a32, v16
v_perm_b32 v17, v246, v244, s53
v_accvgpr_write_b32 a40, v17
v_perm_b32 v18, v247, v245, s52
v_accvgpr_write_b32 a48, v18
v_perm_b32 v19, v247, v245, s53
v_accvgpr_write_b32 a56, v19
s_mov_b32 s64, 0x354000
buffer_load_dwordx2 v[244:245], v20, s[44:47], s64 offen nt
s_mov_b32 s64, 0x356000
buffer_load_dwordx2 v[246:247], v20, s[44:47], s64 offen nt
v_perm_b32 v16, v242, v240, s52
v_accvgpr_write_b32 a33, v16
v_perm_b32 v17, v242, v240, s53
v_accvgpr_write_b32 a41, v17
v_perm_b32 v18, v243, v241, s52
v_accvgpr_write_b32 a49, v18
v_perm_b32 v19, v243, v241, s53
v_accvgpr_write_b32 a57, v19
s_mov_b32 s64, 0x374000
buffer_load_dwordx2 v[240:241], v20, s[44:47], s64 offen nt
s_mov_b32 s64, 0x376000
buffer_load_dwordx2 v[242:243], v20, s[44:47], s64 offen nt
s_waitcnt vmcnt(56)
v_perm_b32 v16, v238, v236, s52
v_accvgpr_write_b32 a34, v16
v_perm_b32 v17, v238, v236, s53
v_accvgpr_write_b32 a42, v17
v_perm_b32 v18, v239, v237, s52
v_accvgpr_write_b32 a50, v18
v_perm_b32 v19, v239, v237, s53
v_accvgpr_write_b32 a58, v19
s_mov_b32 s64, 0x400000
buffer_load_dwordx2 v[236:237], v20, s[44:47], s64 offen nt
s_mov_b32 s64, 0x402000
buffer_load_dwordx2 v[238:239], v20, s[44:47], s64 offen nt
v_perm_b32 v16, v234, v232, s52
v_accvgpr_write_b32 a35, v16
v_perm_b32 v17, v234, v232, s53
v_accvgpr_write_b32 a43, v17
v_perm_b32 v18, v235, v233, s52
v_accvgpr_write_b32 a51, v18
v_perm_b32 v19, v235, v233, s53
v_accvgpr_write_b32 a59, v19
s_mov_b32 s64, 0x420000
buffer_load_dwordx2 v[232:233], v20, s[44:47], s64 offen nt
s_mov_b32 s64, 0x422000
buffer_load_dwordx2 v[234:235], v20, s[44:47], s64 offen nt
s_waitcnt vmcnt(56)
v_perm_b32 v16, v230, v228, s52
v_accvgpr_write_b32 a36, v16
v_perm_b32 v17, v230, v228, s53
v_accvgpr_write_b32 a44, v17
v_perm_b32 v18, v231, v229, s52
v_accvgpr_write_b32 a52, v18
v_perm_b32 v19, v231, v229, s53
v_accvgpr_write_b32 a60, v19
s_mov_b32 s64, 0x404000
buffer_load_dwordx2 v[228:229], v20, s[44:47], s64 offen nt
s_mov_b32 s64, 0x406000
buffer_load_dwordx2 v[230:231], v20, s[44:47], s64 offen nt
v_perm_b32 v16, v226, v224, s52
v_accvgpr_write_b32 a37, v16
v_perm_b32 v17, v226, v224, s53
v_accvgpr_write_b32 a45, v17
v_perm_b32 v18, v227, v225, s52
v_accvgpr_write_b32 a53, v18
v_perm_b32 v19, v227, v225, s53
v_accvgpr_write_b32 a61, v19
s_mov_b32 s64, 0x424000
buffer_load_dwordx2 v[224:225], v20, s[44:47], s64 offen nt
s_mov_b32 s64, 0x426000
buffer_load_dwordx2 v[226:227], v20, s[44:47], s64 offen nt
s_waitcnt vmcnt(56)
v_perm_b32 v16, v222, v220, s52
v_accvgpr_write_b32 a38, v16
v_perm_b32 v17, v222, v220, s53
v_accvgpr_write_b32 a46, v17
v_perm_b32 v18, v223, v221, s52
v_accvgpr_write_b32 a54, v18
v_perm_b32 v19, v223, v221, s53
v_accvgpr_write_b32 a62, v19
s_mov_b32 s64, 0x500000
buffer_load_dwordx2 v[220:221], v20, s[44:47], s64 offen nt
s_mov_b32 s64, 0x502000
buffer_load_dwordx2 v[222:223], v20, s[44:47], s64 offen nt
v_perm_b32 v16, v218, v216, s52
v_accvgpr_write_b32 a39, v16
v_perm_b32 v17, v218, v216, s53
v_accvgpr_write_b32 a47, v17
v_perm_b32 v18, v219, v217, s52
v_accvgpr_write_b32 a55, v18
v_perm_b32 v19, v219, v217, s53
v_accvgpr_write_b32 a63, v19
s_mov_b32 s64, 0x520000
buffer_load_dwordx2 v[216:217], v20, s[44:47], s64 offen nt
s_mov_b32 s64, 0x522000
buffer_load_dwordx2 v[218:219], v20, s[44:47], s64 offen nt
s_waitcnt vmcnt(56)
v_perm_b32 v16, v214, v212, s52
v_accvgpr_write_b32 a136, v16
v_perm_b32 v17, v214, v212, s53
v_accvgpr_write_b32 a144, v17
v_perm_b32 v18, v215, v213, s52
v_accvgpr_write_b32 a152, v18
v_perm_b32 v24, v215, v213, s53
s_mov_b32 s64, 0x504000
buffer_load_dwordx2 v[212:213], v20, s[44:47], s64 offen nt
s_mov_b32 s64, 0x506000
buffer_load_dwordx2 v[214:215], v20, s[44:47], s64 offen nt
v_perm_b32 v19, v210, v208, s52
v_accvgpr_write_b32 a137, v19
v_perm_b32 v16, v210, v208, s53
v_accvgpr_write_b32 a145, v16
v_perm_b32 v17, v211, v209, s52
v_accvgpr_write_b32 a153, v17
v_perm_b32 v25, v211, v209, s53
s_mov_b32 s64, 0x524000
buffer_load_dwordx2 v[208:209], v20, s[44:47], s64 offen nt
s_mov_b32 s64, 0x526000
buffer_load_dwordx2 v[210:211], v20, s[44:47], s64 offen nt
s_waitcnt vmcnt(56)
v_perm_b32 v18, v206, v204, s52
v_accvgpr_write_b32 a138, v18
v_perm_b32 v19, v206, v204, s53
v_accvgpr_write_b32 a146, v19
v_perm_b32 v16, v207, v205, s52
v_accvgpr_write_b32 a154, v16
v_perm_b32 v26, v207, v205, s53
s_mov_b32 s64, 0x440000
buffer_load_dwordx2 v[108:109], v20, s[44:47], s64 offen nt
s_mov_b32 s64, 0x442000
buffer_load_dwordx2 v[110:111], v20, s[44:47], s64 offen nt
v_perm_b32 v17, v202, v200, s52
v_accvgpr_write_b32 a139, v17
v_perm_b32 v18, v202, v200, s53
v_accvgpr_write_b32 a147, v18
v_perm_b32 v19, v203, v201, s52
v_accvgpr_write_b32 a155, v19
v_perm_b32 v27, v203, v201, s53
ds_write_b128 v7, v[24:27] offset:6144
s_mov_b32 s64, 0x460000
buffer_load_dwordx2 v[104:105], v20, s[44:47], s64 offen nt
s_mov_b32 s64, 0x462000
buffer_load_dwordx2 v[106:107], v20, s[44:47], s64 offen nt
s_waitcnt vmcnt(56)
v_perm_b32 v16, v198, v196, s52
v_accvgpr_write_b32 a140, v16
v_perm_b32 v17, v198, v196, s53
v_accvgpr_write_b32 a148, v17
v_perm_b32 v18, v199, v197, s52
v_accvgpr_write_b32 a156, v18
v_perm_b32 v28, v199, v197, s53
s_mov_b32 s64, 0x444000
buffer_load_dwordx2 v[100:101], v20, s[44:47], s64 offen nt
s_mov_b32 s64, 0x446000
buffer_load_dwordx2 v[102:103], v20, s[44:47], s64 offen nt
v_perm_b32 v19, v194, v192, s52
v_accvgpr_write_b32 a141, v19
v_perm_b32 v16, v194, v192, s53
v_accvgpr_write_b32 a149, v16
v_perm_b32 v17, v195, v193, s52
v_accvgpr_write_b32 a157, v17
v_perm_b32 v29, v195, v193, s53
s_mov_b32 s64, 0x464000
buffer_load_dwordx2 v[96:97], v20, s[44:47], s64 offen nt
s_mov_b32 s64, 0x466000
buffer_load_dwordx2 v[98:99], v20, s[44:47], s64 offen nt
s_waitcnt vmcnt(56)
v_perm_b32 v18, v190, v188, s52
v_accvgpr_write_b32 a142, v18
v_perm_b32 v19, v190, v188, s53
v_accvgpr_write_b32 a150, v19
v_perm_b32 v16, v191, v189, s52
v_accvgpr_write_b32 a158, v16
v_perm_b32 v30, v191, v189, s53
s_mov_b32 s64, 0x540000
buffer_load_dwordx2 v[92:93], v20, s[44:47], s64 offen nt
s_mov_b32 s64, 0x542000
buffer_load_dwordx2 v[94:95], v20, s[44:47], s64 offen nt
v_perm_b32 v17, v186, v184, s52
v_accvgpr_write_b32 a143, v17
v_perm_b32 v18, v186, v184, s53
v_accvgpr_write_b32 a151, v18
v_perm_b32 v19, v187, v185, s52
v_accvgpr_write_b32 a159, v19
v_perm_b32 v31, v187, v185, s53
ds_write_b128 v7, v[28:31] offset:7168
s_mov_b32 s64, 0x560000
buffer_load_dwordx2 v[88:89], v20, s[44:47], s64 offen nt
s_mov_b32 s64, 0x562000
buffer_load_dwordx2 v[90:91], v20, s[44:47], s64 offen nt
s_waitcnt vmcnt(56)
v_perm_b32 v16, v134, v132, s52
v_accvgpr_write_b32 a232, v16
v_perm_b32 v17, v134, v132, s53
v_accvgpr_write_b32 a240, v17
v_perm_b32 v18, v135, v133, s52
v_accvgpr_write_b32 a248, v18
v_perm_b32 v24, v135, v133, s53
s_mov_b32 s64, 0x544000
buffer_load_dwordx2 v[132:133], v20, s[44:47], s64 offen nt
s_mov_b32 s64, 0x546000
buffer_load_dwordx2 v[134:135], v20, s[44:47], s64 offen nt
v_perm_b32 v19, v130, v128, s52
v_accvgpr_write_b32 a233, v19
v_perm_b32 v16, v130, v128, s53
v_accvgpr_write_b32 a241, v16
v_perm_b32 v17, v131, v129, s52
v_accvgpr_write_b32 a249, v17
v_perm_b32 v25, v131, v129, s53
s_mov_b32 s64, 0x564000
buffer_load_dwordx2 v[128:129], v20, s[44:47], s64 offen nt
s_mov_b32 s64, 0x566000
buffer_load_dwordx2 v[130:131], v20, s[44:47], s64 offen nt
s_waitcnt vmcnt(56)
v_perm_b32 v18, v126, v124, s52
v_accvgpr_write_b32 a234, v18
v_perm_b32 v19, v126, v124, s53
v_accvgpr_write_b32 a242, v19
v_perm_b32 v16, v127, v125, s52
v_accvgpr_write_b32 a250, v16
v_perm_b32 v26, v127, v125, s53
s_mov_b32 s64, 0x410000
buffer_load_dwordx2 v[124:125], v20, s[44:47], s64 offen nt
s_mov_b32 s64, 0x412000
buffer_load_dwordx2 v[126:127], v20, s[44:47], s64 offen nt
v_perm_b32 v17, v122, v120, s52
v_accvgpr_write_b32 a235, v17
v_perm_b32 v18, v122, v120, s53
v_accvgpr_write_b32 a243, v18
v_perm_b32 v19, v123, v121, s52
v_accvgpr_write_b32 a251, v19
v_perm_b32 v27, v123, v121, s53
ds_write_b128 v7, v[24:27] offset:14336
s_mov_b32 s64, 0x430000
buffer_load_dwordx2 v[84:85], v20, s[44:47], s64 offen nt
s_mov_b32 s64, 0x432000
buffer_load_dwordx2 v[86:87], v20, s[44:47], s64 offen nt
s_waitcnt vmcnt(56)
v_perm_b32 v16, v118, v116, s52
v_accvgpr_write_b32 a236, v16
v_perm_b32 v17, v118, v116, s53
v_accvgpr_write_b32 a244, v17
v_perm_b32 v18, v119, v117, s52
v_accvgpr_write_b32 a252, v18
v_perm_b32 v28, v119, v117, s53
s_mov_b32 s64, 0x414000
buffer_load_dwordx2 v[116:117], v20, s[44:47], s64 offen nt
s_mov_b32 s64, 0x416000
buffer_load_dwordx2 v[118:119], v20, s[44:47], s64 offen nt
v_perm_b32 v19, v114, v112, s52
v_accvgpr_write_b32 a237, v19
v_perm_b32 v16, v114, v112, s53
v_accvgpr_write_b32 a245, v16
v_perm_b32 v17, v115, v113, s52
v_accvgpr_write_b32 a253, v17
v_perm_b32 v29, v115, v113, s53
s_mov_b32 s64, 0x434000
buffer_load_dwordx2 v[80:81], v20, s[44:47], s64 offen nt
s_mov_b32 s64, 0x436000
buffer_load_dwordx2 v[82:83], v20, s[44:47], s64 offen nt
s_waitcnt vmcnt(56)
v_perm_b32 v18, v158, v156, s52
v_accvgpr_write_b32 a238, v18
v_perm_b32 v19, v158, v156, s53
v_accvgpr_write_b32 a246, v19
v_perm_b32 v16, v159, v157, s52
v_accvgpr_write_b32 a254, v16
v_perm_b32 v30, v159, v157, s53
s_mov_b32 s64, 0x510000
buffer_load_dwordx2 v[156:157], v20, s[44:47], s64 offen nt
s_mov_b32 s64, 0x512000
buffer_load_dwordx2 v[158:159], v20, s[44:47], s64 offen nt
v_perm_b32 v17, v154, v152, s52
v_accvgpr_write_b32 a239, v17
v_perm_b32 v18, v154, v152, s53
v_accvgpr_write_b32 a247, v18
v_perm_b32 v19, v155, v153, s52
v_accvgpr_write_b32 a255, v19
v_perm_b32 v31, v155, v153, s53
ds_write_b128 v7, v[28:31] offset:15360
s_mov_b32 s64, 0x530000
buffer_load_dwordx2 v[152:153], v20, s[44:47], s64 offen nt
s_mov_b32 s64, 0x532000
buffer_load_dwordx2 v[154:155], v20, s[44:47], s64 offen nt
s_waitcnt vmcnt(56)
v_perm_b32 v184, v150, v148, s52
v_perm_b32 v192, v150, v148, s53
v_perm_b32 v200, v151, v149, s52
v_perm_b32 v24, v151, v149, s53
s_mov_b32 s64, 0x514000
buffer_load_dwordx2 v[148:149], v20, s[44:47], s64 offen nt
s_mov_b32 s64, 0x516000
buffer_load_dwordx2 v[150:151], v20, s[44:47], s64 offen nt
v_perm_b32 v185, v146, v144, s52
v_perm_b32 v193, v146, v144, s53
v_perm_b32 v201, v147, v145, s52
v_perm_b32 v25, v147, v145, s53
s_mov_b32 s64, 0x534000
buffer_load_dwordx2 v[144:145], v20, s[44:47], s64 offen nt
s_mov_b32 s64, 0x536000
buffer_load_dwordx2 v[146:147], v20, s[44:47], s64 offen nt
s_waitcnt vmcnt(56)
v_perm_b32 v186, v142, v140, s52
v_perm_b32 v194, v142, v140, s53
v_perm_b32 v202, v143, v141, s52
v_perm_b32 v26, v143, v141, s53
s_mov_b32 s64, 0x450000
buffer_load_dwordx2 v[140:141], v20, s[44:47], s64 offen nt
s_mov_b32 s64, 0x452000
buffer_load_dwordx2 v[142:143], v20, s[44:47], s64 offen nt
v_perm_b32 v187, v138, v136, s52
v_perm_b32 v195, v138, v136, s53
v_perm_b32 v203, v139, v137, s52
v_perm_b32 v27, v139, v137, s53
ds_write_b128 v7, v[24:27] offset:22528
s_mov_b32 s64, 0x470000
buffer_load_dwordx2 v[136:137], v20, s[44:47], s64 offen nt
s_mov_b32 s64, 0x472000
buffer_load_dwordx2 v[138:139], v20, s[44:47], s64 offen nt
s_waitcnt vmcnt(56)
v_perm_b32 v188, v254, v252, s52
v_perm_b32 v196, v254, v252, s53
v_perm_b32 v204, v255, v253, s52
v_perm_b32 v28, v255, v253, s53
s_mov_b32 s64, 0x454000
buffer_load_dwordx2 v[252:253], v20, s[44:47], s64 offen nt
s_mov_b32 s64, 0x456000
buffer_load_dwordx2 v[254:255], v20, s[44:47], s64 offen nt
v_perm_b32 v189, v250, v248, s52
v_perm_b32 v197, v250, v248, s53
v_perm_b32 v205, v251, v249, s52
v_perm_b32 v29, v251, v249, s53
s_mov_b32 s64, 0x474000
buffer_load_dwordx2 v[248:249], v20, s[44:47], s64 offen nt
s_mov_b32 s64, 0x476000
buffer_load_dwordx2 v[250:251], v20, s[44:47], s64 offen nt
s_waitcnt vmcnt(56)
v_perm_b32 v190, v246, v244, s52
v_perm_b32 v198, v246, v244, s53
v_perm_b32 v206, v247, v245, s52
v_perm_b32 v30, v247, v245, s53
s_mov_b32 s64, 0x550000
buffer_load_dwordx2 v[244:245], v20, s[44:47], s64 offen nt
s_mov_b32 s64, 0x552000
buffer_load_dwordx2 v[246:247], v20, s[44:47], s64 offen nt
v_perm_b32 v191, v242, v240, s52
v_perm_b32 v199, v242, v240, s53
v_perm_b32 v207, v243, v241, s52
v_perm_b32 v31, v243, v241, s53
ds_write_b128 v7, v[28:31] offset:23552
s_mov_b32 s64, 0x570000
buffer_load_dwordx2 v[240:241], v20, s[44:47], s64 offen nt
s_mov_b32 s64, 0x572000
buffer_load_dwordx2 v[242:243], v20, s[44:47], s64 offen nt
s_waitcnt vmcnt(56)
v_perm_b32 v16, v238, v236, s52
v_accvgpr_write_b32 a64, v16
v_perm_b32 v17, v238, v236, s53
v_accvgpr_write_b32 a72, v17
v_perm_b32 v18, v239, v237, s52
v_accvgpr_write_b32 a80, v18
v_perm_b32 v24, v239, v237, s53
s_mov_b32 s64, 0x554000
buffer_load_dwordx2 v[236:237], v20, s[44:47], s64 offen nt
s_mov_b32 s64, 0x556000
buffer_load_dwordx2 v[238:239], v20, s[44:47], s64 offen nt
v_perm_b32 v19, v234, v232, s52
v_accvgpr_write_b32 a65, v19
v_perm_b32 v16, v234, v232, s53
v_accvgpr_write_b32 a73, v16
v_perm_b32 v17, v235, v233, s52
v_accvgpr_write_b32 a81, v17
v_perm_b32 v25, v235, v233, s53
s_mov_b32 s64, 0x574000
buffer_load_dwordx2 v[232:233], v20, s[44:47], s64 offen nt
s_mov_b32 s64, 0x576000
buffer_load_dwordx2 v[234:235], v20, s[44:47], s64 offen nt
s_waitcnt vmcnt(56)
v_perm_b32 v18, v230, v228, s52
v_accvgpr_write_b32 a66, v18
v_perm_b32 v19, v230, v228, s53
v_accvgpr_write_b32 a74, v19
v_perm_b32 v16, v231, v229, s52
v_accvgpr_write_b32 a82, v16
v_perm_b32 v26, v231, v229, s53
s_mov_b32 s64, 0x600000
buffer_load_dwordx2 v[76:77], v20, s[44:47], s64 offen nt
s_mov_b32 s64, 0x602000
buffer_load_dwordx2 v[78:79], v20, s[44:47], s64 offen nt
v_perm_b32 v17, v226, v224, s52
v_accvgpr_write_b32 a67, v17
v_perm_b32 v18, v226, v224, s53
v_accvgpr_write_b32 a75, v18
v_perm_b32 v19, v227, v225, s52
v_accvgpr_write_b32 a83, v19
v_perm_b32 v27, v227, v225, s53
ds_write_b128 v7, v[24:27] offset:0
s_mov_b32 s64, 0x620000
buffer_load_dwordx2 v[72:73], v20, s[44:47], s64 offen nt
s_mov_b32 s64, 0x622000
buffer_load_dwordx2 v[74:75], v20, s[44:47], s64 offen nt
s_waitcnt vmcnt(56)
v_perm_b32 v16, v222, v220, s52
v_accvgpr_write_b32 a68, v16
v_perm_b32 v17, v222, v220, s53
v_accvgpr_write_b32 a76, v17
v_perm_b32 v18, v223, v221, s52
v_accvgpr_write_b32 a84, v18
v_perm_b32 v28, v223, v221, s53
s_mov_b32 s64, 0x604000
buffer_load_dwordx2 v[68:69], v20, s[44:47], s64 offen nt
s_mov_b32 s64, 0x606000
buffer_load_dwordx2 v[70:71], v20, s[44:47], s64 offen nt
v_perm_b32 v19, v218, v216, s52
v_accvgpr_write_b32 a69, v19
v_perm_b32 v16, v218, v216, s53
v_accvgpr_write_b32 a77, v16
v_perm_b32 v17, v219, v217, s52
v_accvgpr_write_b32 a85, v17
v_perm_b32 v29, v219, v217, s53
s_mov_b32 s64, 0x624000
buffer_load_dwordx2 v[64:65], v20, s[44:47], s64 offen nt
s_mov_b32 s64, 0x626000
buffer_load_dwordx2 v[66:67], v20, s[44:47], s64 offen nt
s_waitcnt vmcnt(56)
v_perm_b32 v18, v214, v212, s52
v_accvgpr_write_b32 a70, v18
v_perm_b32 v19, v214, v212, s53
v_accvgpr_write_b32 a78, v19
v_perm_b32 v16, v215, v213, s52
v_accvgpr_write_b32 a86, v16
v_perm_b32 v30, v215, v213, s53
s_mov_b32 s64, 0x700000
buffer_load_dwordx2 v[60:61], v20, s[44:47], s64 offen nt
s_mov_b32 s64, 0x702000
buffer_load_dwordx2 v[62:63], v20, s[44:47], s64 offen nt
v_perm_b32 v17, v210, v208, s52
v_accvgpr_write_b32 a71, v17
v_perm_b32 v18, v210, v208, s53
v_accvgpr_write_b32 a79, v18
v_perm_b32 v19, v211, v209, s52
v_accvgpr_write_b32 a87, v19
v_perm_b32 v31, v211, v209, s53
ds_write_b128 v7, v[28:31] offset:1024
s_mov_b32 s64, 0x720000
buffer_load_dwordx2 v[56:57], v20, s[44:47], s64 offen nt
s_mov_b32 s64, 0x722000
buffer_load_dwordx2 v[58:59], v20, s[44:47], s64 offen nt
s_waitcnt vmcnt(56)
v_perm_b32 v16, v110, v108, s52
v_accvgpr_write_b32 a160, v16
v_perm_b32 v17, v110, v108, s53
v_accvgpr_write_b32 a168, v17
v_perm_b32 v18, v111, v109, s52
v_accvgpr_write_b32 a176, v18
v_perm_b32 v24, v111, v109, s53
s_mov_b32 s64, 0x704000
buffer_load_dwordx2 v[108:109], v20, s[44:47], s64 offen nt
s_mov_b32 s64, 0x706000
buffer_load_dwordx2 v[110:111], v20, s[44:47], s64 offen nt
v_perm_b32 v19, v106, v104, s52
v_accvgpr_write_b32 a161, v19
v_perm_b32 v16, v106, v104, s53
v_accvgpr_write_b32 a169, v16
v_perm_b32 v17, v107, v105, s52
v_accvgpr_write_b32 a177, v17
v_perm_b32 v25, v107, v105, s53
s_mov_b32 s64, 0x724000
buffer_load_dwordx2 v[104:105], v20, s[44:47], s64 offen nt
s_mov_b32 s64, 0x726000
buffer_load_dwordx2 v[106:107], v20, s[44:47], s64 offen nt
s_waitcnt vmcnt(56)
v_perm_b32 v18, v102, v100, s52
v_accvgpr_write_b32 a162, v18
v_perm_b32 v19, v102, v100, s53
v_accvgpr_write_b32 a170, v19
v_perm_b32 v16, v103, v101, s52
v_accvgpr_write_b32 a178, v16
v_perm_b32 v26, v103, v101, s53
s_mov_b32 s64, 0x640000
buffer_load_dwordx2 v[100:101], v20, s[44:47], s64 offen nt
s_mov_b32 s64, 0x642000
buffer_load_dwordx2 v[102:103], v20, s[44:47], s64 offen nt
v_perm_b32 v17, v98, v96, s52
v_accvgpr_write_b32 a163, v17
v_perm_b32 v18, v98, v96, s53
v_accvgpr_write_b32 a171, v18
v_perm_b32 v19, v99, v97, s52
v_accvgpr_write_b32 a179, v19
v_perm_b32 v27, v99, v97, s53
ds_write_b128 v7, v[24:27] offset:8192
s_mov_b32 s64, 0x660000
buffer_load_dwordx2 v[96:97], v20, s[44:47], s64 offen nt
s_mov_b32 s64, 0x662000
buffer_load_dwordx2 v[98:99], v20, s[44:47], s64 offen nt
s_waitcnt vmcnt(56)
v_perm_b32 v16, v94, v92, s52
v_accvgpr_write_b32 a164, v16
v_perm_b32 v17, v94, v92, s53
v_accvgpr_write_b32 a172, v17
v_perm_b32 v18, v95, v93, s52
v_accvgpr_write_b32 a180, v18
v_perm_b32 v28, v95, v93, s53
s_mov_b32 s64, 0x644000
buffer_load_dwordx2 v[92:93], v20, s[44:47], s64 offen nt
s_mov_b32 s64, 0x646000
buffer_load_dwordx2 v[94:95], v20, s[44:47], s64 offen nt
v_perm_b32 v19, v90, v88, s52
v_accvgpr_write_b32 a165, v19
v_perm_b32 v16, v90, v88, s53
v_accvgpr_write_b32 a173, v16
v_perm_b32 v17, v91, v89, s52
v_accvgpr_write_b32 a181, v17
v_perm_b32 v29, v91, v89, s53
s_mov_b32 s64, 0x664000
buffer_load_dwordx2 v[88:89], v20, s[44:47], s64 offen nt
s_mov_b32 s64, 0x666000
buffer_load_dwordx2 v[90:91], v20, s[44:47], s64 offen nt
s_waitcnt vmcnt(56)
v_perm_b32 v18, v134, v132, s52
v_accvgpr_write_b32 a166, v18
v_perm_b32 v19, v134, v132, s53
v_accvgpr_write_b32 a174, v19
v_perm_b32 v16, v135, v133, s52
v_accvgpr_write_b32 a182, v16
v_perm_b32 v30, v135, v133, s53
s_mov_b32 s64, 0x740000
buffer_load_dwordx2 v[52:53], v20, s[44:47], s64 offen nt
s_mov_b32 s64, 0x742000
buffer_load_dwordx2 v[54:55], v20, s[44:47], s64 offen nt
v_perm_b32 v17, v130, v128, s52
v_accvgpr_write_b32 a167, v17
v_perm_b32 v18, v130, v128, s53
v_accvgpr_write_b32 a175, v18
v_perm_b32 v19, v131, v129, s52
v_accvgpr_write_b32 a183, v19
v_perm_b32 v31, v131, v129, s53
ds_write_b128 v7, v[28:31] offset:9216
s_mov_b32 s64, 0x760000
buffer_load_dwordx2 v[48:49], v20, s[44:47], s64 offen nt
s_mov_b32 s64, 0x762000
buffer_load_dwordx2 v[50:51], v20, s[44:47], s64 offen nt
s_waitcnt vmcnt(56)
v_perm_b32 v112, v126, v124, s52
v_perm_b32 v120, v126, v124, s53
v_perm_b32 v128, v127, v125, s52
v_perm_b32 v24, v127, v125, s53
s_mov_b32 s64, 0x744000
buffer_load_dwordx2 v[44:45], v20, s[44:47], s64 offen nt
s_mov_b32 s64, 0x746000
buffer_load_dwordx2 v[46:47], v20, s[44:47], s64 offen nt
v_perm_b32 v113, v86, v84, s52
v_perm_b32 v121, v86, v84, s53
v_perm_b32 v129, v87, v85, s52
v_perm_b32 v25, v87, v85, s53
s_mov_b32 s64, 0x764000
buffer_load_dwordx2 v[84:85], v20, s[44:47], s64 offen nt
s_mov_b32 s64, 0x766000
buffer_load_dwordx2 v[86:87], v20, s[44:47], s64 offen nt
s_waitcnt vmcnt(56)
v_perm_b32 v114, v118, v116, s52
v_perm_b32 v122, v118, v116, s53
v_perm_b32 v130, v119, v117, s52
v_perm_b32 v26, v119, v117, s53
s_mov_b32 s64, 0x610000
buffer_load_dwordx2 v[40:41], v20, s[44:47], s64 offen nt
s_mov_b32 s64, 0x612000
buffer_load_dwordx2 v[42:43], v20, s[44:47], s64 offen nt
v_perm_b32 v115, v82, v80, s52
v_perm_b32 v123, v82, v80, s53
v_perm_b32 v131, v83, v81, s52
v_perm_b32 v27, v83, v81, s53
ds_write_b128 v7, v[24:27] offset:16384
s_mov_b32 s64, 0x630000
buffer_load_dwordx2 v[80:81], v20, s[44:47], s64 offen nt
s_mov_b32 s64, 0x632000
buffer_load_dwordx2 v[82:83], v20, s[44:47], s64 offen nt
s_waitcnt vmcnt(56)
v_perm_b32 v116, v158, v156, s52
v_perm_b32 v124, v158, v156, s53
v_perm_b32 v132, v159, v157, s52
v_perm_b32 v28, v159, v157, s53
s_mov_b32 s64, 0x614000
buffer_load_dwordx2 v[156:157], v20, s[44:47], s64 offen nt
s_mov_b32 s64, 0x616000
buffer_load_dwordx2 v[158:159], v20, s[44:47], s64 offen nt
v_perm_b32 v117, v154, v152, s52
v_perm_b32 v125, v154, v152, s53
v_perm_b32 v133, v155, v153, s52
v_perm_b32 v29, v155, v153, s53
s_mov_b32 s64, 0x634000
buffer_load_dwordx2 v[36:37], v20, s[44:47], s64 offen nt
s_mov_b32 s64, 0x636000
buffer_load_dwordx2 v[38:39], v20, s[44:47], s64 offen nt
s_waitcnt vmcnt(56)
v_perm_b32 v118, v150, v148, s52
v_perm_b32 v126, v150, v148, s53
v_perm_b32 v134, v151, v149, s52
v_perm_b32 v30, v151, v149, s53
s_mov_b32 s64, 0x710000
buffer_load_dwordx2 v[32:33], v20, s[44:47], s64 offen nt
s_mov_b32 s64, 0x712000
buffer_load_dwordx2 v[34:35], v20, s[44:47], s64 offen nt
v_perm_b32 v119, v146, v144, s52
v_perm_b32 v127, v146, v144, s53
v_perm_b32 v135, v147, v145, s52
v_perm_b32 v31, v147, v145, s53
ds_write_b128 v7, v[28:31] offset:17408
s_waitcnt vmcnt(54)
v_perm_b32 v208, v142, v140, s52
v_perm_b32 v216, v142, v140, s53
v_perm_b32 v224, v143, v141, s52
v_perm_b32 v24, v143, v141, s53
v_perm_b32 v209, v138, v136, s52
v_perm_b32 v217, v138, v136, s53
v_perm_b32 v225, v139, v137, s52
v_perm_b32 v25, v139, v137, s53
s_waitcnt vmcnt(50)
v_perm_b32 v210, v254, v252, s52
v_perm_b32 v218, v254, v252, s53
v_perm_b32 v226, v255, v253, s52
v_perm_b32 v26, v255, v253, s53
s_mov_b32 s64, 0x730000
buffer_load_dwordx2 v[252:253], v20, s[44:47], s64 offen nt
s_mov_b32 s64, 0x732000
buffer_load_dwordx2 v[254:255], v20, s[44:47], s64 offen nt
v_perm_b32 v211, v250, v248, s52
v_perm_b32 v219, v250, v248, s53
v_perm_b32 v227, v251, v249, s52
v_perm_b32 v27, v251, v249, s53
ds_write_b128 v7, v[24:27] offset:24576
s_mov_b32 s64, 0x714000
buffer_load_dwordx2 v[248:249], v20, s[44:47], s64 offen nt
s_mov_b32 s64, 0x716000
buffer_load_dwordx2 v[250:251], v20, s[44:47], s64 offen nt
s_waitcnt vmcnt(50)
v_perm_b32 v212, v246, v244, s52
v_perm_b32 v220, v246, v244, s53
v_perm_b32 v228, v247, v245, s52
v_perm_b32 v28, v247, v245, s53
s_mov_b32 s64, 0x734000
buffer_load_dwordx2 v[244:245], v20, s[44:47], s64 offen nt
s_mov_b32 s64, 0x736000
buffer_load_dwordx2 v[246:247], v20, s[44:47], s64 offen nt
v_perm_b32 v213, v242, v240, s52
v_perm_b32 v221, v242, v240, s53
v_perm_b32 v229, v243, v241, s52
v_perm_b32 v29, v243, v241, s53
s_waitcnt vmcnt(48)
v_perm_b32 v214, v238, v236, s52
v_perm_b32 v222, v238, v236, s53
v_perm_b32 v230, v239, v237, s52
v_perm_b32 v30, v239, v237, s53
s_mov_b32 s64, 0x650000
buffer_load_dwordx2 v[236:237], v20, s[44:47], s64 offen nt
s_mov_b32 s64, 0x652000
buffer_load_dwordx2 v[238:239], v20, s[44:47], s64 offen nt
v_perm_b32 v215, v234, v232, s52
v_perm_b32 v223, v234, v232, s53
v_perm_b32 v231, v235, v233, s52
v_perm_b32 v31, v235, v233, s53
ds_write_b128 v7, v[28:31] offset:25600
s_waitcnt vmcnt(46)
v_perm_b32 v16, v78, v76, s52
v_accvgpr_write_b32 a88, v16
v_perm_b32 v17, v78, v76, s53
v_accvgpr_write_b32 a96, v17
v_perm_b32 v18, v79, v77, s52
v_accvgpr_write_b32 a104, v18
v_perm_b32 v24, v79, v77, s53
s_mov_b32 s64, 0x670000
buffer_load_dwordx2 v[76:77], v20, s[44:47], s64 offen nt
s_mov_b32 s64, 0x672000
buffer_load_dwordx2 v[78:79], v20, s[44:47], s64 offen nt
v_perm_b32 v19, v74, v72, s52
v_accvgpr_write_b32 a89, v19
v_perm_b32 v16, v74, v72, s53
v_accvgpr_write_b32 a97, v16
v_perm_b32 v17, v75, v73, s52
v_accvgpr_write_b32 a105, v17
v_perm_b32 v25, v75, v73, s53
s_mov_b32 s64, 0x654000
buffer_load_dwordx2 v[72:73], v20, s[44:47], s64 offen nt
s_mov_b32 s64, 0x656000
buffer_load_dwordx2 v[74:75], v20, s[44:47], s64 offen nt
s_waitcnt vmcnt(46)
v_perm_b32 v18, v70, v68, s52
v_accvgpr_write_b32 a90, v18
v_perm_b32 v19, v70, v68, s53
v_accvgpr_write_b32 a98, v19
v_perm_b32 v16, v71, v69, s52
v_accvgpr_write_b32 a106, v16
v_perm_b32 v26, v71, v69, s53
s_mov_b32 s64, 0x674000
buffer_load_dwordx2 v[68:69], v20, s[44:47], s64 offen nt
s_mov_b32 s64, 0x676000
buffer_load_dwordx2 v[70:71], v20, s[44:47], s64 offen nt
v_perm_b32 v17, v66, v64, s52
v_accvgpr_write_b32 a91, v17
v_perm_b32 v18, v66, v64, s53
v_accvgpr_write_b32 a99, v18
v_perm_b32 v19, v67, v65, s52
v_accvgpr_write_b32 a107, v19
v_perm_b32 v27, v67, v65, s53
ds_write_b128 v7, v[24:27] offset:2048
s_mov_b32 s64, 0x750000
buffer_load_dwordx2 v[64:65], v20, s[44:47], s64 offen nt
s_mov_b32 s64, 0x752000
buffer_load_dwordx2 v[66:67], v20, s[44:47], s64 offen nt
s_waitcnt vmcnt(46)
v_perm_b32 v16, v62, v60, s52
v_accvgpr_write_b32 a92, v16
v_perm_b32 v17, v62, v60, s53
v_accvgpr_write_b32 a100, v17
v_perm_b32 v18, v63, v61, s52
v_accvgpr_write_b32 a108, v18
v_perm_b32 v28, v63, v61, s53
s_mov_b32 s64, 0x770000
buffer_load_dwordx2 v[60:61], v20, s[44:47], s64 offen nt
s_mov_b32 s64, 0x772000
buffer_load_dwordx2 v[62:63], v20, s[44:47], s64 offen nt
v_perm_b32 v19, v58, v56, s52
v_accvgpr_write_b32 a93, v19
v_perm_b32 v16, v58, v56, s53
v_accvgpr_write_b32 a101, v16
v_perm_b32 v17, v59, v57, s52
v_accvgpr_write_b32 a109, v17
v_perm_b32 v29, v59, v57, s53
s_mov_b32 s64, 0x754000
buffer_load_dwordx2 v[56:57], v20, s[44:47], s64 offen nt
s_mov_b32 s64, 0x756000
buffer_load_dwordx2 v[58:59], v20, s[44:47], s64 offen nt
s_waitcnt vmcnt(46)
v_perm_b32 v18, v110, v108, s52
v_accvgpr_write_b32 a94, v18
v_perm_b32 v19, v110, v108, s53
v_accvgpr_write_b32 a102, v19
v_perm_b32 v16, v111, v109, s52
v_accvgpr_write_b32 a110, v16
v_perm_b32 v30, v111, v109, s53
s_mov_b32 s64, 0x774000
buffer_load_dwordx2 v[108:109], v20, s[44:47], s64 offen nt
s_mov_b32 s64, 0x776000
buffer_load_dwordx2 v[110:111], v20, s[44:47], s64 offen nt
v_perm_b32 v17, v106, v104, s52
v_accvgpr_write_b32 a95, v17
v_perm_b32 v18, v106, v104, s53
v_accvgpr_write_b32 a103, v18
v_perm_b32 v19, v107, v105, s52
v_accvgpr_write_b32 a111, v19
v_perm_b32 v31, v107, v105, s53
ds_write_b128 v7, v[28:31] offset:3072
s_waitcnt vmcnt(44)
v_perm_b32 v16, v102, v100, s52
v_accvgpr_write_b32 a184, v16
v_perm_b32 v17, v102, v100, s53
v_accvgpr_write_b32 a192, v17
v_perm_b32 v18, v103, v101, s52
v_accvgpr_write_b32 a200, v18
v_perm_b32 v24, v103, v101, s53
v_perm_b32 v19, v98, v96, s52
v_accvgpr_write_b32 a185, v19
v_perm_b32 v16, v98, v96, s53
v_accvgpr_write_b32 a193, v16
v_perm_b32 v17, v99, v97, s52
v_accvgpr_write_b32 a201, v17
v_perm_b32 v25, v99, v97, s53
s_waitcnt vmcnt(40)
v_perm_b32 v18, v94, v92, s52
v_accvgpr_write_b32 a186, v18
v_perm_b32 v19, v94, v92, s53
v_accvgpr_write_b32 a194, v19
v_perm_b32 v16, v95, v93, s52
v_accvgpr_write_b32 a202, v16
v_perm_b32 v26, v95, v93, s53
v_perm_b32 v17, v90, v88, s52
v_accvgpr_write_b32 a187, v17
v_perm_b32 v18, v90, v88, s53
v_accvgpr_write_b32 a195, v18
v_perm_b32 v19, v91, v89, s52
v_accvgpr_write_b32 a203, v19
v_perm_b32 v27, v91, v89, s53
ds_write_b128 v7, v[24:27] offset:10240
s_waitcnt vmcnt(36)
v_perm_b32 v16, v54, v52, s52
v_accvgpr_write_b32 a188, v16
v_perm_b32 v17, v54, v52, s53
v_accvgpr_write_b32 a196, v17
v_perm_b32 v18, v55, v53, s52
v_accvgpr_write_b32 a204, v18
v_perm_b32 v28, v55, v53, s53
v_perm_b32 v19, v50, v48, s52
v_accvgpr_write_b32 a189, v19
v_perm_b32 v16, v50, v48, s53
v_accvgpr_write_b32 a197, v16
v_perm_b32 v17, v51, v49, s52
v_accvgpr_write_b32 a205, v17
v_perm_b32 v29, v51, v49, s53
s_waitcnt vmcnt(32)
v_perm_b32 v18, v46, v44, s52
v_accvgpr_write_b32 a190, v18
v_perm_b32 v19, v46, v44, s53
v_accvgpr_write_b32 a198, v19
v_perm_b32 v16, v47, v45, s52
v_accvgpr_write_b32 a206, v16
v_perm_b32 v30, v47, v45, s53
v_perm_b32 v17, v86, v84, s52
v_accvgpr_write_b32 a191, v17
v_perm_b32 v18, v86, v84, s53
v_accvgpr_write_b32 a199, v18
v_perm_b32 v19, v87, v85, s52
v_accvgpr_write_b32 a207, v19
v_perm_b32 v31, v87, v85, s53
ds_write_b128 v7, v[28:31] offset:11264
s_waitcnt vmcnt(28)
v_perm_b32 v136, v42, v40, s52
v_perm_b32 v144, v42, v40, s53
v_perm_b32 v152, v43, v41, s52
v_perm_b32 v24, v43, v41, s53
v_perm_b32 v137, v82, v80, s52
v_perm_b32 v145, v82, v80, s53
v_perm_b32 v153, v83, v81, s52
v_perm_b32 v25, v83, v81, s53
s_waitcnt vmcnt(24)
v_perm_b32 v138, v158, v156, s52
v_perm_b32 v146, v158, v156, s53
v_perm_b32 v154, v159, v157, s52
v_perm_b32 v26, v159, v157, s53
v_perm_b32 v139, v38, v36, s52
v_perm_b32 v147, v38, v36, s53
v_perm_b32 v155, v39, v37, s52
v_perm_b32 v27, v39, v37, s53
ds_write_b128 v7, v[24:27] offset:18432
s_waitcnt vmcnt(20)
v_perm_b32 v140, v34, v32, s52
v_perm_b32 v148, v34, v32, s53
v_perm_b32 v156, v35, v33, s52
v_perm_b32 v28, v35, v33, s53
v_perm_b32 v141, v254, v252, s52
v_perm_b32 v149, v254, v252, s53
v_perm_b32 v157, v255, v253, s52
v_perm_b32 v29, v255, v253, s53
s_waitcnt vmcnt(16)
v_perm_b32 v142, v250, v248, s52
v_perm_b32 v150, v250, v248, s53
v_perm_b32 v158, v251, v249, s52
v_perm_b32 v30, v251, v249, s53
v_perm_b32 v143, v246, v244, s52
v_perm_b32 v151, v246, v244, s53
v_perm_b32 v159, v247, v245, s52
v_perm_b32 v31, v247, v245, s53
ds_write_b128 v7, v[28:31] offset:19456
s_waitcnt vmcnt(12)
v_perm_b32 v232, v238, v236, s52
v_perm_b32 v240, v238, v236, s53
v_perm_b32 v248, v239, v237, s52
v_perm_b32 v24, v239, v237, s53
v_perm_b32 v233, v78, v76, s52
v_perm_b32 v241, v78, v76, s53
v_perm_b32 v249, v79, v77, s52
v_perm_b32 v25, v79, v77, s53
s_waitcnt vmcnt(8)
v_perm_b32 v234, v74, v72, s52
v_perm_b32 v242, v74, v72, s53
v_perm_b32 v250, v75, v73, s52
v_perm_b32 v26, v75, v73, s53
v_perm_b32 v235, v70, v68, s52
v_perm_b32 v243, v70, v68, s53
v_perm_b32 v251, v71, v69, s52
v_perm_b32 v27, v71, v69, s53
ds_write_b128 v7, v[24:27] offset:26624
s_waitcnt vmcnt(4)
v_perm_b32 v236, v66, v64, s52
v_perm_b32 v244, v66, v64, s53
v_perm_b32 v252, v67, v65, s52
v_perm_b32 v28, v67, v65, s53
v_perm_b32 v237, v62, v60, s52
v_perm_b32 v245, v62, v60, s53
v_perm_b32 v253, v63, v61, s52
v_perm_b32 v29, v63, v61, s53
s_waitcnt vmcnt(0)
v_perm_b32 v238, v58, v56, s52
v_perm_b32 v246, v58, v56, s53
v_perm_b32 v254, v59, v57, s52
v_perm_b32 v30, v59, v57, s53
v_perm_b32 v239, v110, v108, s52
v_perm_b32 v247, v110, v108, s53
v_perm_b32 v255, v111, v109, s52
v_perm_b32 v31, v111, v109, s53
ds_write_b128 v7, v[28:31] offset:27648
s_waitcnt lgkmcnt(0)
s_cmp_lg_u32 s62, 0
s_cbranch_scc1 L_cd_7
v_mbcnt_lo_u32_b32 v17, -1, 0
v_mbcnt_hi_u32_b32 v17, -1, v17
v_lshlrev_b32 v17, 2, v17
L_ct_8:
buffer_load_dword v18, v17, s[40:43], 0 offen sc1
s_mov_b32 s64, 0x10001000
s_mov_b32 s65, 0x10001000
s_waitcnt vmcnt(0)
v_cmp_ne_u32 vcc, 64, v18
s_nop 0
s_and_b64 s[64:65], s[64:65], vcc
s_cbranch_scc0 L_co_9
s_sleep 12
s_add_u32 s63, s63, 1
s_cmp_lt_u32 s63, 0x20000
s_cbranch_scc1 L_ct_8
s_branch L_giveup
L_co_9:
v_cmp_ne_u32 vcc, 32, v18
s_mov_b32 s64, 0x110011
s_mov_b32 s65, 0x110011
s_and_b64 s[64:65], s[64:65], vcc
s_cbranch_scc1 L_recensus
L_sd_10:
v_readlane_b32 s64, v18, 2
s_nop 0
s_cmp_lg_u32 s64, 0
s_cbranch_scc1 L_sk_11
s_sleep 4
buffer_load_dword v18, v17, s[40:43], 0 offen sc1
s_waitcnt vmcnt(0)
s_add_u32 s63, s63, 1
s_cmp_lt_u32 s63, 0x20000
s_cbranch_scc1 L_sd_10
s_branch L_giveup
L_sk_11:
s_cmp_eq_u32 s64, 2
s_cselect_b32 s64, 0x200000, 0
s_add_u32 s64, s64, 0x6000
s_add_u32 s36, s34, s64
s_addc_u32 s37, s35, 0
s_and_b32 s37, s37, 0xffff
L_cd_7:
s_lshl_b32 s84, s80, 15
s_xor_b32 s85, s84, 0x8000
s_add_u32 s84, s84, 0x3e000
s_add_u32 s85, s85, 0x3c000
s_mov_b32 s59, 0
s_mov_b32 s96, 1
s_mov_b32 s97, 1
L_fq0_12:
buffer_load_dword v79, v1, s[36:39], 0 offen sc1
s_waitcnt vmcnt(0)
v_cmp_gt_u32 vcc, s96, v79
s_cbranch_vccz L_fq0_ok_13
s_add_u32 s63, s63, 1
s_cmp_lt_u32 s63, 0x20000
s_cbranch_scc1 L_fq0_12
s_branch L_giveup
L_fq0_ok_13:
s_add_u32 m0, s90, 0
s_add_u32 s65, s88, 0
buffer_load_dwordx4 v5, s[36:39], s65 offen offset:0 sc1 lds
buffer_load_dwordx4 v5, s[36:39], s65 offen offset:1024 sc1 lds
s_add_u32 m0, s90, 8192
s_add_u32 s65, s88, 16384
buffer_load_dwordx4 v5, s[36:39], s65 offen offset:0 sc1 lds
buffer_load_dwordx4 v5, s[36:39], s65 offen offset:1024 sc1 lds
s_add_u32 m0, s90, 16384
s_add_u32 s65, s88, 32768
buffer_load_dwordx4 v5, s[36:39], s65 offen offset:0 sc1 lds
buffer_load_dwordx4 v5, s[36:39], s65 offen offset:1024 sc1 lds
s_add_u32 s88, s88, 0x200000
s_xor_b32 s88, s88, 0x2000
L_qk_top:
s_and_b32 s65, s59, 3
s_lshr_b32 s64, s65, 1
s_add_u32 s64, s64, s65
s_lshl_b32 s64, s64, 16
s_add_u32 s91, s84, s64
s_add_u32 s92, s85, s64
s_mul_i32 s64, s65, 0x10000
s_add_u32 s93, s86, s64
s_add_u32 s94, s87, s64
s_xor_b32 s65, s65, 2
s_mul_i32 s64, s65, 0x10000
s_add_u32 s95, s86, s64
s_add_u32 s96, s59, 2
s_min_u32 s96, s96, 64
v_mov_b32 v64, -1
v_mov_b32 v65, -1
v_mov_b32 v66, -1
v_mov_b32 v67, -1
s_cmp_lg_u32 s58, 0
s_cbranch_scc1 L_sl_14
buffer_store_dwordx4 v[64:67], v11, s[36:39], s95 offen
L_sd_15:
v_lshrrev_b32 v110, 1, v5
v_add_u32 v110, 161024, v110
ds_read_b64 v[108:109], v110
buffer_load_dwordx4 v[92:95], v2, s[36:39], s91 offen offset:0 sc1
buffer_load_dwordx4 v[96:99], v2, s[36:39], s91 offen offset:512 sc1
v_mov_b32 v64, 0
v_mov_b32 v65, 0
v_mov_b32 v66, 0
v_mov_b32 v67, 0
v_mov_b32 v68, 0
v_mov_b32 v69, 0
v_mov_b32 v70, 0
v_mov_b32 v71, 0
v_mov_b32 v72, 0
v_mov_b32 v73, 0
v_mov_b32 v74, 0
v_mov_b32 v75, 0
v_mov_b32 v76, 0
v_mov_b32 v77, 0
v_mov_b32 v78, 0
v_mov_b32 v79, 0
L_pl_16:
buffer_load_dwordx4 v[100:103], v2, s[36:39], s91 offen offset:128 sc1
buffer_load_dwordx4 v[104:107], v2, s[36:39], s91 offen offset:640 sc1
s_waitcnt vmcnt(2)
v_max3_u32 v110, v92, v93, v94
v_max3_u32 v110, v110, v95, v96
v_max3_u32 v110, v110, v97, v98
v_max_u32 v110, v110, v99
v_cmp_eq_u32 vcc, -1, v110
s_cbranch_vccz L_plg_17
buffer_load_dwordx4 v[92:95], v2, s[36:39], s91 offen offset:0 sc1
buffer_load_dwordx4 v[96:99], v2, s[36:39], s91 offen offset:512 sc1
s_waitcnt vmcnt(2)
v_max3_u32 v110, v100, v101, v102
v_max3_u32 v110, v110, v103, v104
v_max3_u32 v110, v110, v105, v106
v_max_u32 v110, v110, v107
v_cmp_eq_u32 vcc, -1, v110
s_cbranch_vccz L_plg_17
s_add_u32 s63, s63, 1
s_cmp_lt_u32 s63, 0x20000
s_cbranch_scc1 L_pl_16
s_branch L_giveup
L_plg_17:
buffer_load_dwordx4 v[48:51], v2, s[36:39], s92 offen offset:0 sc1
buffer_load_dwordx4 v[52:55], v2, s[36:39], s92 offen offset:512 sc1
buffer_load_dwordx4 v[56:59], v2, s[36:39], s92 offen offset:128 sc1
buffer_load_dwordx4 v[60:63], v2, s[36:39], s92 offen offset:640 sc1
s_waitcnt vmcnt(4)
v_max3_u32 v110, v92, v93, v94
v_max3_u32 v110, v110, v95, v96
v_max3_u32 v110, v110, v97, v98
v_max3_u32 v110, v110, v99, v100
v_max3_u32 v110, v110, v101, v102
v_max3_u32 v110, v110, v103, v104
v_max3_u32 v110, v110, v105, v106
v_max_u32 v110, v110, v107
v_cmp_eq_u32 vcc, -1, v110
s_cbranch_vccnz L_lm_19
L_lb_18:
s_waitcnt lgkmcnt(0)
v_mfma_f32_4x4x4_16b_bf16 v[16:19], v[108:109], v[92:93], 0
v_mfma_f32_4x4x4_16b_bf16 v[20:23], v[108:109], v[94:95], 0
v_mfma_f32_4x4x4_16b_bf16 v[24:27], v[108:109], v[96:97], 0
v_mfma_f32_4x4x4_16b_bf16 v[28:31], v[108:109], v[98:99], 0
v_mfma_f32_4x4x4_16b_bf16 v[32:35], v[108:109], v[100:101], 0
v_mfma_f32_4x4x4_16b_bf16 v[36:39], v[108:109], v[102:103], 0
v_mfma_f32_4x4x4_16b_bf16 v[40:43], v[108:109], v[104:105], 0
v_mfma_f32_4x4x4_16b_bf16 v[44:47], v[108:109], v[106:107], 0
v_xor_b32 v111, 2048, v12
ds_read_b128 v[92:95], v7 offset:0
ds_read_b128 v[96:99], v7 offset:1024
L_rc_20:
s_waitcnt vmcnt(3)
v_max3_u32 v110, v48, v49, v50
v_max_u32 v110, v110, v51
v_cmp_eq_u32 vcc, -1, v110
v_mfma_f32_4x4x4_16b_bf16 v[100:103], v[108:109], v[48:49], v[16:19]
v_mfma_f32_4x4x4_16b_bf16 v[104:107], v[108:109], v[50:51], v[20:23]
s_cbranch_vccnz L_ra_21
s_waitcnt vmcnt(2)
v_max3_u32 v110, v52, v53, v54
v_max_u32 v110, v110, v55
v_cmp_eq_u32 vcc, -1, v110
v_cvt_pk_bf16_f32 v48, v100, v101
v_cvt_pk_bf16_f32 v49, v102, v103
v_cvt_pk_bf16_f32 v50, v104, v105
v_cvt_pk_bf16_f32 v51, v106, v107
ds_write_b128 v4, v[48:51] offset:0
s_cbranch_vccnz L_gm_23
L_gb_22:
v_mfma_f32_4x4x4_16b_bf16 v[24:27], v[108:109], v[52:53], v[24:27]
v_mfma_f32_4x4x4_16b_bf16 v[28:31], v[108:109], v[54:55], v[28:31]
buffer_store_dwordx4 v[80:83], v12, s[36:39], s89 offen sc1
buffer_store_dwordx4 v[84:87], v111, s[36:39], s89 offen sc1
ds_read_b128 v[100:103], v7 offset:2048
ds_read_b128 v[104:107], v7 offset:3072
s_waitcnt lgkmcnt(2)
s_barrier
ds_read_b128 v[80:83], v5 offset:0
ds_read_b128 v[84:87], v5 offset:4096
ds_read_b128 v[88:91], v5 offset:8192
v_cvt_pk_bf16_f32 v52, v24, v25
v_cvt_pk_bf16_f32 v53, v26, v27
v_cvt_pk_bf16_f32 v54, v28, v29
v_cvt_pk_bf16_f32 v55, v30, v31
ds_write_b128 v4, v[52:55] offset:1024
s_waitcnt lgkmcnt(3)
v_smfmac_f32_16x16x64_bf16 v[64:67], v[80:83], a[0:7], v3
s_waitcnt vmcnt(2)
v_max3_u32 v110, v56, v57, v58
v_smfmac_f32_16x16x64_bf16 v[68:71], v[80:83], a[8:15], v3
v_max3_u32 v110, v110, v59, v60
v_smfmac_f32_16x16x64_bf16 v[72:75], v[80:83], a[16:23], v3
v_max3_u32 v110, v110, v61, v62
v_smfmac_f32_16x16x64_bf16 v[76:79], v[80:83], a[24:31], v3
ds_read_b128 v[80:83], v5 offset:12288
s_waitcnt lgkmcnt(3)
v_smfmac_f32_16x16x64_bf16 v[64:67], v[84:87], a[32:39], v3
v_max_u32 v110, v110, v63
v_cmp_eq_u32 vcc, -1, v110
v_smfmac_f32_16x16x64_bf16 v[68:71], v[84:87], a[40:47], v3
v_smfmac_f32_16x16x64_bf16 v[72:75], v[84:87], a[48:55], v3
s_cbranch_vccnz L_gm_25
L_gb_24:
v_mfma_f32_4x4x4_16b_bf16 v[32:35], v[108:109], v[56:57], v[32:35]
v_mfma_f32_4x4x4_16b_bf16 v[36:39], v[108:109], v[58:59], v[36:39]
v_mfma_f32_4x4x4_16b_bf16 v[40:43], v[108:109], v[60:61], v[40:43]
v_mfma_f32_4x4x4_16b_bf16 v[44:47], v[108:109], v[62:63], v[44:47]
v_smfmac_f32_16x16x64_bf16 v[76:79], v[84:87], a[56:63], v3
s_waitcnt lgkmcnt(1)
s_barrier
ds_read_b128 v[84:87], v5 offset:1024
v_smfmac_f32_16x16x64_bf16 v[64:67], v[88:91], a[64:71], v3
v_smfmac_f32_16x16x64_bf16 v[68:71], v[88:91], a[72:79], v3
v_cvt_pk_bf16_f32 v56, v32, v33
v_smfmac_f32_16x16x64_bf16 v[72:75], v[88:91], a[80:87], v3
v_cvt_pk_bf16_f32 v57, v34, v35
v_smfmac_f32_16x16x64_bf16 v[76:79], v[88:91], v[92:99], v3
ds_read_b128 v[88:91], v5 offset:5120
v_cvt_pk_bf16_f32 v58, v36, v37
s_waitcnt lgkmcnt(2)
v_smfmac_f32_16x16x64_bf16 v[64:67], v[80:83], a[88:95], v3
ds_read_b128 v[92:95], v7 offset:4096
v_cvt_pk_bf16_f32 v59, v38, v39
v_smfmac_f32_16x16x64_bf16 v[68:71], v[80:83], a[96:103], v3
ds_read_b128 v[96:99], v7 offset:5120
ds_write_b128 v4, v[56:59] offset:2048
v_smfmac_f32_16x16x64_bf16 v[72:75], v[80:83], a[104:111], v3
v_cvt_pk_bf16_f32 v60, v40, v41
v_smfmac_f32_16x16x64_bf16 v[76:79], v[80:83], v[100:107], v3
ds_read_b128 v[80:83], v5 offset:9216
v_cvt_pk_bf16_f32 v61, v42, v43
s_waitcnt lgkmcnt(5)
v_smfmac_f32_16x16x64_bf16 v[64:67], v[84:87], a[112:119], v3
ds_read_b128 v[100:103], v7 offset:6144
v_cvt_pk_bf16_f32 v62, v44, v45
v_smfmac_f32_16x16x64_bf16 v[68:71], v[84:87], a[120:127], v3
ds_read_b128 v[104:107], v7 offset:7168
v_cvt_pk_bf16_f32 v63, v46, v47
v_smfmac_f32_16x16x64_bf16 v[72:75], v[84:87], a[128:135], v3
ds_write_b128 v4, v[60:63] offset:3072
s_waitcnt lgkmcnt(5)
v_smfmac_f32_16x16x64_bf16 v[76:79], v[84:87], v[92:99], v3
ds_read_b128 v[84:87], v5 offset:13312
v_smfmac_f32_16x16x64_bf16 v[64:67], v[88:91], a[136:143], v3
ds_read_b128 v[92:95], v7 offset:8192
v_smfmac_f32_16x16x64_bf16 v[68:71], v[88:91], a[144:151], v3
ds_read_b128 v[96:99], v7 offset:9216
v_smfmac_f32_16x16x64_bf16 v[72:75], v[88:91], a[152:159], v3
ds_read_b128 v[16:19], v5 offset:16384
s_waitcnt lgkmcnt(5)
v_smfmac_f32_16x16x64_bf16 v[76:79], v[88:91], v[100:107], v3
s_waitcnt lgkmcnt(4)
s_barrier
ds_read_b128 v[88:91], v5 offset:2048
v_smfmac_f32_16x16x64_bf16 v[64:67], v[80:83], a[160:167], v3
ds_read_b128 v[100:103], v7 offset:10240
v_smfmac_f32_16x16x64_bf16 v[68:71], v[80:83], a[168:175], v3
ds_read_b128 v[104:107], v7 offset:11264
v_smfmac_f32_16x16x64_bf16 v[72:75], v[80:83], a[176:183], v3
ds_read_b128 v[20:23], v5 offset:17408
s_waitcnt lgkmcnt(5)
v_smfmac_f32_16x16x64_bf16 v[76:79], v[80:83], v[92:99], v3
ds_read_b128 v[80:83], v5 offset:6144
v_smfmac_f32_16x16x64_bf16 v[64:67], v[84:87], a[184:191], v3
ds_read_b128 v[92:95], v7 offset:12288
v_smfmac_f32_16x16x64_bf16 v[68:71], v[84:87], a[192:199], v3
ds_read_b128 v[96:99], v7 offset:13312
v_smfmac_f32_16x16x64_bf16 v[72:75], v[84:87], a[200:207], v3
ds_read_b128 v[24:27], v5 offset:18432
s_waitcnt lgkmcnt(5)
v_smfmac_f32_16x16x64_bf16 v[76:79], v[84:87], v[100:107], v3
ds_read_b128 v[84:87], v5 offset:10240
v_smfmac_f32_16x16x64_bf16 v[64:67], v[88:91], a[208:215], v3
ds_read_b128 v[100:103], v7 offset:14336
v_smfmac_f32_16x16x64_bf16 v[68:71], v[88:91], a[216:223], v3
ds_read_b128 v[104:107], v7 offset:15360
v_smfmac_f32_16x16x64_bf16 v[72:75], v[88:91], a[224:231], v3
ds_read_b128 v[28:31], v5 offset:19456
s_waitcnt lgkmcnt(5)
v_smfmac_f32_16x16x64_bf16 v[76:79], v[88:91], v[92:99], v3
ds_read_b128 v[88:91], v5 offset:14336
v_smfmac_f32_16x16x64_bf16 v[64:67], v[80:83], a[232:239], v3
ds_read_b128 v[92:95], v7 offset:16384
v_smfmac_f32_16x16x64_bf16 v[68:71], v[80:83], a[240:247], v3
ds_read_b128 v[96:99], v7 offset:17408
v_smfmac_f32_16x16x64_bf16 v[72:75], v[80:83], a[248:255], v3
ds_read_b128 v[32:35], v5 offset:20480
s_waitcnt lgkmcnt(5)
v_smfmac_f32_16x16x64_bf16 v[76:79], v[80:83], v[100:107], v3
ds_read_b128 v[80:83], v5 offset:3072
v_smfmac_f32_16x16x64_bf16 v[64:67], v[84:87], v[112:119], v3
ds_read_b128 v[100:103], v7 offset:18432
v_smfmac_f32_16x16x64_bf16 v[68:71], v[84:87], v[120:127], v3
ds_read_b128 v[104:107], v7 offset:19456
v_smfmac_f32_16x16x64_bf16 v[72:75], v[84:87], v[128:135], v3
ds_read_b128 v[36:39], v5 offset:21504
s_waitcnt lgkmcnt(5)
v_smfmac_f32_16x16x64_bf16 v[76:79], v[84:87], v[92:99], v3
ds_read_b128 v[84:87], v5 offset:7168
v_smfmac_f32_16x16x64_bf16 v[64:67], v[88:91], v[136:143], v3
ds_read_b128 v[92:95], v7 offset:20480
v_smfmac_f32_16x16x64_bf16 v[68:71], v[88:91], v[144:151], v3
ds_read_b128 v[96:99], v7 offset:21504
v_smfmac_f32_16x16x64_bf16 v[72:75], v[88:91], v[152:159], v3
ds_read_b128 v[40:43], v5 offset:22528
s_waitcnt lgkmcnt(5)
v_smfmac_f32_16x16x64_bf16 v[76:79], v[88:91], v[100:107], v3
ds_read_b128 v[88:91], v5 offset:11264
v_smfmac_f32_16x16x64_bf16 v[64:67], v[80:83], v[160:167], v3
ds_read_b128 v[100:103], v7 offset:22528
v_smfmac_f32_16x16x64_bf16 v[68:71], v[80:83], v[168:175], v3
ds_read_b128 v[104:107], v7 offset:23552
v_smfmac_f32_16x16x64_bf16 v[72:75], v[80:83], v[176:183], v3
ds_read_b128 v[44:47], v5 offset:23552
ds_read_b128 v[56:59], v13 offset:0
s_waitcnt lgkmcnt(6)
v_smfmac_f32_16x16x64_bf16 v[76:79], v[80:83], v[92:99], v3
ds_read_b128 v[80:83], v5 offset:15360
v_smfmac_f32_16x16x64_bf16 v[64:67], v[84:87], v[184:191], v3
ds_read_b128 v[92:95], v7 offset:24576
v_smfmac_f32_16x16x64_bf16 v[68:71], v[84:87], v[192:199], v3
ds_read_b128 v[96:99], v7 offset:25600
v_smfmac_f32_16x16x64_bf16 v[72:75], v[84:87], v[200:207], v3
ds_read_b128 v[60:63], v13 offset:1024
s_waitcnt lgkmcnt(6)
v_smfmac_f32_16x16x64_bf16 v[76:79], v[84:87], v[100:107], v3
ds_read_b128 v[100:103], v7 offset:26624
v_smfmac_f32_16x16x64_bf16 v[64:67], v[88:91], v[208:215], v3
ds_read_b128 v[104:107], v7 offset:27648
v_smfmac_f32_16x16x64_bf16 v[68:71], v[88:91], v[216:223], v3
v_smfmac_f32_16x16x64_bf16 v[72:75], v[88:91], v[224:231], v3
s_waitcnt lgkmcnt(3)
v_smfmac_f32_16x16x64_bf16 v[76:79], v[88:91], v[92:99], v3
v_smfmac_f32_16x16x64_bf16 v[64:67], v[80:83], v[232:239], v3
v_smfmac_f32_16x16x64_bf16 v[68:71], v[80:83], v[240:247], v3
v_smfmac_f32_16x16x64_bf16 v[72:75], v[80:83], v[248:255], v3
s_waitcnt lgkmcnt(0)
v_smfmac_f32_16x16x64_bf16 v[76:79], v[80:83], v[100:107], v3
s_nop 3
v_permlane32_swap_b32 v64, v66
v_permlane32_swap_b32 v65, v67
v_pk_add_f32 v[64:65], v[64:65], v[66:67]
v_permlane32_swap_b32 v68, v70
v_permlane32_swap_b32 v69, v71
v_pk_add_f32 v[68:69], v[68:69], v[70:71]
v_cvt_pk_bf16_f32 v80, v64, v68
v_cvt_pk_bf16_f32 v82, v65, v69
v_permlane32_swap_b32 v72, v74
v_permlane32_swap_b32 v73, v75
v_pk_add_f32 v[72:73], v[72:73], v[74:75]
v_permlane32_swap_b32 v76, v78
v_permlane32_swap_b32 v77, v79
v_pk_add_f32 v[76:77], v[76:77], v[78:79]
v_cvt_pk_bf16_f32 v81, v72, v76
v_cvt_pk_bf16_f32 v83, v73, v77
ds_write_b64 v8, v[80:81] offset:0
ds_write_b64 v8, v[82:83] offset:288
v_xor_b32 v78, 512, v10
v_mov_b32 v72, v15
v_mov_b32 v73, v15
v_mov_b32 v74, v15
v_mov_b32 v75, v15
s_waitcnt lgkmcnt(0)
s_barrier
s_cmp_eq_u32 s59, 63
s_cbranch_scc1 L_qk_last
ds_read_b128 v[96:99], v9 offset:40960
ds_read_b128 v[100:103], v9 offset:41024
ds_read_b128 v[104:107], v9 offset:41088
ds_read_b128 v[108:111], v9 offset:41152
buffer_load_dwordx4 v[48:51], v10, s[36:39], s94 offen sc1
buffer_load_dwordx4 v[52:55], v78, s[36:39], s94 offen sc1
v_mov_b32 v77, s59
s_waitcnt lgkmcnt(3)
v_mfma_f32_16x16x32_bf16 v[64:67], v[16:19], v[96:99], 0
v_mfma_f32_16x16x32_bf16 v[68:71], v[32:35], v[96:99], 0
s_waitcnt lgkmcnt(2)
v_mfma_f32_16x16x32_bf16 v[64:67], v[20:23], v[100:103], v[64:67]
v_mfma_f32_16x16x32_bf16 v[68:71], v[36:39], v[100:103], v[68:71]
s_waitcnt vmcnt(2)
buffer_store_dword v77, v0, s[36:39], 0 offen sc1
s_waitcnt lgkmcnt(1)
v_mfma_f32_16x16x32_bf16 v[64:67], v[24:27], v[104:107], v[64:67]
v_mfma_f32_16x16x32_bf16 v[68:71], v[40:43], v[104:107], v[68:71]
s_waitcnt lgkmcnt(0)
v_mfma_f32_16x16x32_bf16 v[64:67], v[28:31], v[108:111], v[64:67]
v_mfma_f32_16x16x32_bf16 v[68:71], v[44:47], v[108:111], v[68:71]
v_mfma_f32_16x16x32_bf16 v[72:75], v[96:99], v[96:99], v[72:75]
v_mfma_f32_16x16x32_bf16 v[72:75], v[100:103], v[100:103], v[72:75]
v_mfma_f32_16x16x32_bf16 v[72:75], v[104:107], v[104:107], v[72:75]
v_mfma_f32_16x16x32_bf16 v[72:75], v[108:111], v[108:111], v[72:75]
v_mov_b32 v80, 0x3f803f80
v_mov_b32 v81, 0x3f803f80
v_mov_b32 v82, 0x3f803f80
v_mov_b32 v83, 0x3f803f80
v_max3_f32 v76, v64, v65, v66
v_max3_f32 v77, v68, v69, v70
v_max3_f32 v76, v76, v67, v71
v_max_f32 v76, v76, v77
v_max3_f32 v76, v76, v72, v73
v_max3_f32 v76, v76, v74, v75
s_waitcnt vmcnt(1)
v_mov_b32 v77, v76
v_max3_u32 v79, v48, v49, v50
v_max3_u32 v79, v79, v51, v52
v_permlane16_swap_b32 v76, v77
v_max_f32 v76, v76, v77
v_mov_b32 v77, v76
v_max3_u32 v79, v79, v53, v54
v_max_u32 v79, v79, v55
v_permlane32_swap_b32 v76, v77
v_max_f32 v76, v76, v77
v_mul_f32 v76, s99, v76
v_cmp_eq_u32 vcc, -1, v79
v_fma_f32 v64, v64, s99, -v76
v_fma_f32 v65, v65, s99, -v76
v_exp_f32 v64, v64
v_fma_f32 v66, v66, s99, -v76
v_exp_f32 v65, v65
v_fma_f32 v67, v67, s99, -v76
v_exp_f32 v66, v66
s_cbranch_vccnz L_vm_27
L_vb_26:
v_fma_f32 v68, v68, s99, -v76
v_exp_f32 v67, v67
v_cvt_pk_bf16_f32 v64, v64, v65
v_fma_f32 v69, v69, s99, -v76
v_exp_f32 v68, v68
v_fma_f32 v70, v70, s99, -v76
v_exp_f32 v69, v69
v_cvt_pk_bf16_f32 v65, v66, v67
v_fma_f32 v71, v71, s99, -v76
v_exp_f32 v70, v70
v_fma_f32 v72, v72, s99, -v76
v_exp_f32 v71, v71
v_cvt_pk_bf16_f32 v66, v68, v69
v_fma_f32 v73, v73, s99, -v76
v_cvt_pk_bf16_f32 v67, v70, v71
v_exp_f32 v72, v72
v_fma_f32 v74, v74, s99, -v76
v_mfma_f32_16x16x32_bf16 v[92:95], v[80:83], v[64:67], 0
v_exp_f32 v73, v73
v_fma_f32 v75, v75, s99, -v76
v_mfma_f32_16x16x32_bf16 v[84:87], v[56:59], v[64:67], 0
v_exp_f32 v74, v74
v_exp_f32 v75, v75
v_mfma_f32_16x16x32_bf16 v[88:91], v[60:63], v[64:67], 0
v_cvt_pk_bf16_f32 v68, v72, v73
v_cvt_pk_bf16_f32 v69, v74, v75
s_nop 1
v_mfma_f32_16x16x16_bf16 v[92:95], v[80:81], v[68:69], v[92:95]
v_mfma_f32_16x16x16_bf16 v[84:87], v[48:49], v[68:69], v[84:87]
v_mfma_f32_16x16x16_bf16 v[88:91], v[50:51], v[68:69], v[88:91]
s_cmp_lg_u32 s58, 0
s_nop 4
v_rcp_f32 v76, v92
s_nop 0
v_pk_mul_f32 v[84:85], v[84:85], v[76:77] op_sel_hi:[1,0]
v_cvt_pk_bf16_f32 v64, v84, v85
v_min_u32 v64, s54, v64
v_pk_mul_f32 v[86:87], v[86:87], v[76:77] op_sel_hi:[1,0]
v_cvt_pk_bf16_f32 v65, v86, v87
v_min_u32 v65, s54, v65
v_pk_mul_f32 v[88:89], v[88:89], v[76:77] op_sel_hi:[1,0]
v_cvt_pk_bf16_f32 v66, v88, v89
v_min_u32 v66, s54, v66
v_pk_mul_f32 v[90:91], v[90:91], v[76:77] op_sel_hi:[1,0]
v_cvt_pk_bf16_f32 v67, v90, v91
v_min_u32 v67, s54, v67
s_cbranch_scc1 L_sl_28
buffer_store_dwordx4 v[64:67], v11, s[36:39], s93 offen
L_sd_29:
L_qk_x:
s_cmp_ge_u32 s97, s96
s_cbranch_scc1 L_sn_30
buffer_load_dword v79, v1, s[36:39], 0 offen sc1
L_sn_30:
ds_read_b128 v[80:83], v14 offset:0
ds_read_b128 v[84:87], v14 offset:1024
ds_read_b128 v[88:91], v14 offset:2048
ds_read_b128 v[92:95], v14 offset:3072
v_mov_b32 v76, 0xff800000
v_cmp_gt_i32 vcc, 0, v6
s_nop 1
v_cndmask_b32 v64, 0, v76, vcc
v_cmp_gt_i32 vcc, 1, v6
s_nop 1
v_cndmask_b32 v65, 0, v76, vcc
v_cmp_gt_i32 vcc, 2, v6
s_nop 1
v_cndmask_b32 v66, 0, v76, vcc
v_cmp_gt_i32 vcc, 3, v6
s_nop 1
v_cndmask_b32 v67, 0, v76, vcc
v_cmp_gt_i32 vcc, 16, v6
s_nop 1
v_cndmask_b32 v68, 0, v76, vcc
v_cmp_gt_i32 vcc, 17, v6
s_nop 1
v_cndmask_b32 v69, 0, v76, vcc
v_cmp_gt_i32 vcc, 18, v6
s_nop 1
v_cndmask_b32 v70, 0, v76, vcc
v_cmp_gt_i32 vcc, 19, v6
s_nop 1
v_cndmask_b32 v71, 0, v76, vcc
v_mov_b32 v72, v15
v_mov_b32 v73, v15
v_mov_b32 v74, v15
v_mov_b32 v75, v15
v_xor_b32 v78, 2048, v13
s_waitcnt lgkmcnt(3)
v_mfma_f32_16x16x32_bf16 v[64:67], v[16:19], v[80:83], v[64:67]
v_mfma_f32_16x16x32_bf16 v[68:71], v[32:35], v[80:83], v[68:71]
v_mfma_f32_16x16x32_bf16 v[72:75], v[96:99], v[80:83], v[72:75]
s_waitcnt lgkmcnt(2)
v_mfma_f32_16x16x32_bf16 v[64:67], v[20:23], v[84:87], v[64:67]
v_mfma_f32_16x16x32_bf16 v[68:71], v[36:39], v[84:87], v[68:71]
v_mfma_f32_16x16x32_bf16 v[72:75], v[100:103], v[84:87], v[72:75]
s_waitcnt lgkmcnt(1)
v_mfma_f32_16x16x32_bf16 v[64:67], v[24:27], v[88:91], v[64:67]
v_mfma_f32_16x16x32_bf16 v[68:71], v[40:43], v[88:91], v[68:71]
v_mfma_f32_16x16x32_bf16 v[72:75], v[104:107], v[88:91], v[72:75]
ds_read_b128 v[16:19], v78 offset:0
ds_read_b128 v[20:23], v78 offset:1024
s_waitcnt lgkmcnt(2)
v_mfma_f32_16x16x32_bf16 v[64:67], v[28:31], v[92:95], v[64:67]
v_mfma_f32_16x16x32_bf16 v[68:71], v[44:47], v[92:95], v[68:71]
v_mfma_f32_16x16x32_bf16 v[72:75], v[108:111], v[92:95], v[72:75]
s_waitcnt lgkmcnt(0)
s_barrier
s_cmp_ge_u32 s97, s96
s_cbranch_scc1 L_sn_31
s_waitcnt vmcnt(0)
v_cmp_gt_u32 vcc, s96, v79
s_cbranch_vccz L_fq_ok_33
L_fq_32:
buffer_load_dword v79, v1, s[36:39], 0 offen sc1
s_waitcnt vmcnt(0)
v_cmp_gt_u32 vcc, s96, v79
s_cbranch_vccz L_fq_ok_33
s_add_u32 s63, s63, 1
s_cmp_lt_u32 s63, 0x20000
s_cbranch_scc1 L_fq_32
s_branch L_giveup
L_fq_ok_33:
s_mov_b32 s97, s96
s_add_u32 s64, s96, 1
s_min_u32 s64, s64, 64
v_cmp_gt_u32 vcc, s64, v79
s_nop 0
s_cmp_eq_u64 vcc, 0
s_cselect_b32 s97, s64, s97
s_add_u32 s64, s96, 3
s_min_u32 s64, s64, 64
v_cmp_gt_u32 vcc, s64, v79
s_nop 0
s_cmp_eq_u64 vcc, 0
s_cselect_b32 s97, s64, s97
s_add_u32 s64, s96, 7
s_min_u32 s64, s64, 64
v_cmp_gt_u32 vcc, s64, v79
s_nop 0
s_cmp_eq_u64 vcc, 0
s_cselect_b32 s97, s64, s97
s_add_u32 s64, s96, 15
s_min_u32 s64, s64, 64
v_cmp_gt_u32 vcc, s64, v79
s_nop 0
s_cmp_eq_u64 vcc, 0
s_cselect_b32 s97, s64, s97
L_sn_31:
s_cmp_eq_u32 s59, 63
s_cbranch_scc1 L_nd_34
s_add_u32 m0, s90, 0
s_add_u32 s65, s88, 0
buffer_load_dwordx4 v5, s[36:39], s65 offen offset:0 sc1 lds
buffer_load_dwordx4 v5, s[36:39], s65 offen offset:1024 sc1 lds
s_add_u32 m0, s90, 8192
s_add_u32 s65, s88, 16384
buffer_load_dwordx4 v5, s[36:39], s65 offen offset:0 sc1 lds
buffer_load_dwordx4 v5, s[36:39], s65 offen offset:1024 sc1 lds
s_add_u32 m0, s90, 16384
s_add_u32 s65, s88, 32768
buffer_load_dwordx4 v5, s[36:39], s65 offen offset:0 sc1 lds
buffer_load_dwordx4 v5, s[36:39], s65 offen offset:1024 sc1 lds
s_add_u32 s88, s88, 0x200000
s_xor_b32 s88, s88, 0x2000
L_nd_34:
v_mov_b32 v108, 0x3f803f80
v_mov_b32 v109, 0x3f803f80
v_mov_b32 v110, 0x3f803f80
v_mov_b32 v111, 0x3f803f80
v_max3_f32 v76, v64, v65, v66
v_max3_f32 v77, v68, v69, v70
v_max3_f32 v76, v76, v67, v71
v_max3_f32 v77, v77, v72, v73
v_max3_f32 v76, v76, v74, v75
v_max_f32 v76, v76, v77
v_mov_b32 v77, v76
s_nop 1
v_permlane16_swap_b32 v76, v77
v_max_f32 v76, v76, v77
v_mov_b32 v77, v76
s_nop 1
v_permlane32_swap_b32 v76, v77
v_max_f32 v76, v76, v77
v_mul_f32 v76, s99, v76
v_fma_f32 v64, v64, s99, -v76
v_fma_f32 v65, v65, s99, -v76
v_exp_f32 v64, v64
v_fma_f32 v66, v66, s99, -v76
v_exp_f32 v65, v65
v_fma_f32 v67, v67, s99, -v76
v_exp_f32 v66, v66
v_fma_f32 v68, v68, s99, -v76
v_exp_f32 v67, v67
v_fma_f32 v69, v69, s99, -v76
v_exp_f32 v68, v68
v_fma_f32 v70, v70, s99, -v76
v_exp_f32 v69, v69
v_fma_f32 v71, v71, s99, -v76
v_exp_f32 v70, v70
v_fma_f32 v72, v72, s99, -v76
v_exp_f32 v71, v71
v_fma_f32 v73, v73, s99, -v76
v_exp_f32 v72, v72
v_fma_f32 v74, v74, s99, -v76
v_exp_f32 v73, v73
v_fma_f32 v75, v75, s99, -v76
v_exp_f32 v74, v74
v_exp_f32 v75, v75
v_cvt_pk_bf16_f32 v64, v64, v65
v_cvt_pk_bf16_f32 v65, v66, v67
v_cvt_pk_bf16_f32 v66, v68, v69
v_cvt_pk_bf16_f32 v67, v70, v71
v_cvt_pk_bf16_f32 v68, v72, v73
v_cvt_pk_bf16_f32 v69, v74, v75
v_mfma_f32_16x16x32_bf16 v[104:107], v[108:111], v[64:67], 0
v_mfma_f32_16x16x32_bf16 v[88:91], v[56:59], v[64:67], 0
v_mfma_f32_16x16x32_bf16 v[92:95], v[60:63], v[64:67], 0
v_mfma_f32_16x16x32_bf16 v[96:99], v[16:19], v[64:67], 0
v_mfma_f32_16x16x32_bf16 v[100:103], v[20:23], v[64:67], 0
v_mfma_f32_16x16x16_bf16 v[104:107], v[108:109], v[68:69], v[104:107]
v_mfma_f32_16x16x16_bf16 v[88:91], v[48:49], v[68:69], v[88:91]
v_mfma_f32_16x16x16_bf16 v[92:95], v[50:51], v[68:69], v[92:95]
v_mfma_f32_16x16x16_bf16 v[96:99], v[52:53], v[68:69], v[96:99]
v_mfma_f32_16x16x16_bf16 v[100:103], v[54:55], v[68:69], v[100:103]
s_nop 3
v_rcp_f32 v76, v104
s_nop 0
v_pk_mul_f32 v[88:89], v[88:89], v[76:77] op_sel_hi:[1,0]
v_cvt_pk_bf16_f32 v80, v88, v89
v_pk_mul_f32 v[90:91], v[90:91], v[76:77] op_sel_hi:[1,0]
v_cvt_pk_bf16_f32 v81, v90, v91
v_pk_mul_f32 v[92:93], v[92:93], v[76:77] op_sel_hi:[1,0]
v_cvt_pk_bf16_f32 v82, v92, v93
v_pk_mul_f32 v[94:95], v[94:95], v[76:77] op_sel_hi:[1,0]
v_cvt_pk_bf16_f32 v83, v94, v95
v_pk_mul_f32 v[96:97], v[96:97], v[76:77] op_sel_hi:[1,0]
v_cvt_pk_bf16_f32 v84, v96, v97
v_pk_mul_f32 v[98:99], v[98:99], v[76:77] op_sel_hi:[1,0]
v_cvt_pk_bf16_f32 v85, v98, v99
v_pk_mul_f32 v[100:101], v[100:101], v[76:77] op_sel_hi:[1,0]
v_cvt_pk_bf16_f32 v86, v100, v101
v_pk_mul_f32 v[102:103], v[102:103], v[76:77] op_sel_hi:[1,0]
v_cvt_pk_bf16_f32 v87, v102, v103
L_qk_xe:
s_lshl_b32 s89, s59, 19
s_add_u32 s89, s89, s83
s_lshl_b32 s64, s59, 11
s_and_b32 s64, s64, 0x2000
s_add_u32 s89, s89, s64
s_add_u32 s59, s59, 1
s_cmp_lt_u32 s59, 61
s_cbranch_scc1 L_qk_top
v_xor_b32 v111, 2048, v12
buffer_store_dwordx4 v[80:83], v12, s[36:39], s89 offen sc1
buffer_store_dwordx4 v[84:87], v111, s[36:39], s89 offen sc1
s_waitcnt vmcnt(0)
v_mov_b32 v108, s59
buffer_store_dword v108, v0, s[36:39], 0 offen sc1
s_cmp_lt_u32 s59, 64
s_cbranch_scc1 L_qk_top
s_endpgm
L_qk_last:
ds_read_b128 v[96:99], v9 offset:40960
ds_read_b128 v[100:103], v9 offset:41024
ds_read_b128 v[104:107], v9 offset:41088
ds_read_b128 v[108:111], v9 offset:41152
L_pvl_35:
buffer_load_dwordx4 v[48:51], v10, s[36:39], s94 offen sc1
buffer_load_dwordx4 v[52:55], v78, s[36:39], s94 offen sc1
s_waitcnt vmcnt(0)
v_max3_u32 v76, v48, v49, v50
v_max3_u32 v76, v76, v51, v52
v_max3_u32 v76, v76, v53, v54
v_max_u32 v76, v76, v55
v_cmp_eq_u32 vcc, -1, v76
s_cbranch_vccz L_pvl_ok_36
s_add_u32 s63, s63, 1
s_cmp_lt_u32 s63, 0x20000
s_cbranch_scc1 L_pvl_35
s_branch L_giveup
L_pvl_ok_36:
v_mov_b32 v77, s59
buffer_store_dword v77, v0, s[36:39], 0 offen sc1
s_waitcnt lgkmcnt(0)
s_branch L_qk_x
L_sl_14:
buffer_store_dwordx4 v[64:67], v11, s[36:39], s95 offen sc1
s_branch L_sd_15
L_lm_19:
L_lr_37:
buffer_load_dwordx4 v[92:95], v2, s[36:39], s91 offen offset:0 sc1
buffer_load_dwordx4 v[96:99], v2, s[36:39], s91 offen offset:512 sc1
buffer_load_dwordx4 v[100:103], v2, s[36:39], s91 offen offset:128 sc1
buffer_load_dwordx4 v[104:107], v2, s[36:39], s91 offen offset:640 sc1
s_waitcnt vmcnt(0)
v_max3_u32 v110, v92, v93, v94
v_max3_u32 v110, v110, v95, v96
v_max3_u32 v110, v110, v97, v98
v_max3_u32 v110, v110, v99, v100
v_max3_u32 v110, v110, v101, v102
v_max3_u32 v110, v110, v103, v104
v_max3_u32 v110, v110, v105, v106
v_max_u32 v110, v110, v107
v_cmp_eq_u32 vcc, -1, v110
s_cbranch_vccz L_lr_ok_38
s_add_u32 s63, s63, 1
s_cmp_lt_u32 s63, 0x20000
s_cbranch_scc1 L_lr_37
s_branch L_giveup
L_lr_ok_38:
s_branch L_lb_18
L_ra_21:
buffer_load_dwordx4 v[48:51], v2, s[36:39], s92 offen offset:0 sc1
buffer_load_dwordx4 v[52:55], v2, s[36:39], s92 offen offset:512 sc1
buffer_load_dwordx4 v[56:59], v2, s[36:39], s92 offen offset:128 sc1
buffer_load_dwordx4 v[60:63], v2, s[36:39], s92 offen offset:640 sc1
s_add_u32 s63, s63, 1
s_cmp_lt_u32 s63, 0x20000
s_cbranch_scc1 L_rc_20
s_branch L_giveup
L_gm_23:
L_gr_39:
buffer_load_dwordx4 v[52:55], v2, s[36:39], s92 offen offset:512 sc1
buffer_load_dwordx4 v[56:59], v2, s[36:39], s92 offen offset:128 sc1
buffer_load_dwordx4 v[60:63], v2, s[36:39], s92 offen offset:640 sc1
s_waitcnt vmcnt(0)
v_max3_u32 v110, v52, v53, v54
v_max3_u32 v110, v110, v55, v56
v_max3_u32 v110, v110, v57, v58
v_max3_u32 v110, v110, v59, v60
v_max3_u32 v110, v110, v61, v62
v_max_u32 v110, v110, v63
v_cmp_eq_u32 vcc, -1, v110
s_cbranch_vccz L_gr_ok_40
s_add_u32 s63, s63, 1
s_cmp_lt_u32 s63, 0x20000
s_cbranch_scc1 L_gr_39
s_branch L_giveup
L_gr_ok_40:
s_branch L_gb_22
L_gm_25:
L_gr_41:
buffer_load_dwordx4 v[56:59], v2, s[36:39], s92 offen offset:128 sc1
buffer_load_dwordx4 v[60:63], v2, s[36:39], s92 offen offset:640 sc1
s_waitcnt vmcnt(0)
v_max3_u32 v110, v56, v57, v58
v_max3_u32 v110, v110, v59, v60
v_max3_u32 v110, v110, v61, v62
v_max_u32 v110, v110, v63
v_cmp_eq_u32 vcc, -1, v110
s_cbranch_vccz L_gr_ok_42
s_add_u32 s63, s63, 1
s_cmp_lt_u32 s63, 0x20000
s_cbranch_scc1 L_gr_41
s_branch L_giveup
L_gr_ok_42:
s_branch L_gb_24
L_vm_27:
L_pvm_43:
buffer_load_dwordx4 v[48:51], v10, s[36:39], s94 offen sc1
buffer_load_dwordx4 v[52:55], v78, s[36:39], s94 offen sc1
s_waitcnt vmcnt(0)
v_max3_u32 v79, v48, v49, v50
v_max3_u32 v79, v79, v51, v52
v_max3_u32 v79, v79, v53, v54
v_max_u32 v79, v79, v55
v_cmp_eq_u32 vcc, -1, v79
s_cbranch_vccz L_pvm_ok_44
s_add_u32 s63, s63, 1
s_cmp_lt_u32 s63, 0x20000
s_cbranch_scc1 L_pvm_43
s_branch L_giveup
L_pvm_ok_44:
s_branch L_vb_26
L_sl_28:
buffer_store_dwordx4 v[64:67], v11, s[36:39], s93 offen sc1
s_branch L_sd_29
L_role_vo:
s_lshr_b32 s80, s57, 5
s_and_b32 s81, s57, 15
s_lshl_b32 s82, s80, 4
s_add_u32 s82, s82, s81
s_mov_b32 s98, 0xffff0000
v_and_b32 v1, 63, v0
s_mov_b32 s2, 0x10001
s_mov_b32 s3, 0x10001
s_mov_b32 s44, s16
s_and_b32 s45, s17, 0xffff
s_mov_b32 s46, 0x800000
s_mov_b32 s47, 0x20000
s_mov_b32 s48, s18
s_and_b32 s49, s19, 0xffff
s_mov_b32 s50, 0x800000
s_mov_b32 s51, 0x20000
v_and_b32 v21, 8, v1
v_mov_b32 v3, 0x4444
v_mov_b32 v255, 0xeeee
v_cmp_ne_u32 vcc, 0, v21
s_nop 1
v_cndmask_b32 v3, v3, v255, vcc
v_and_b32 v21, 3, v1
v_and_b32 v23, 15, v1
v_cmp_eq_u32 vcc, 0, v21
s_nop 1
v_cndmask_b32 v24, 0, 1.0, vcc
v_cmp_eq_u32 vcc, 1, v21
s_nop 1
v_cndmask_b32 v25, 0, 1.0, vcc
v_perm_b32 v10, v25, v24, s53
v_cmp_eq_u32 vcc, 2, v21
s_nop 1
v_cndmask_b32 v24, 0, 1.0, vcc
v_cmp_eq_u32 vcc, 3, v21
s_nop 1
v_cndmask_b32 v25, 0, 1.0, vcc
v_perm_b32 v11, v25, v24, s53
v_lshrrev_b32 v21, 4, v1
v_lshlrev_b32 v21, 11, v21
v_bfe_u32 v23, v1, 3, 1
v_lshl_add_u32 v21, v23, 9, v21
v_and_b32 v23, 7, v1
v_lshl_add_u32 v21, v23, 4, v21
v_and_b32 v23, 15, v1
s_lshl_b32 s64, s56, 13
v_add_u32 v7, s64, v21
v_lshrrev_b32 v21, 4, v1
v_lshlrev_b32 v21, 10, v21
v_bfe_u32 v23, v1, 3, 1
v_lshl_add_u32 v21, v23, 8, v21
v_and_b32 v23, 7, v1
v_lshl_add_u32 v21, v23, 4, v21
v_and_b32 v23, 15, v1
s_lshl_b32 s64, s56, 12
v_add_u32 v2, s64, v21
v_lshlrev_b32 v4, 4, v1
v_add_u32 v0, s64, v4
s_and_b32 s64, s64, 0x2000
v_add_u32 v2, s64, v2
v_lshrrev_b32 v21, 4, v1
v_lshrrev_b32 v20, 5, v1
v_lshlrev_b32 v20, 2, v20
v_bfe_u32 v22, v1, 4, 1
v_add_u32 v20, v20, v22
s_lshl_b32 s64, s56, 6
v_add_u32 v20, s64, v20
v_lshlrev_b32 v20, 13, v20
v_lshlrev_b32 v21, 2, v21
v_xor_b32 v21, v21, v23
v_lshl_add_u32 v20, v21, 4, v20
s_lshl_b32 s64, s82, 8
v_add_u32 v20, s64, v20
v_bfe_u32 v21, v1, 4, 1
v_bfe_u32 v22, v1, 2, 1
v_lshl_add_u32 v21, v21, 1, v22
v_and_b32 v22, 3, v1
s_lshl_b32 s64, s56, 2
v_add_u32 v22, s64, v22
v_lshlrev_b32 v96, 2, v21
v_xor_b32 v22, v22, v96
v_lshlrev_b32 v22, 4, v22
v_lshl_add_u32 v22, v21, 8, v22
v_bfe_u32 v21, v1, 3, 1
v_lshl_add_u32 v22, v21, 10, v22
v_lshrrev_b32 v21, 5, v1
v_lshl_add_u32 v96, v21, 12, v22
v_add_u32 v97, 0x10000, v96
v_add_u32 v98, 0x20000, v96
s_lshl_b32 s83, s56, 12
v_lshrrev_b32 v22, 5, v1
v_lshlrev_b32 v22, 7, v22
v_bfe_u32 v21, v1, 4, 1
v_lshl_add_u32 v22, v21, 2, v22
v_lshlrev_b32 v21, 11, v22
v_lshl_add_u32 v21, v23, 3, v21
s_lshl_b32 s64, s80, 22
s_lshl_b32 s65, s56, 20
s_add_u32 s64, s64, s65
s_lshl_b32 s65, s81, 7
s_add_u32 s64, s64, s65
v_add_u32 v21, s64, v21
s_lshl_b32 s64, s56, 15
s_add_u32 s64, s64, 26624
v_add_u32 v5, s64, v4
v_and_b32 v24, 31, v1
v_lshlrev_b32 v24, 4, v24
v_lshrrev_b32 v25, 5, v1
v_lshl_add_u32 v24, v25, 3, v24
s_lshl_b32 s64, s56, 9
v_add_u32 v6, s64, v24
v_bfe_u32 v24, v1, 4, 1
v_lshl_add_u32 v24, v24, 1, v25
v_mul_u32_u24 v24, 576, v24
v_lshl_add_u32 v24, v23, 4, v24
s_mul_i32 s64, s56, 2304
s_add_u32 s64, s64, 16384
v_add_u32 v8, s64, v24
v_bfe_u32 v24, v1, 2, 3
v_mul_u32_u24 v26, 288, v24
v_lshl_add_u32 v26, v25, 5, v26
v_and_b32 v27, 3, v1
v_lshl_add_u32 v26, v27, 3, v26
s_lshl_b32 s64, s56, 6
s_add_u32 s64, s64, 16384
v_add_u32 v9, s64, v26
s_lshl_b32 s64, s81, 10
s_and_b32 s65, s64, 0x2000
s_add_u32 s64, s64, s65
s_lshl_b32 s65, s56, 8
s_add_u32 s64, s64, s65
v_lshlrev_b32 v26, 2, v1
v_add_u32 v13, s64, v26
v_lshlrev_b32 v12, 11, v24
v_lshl_add_u32 v12, v25, 4, v12
v_lshl_add_u32 v12, v27, 2, v12
s_lshl_b32 s64, s81, 7
s_lshl_b32 s65, s56, 5
s_add_u32 s64, s64, s65
v_add_u32 v12, s64, v12
s_lshl_b32 s86, s80, 15
s_add_u32 s86, s86, 0xbc000
s_lshl_b32 s87, s82, 11
s_add_u32 s87, s87, 0xfc000
s_add_u32 m0, s83, 0
s_mov_b32 s64, 0x0
buffer_load_dwordx4 v20, s[44:47], s64 offen nt lds
s_add_u32 m0, s83, 1024
s_mov_b32 s64, 0x20000
buffer_load_dwordx4 v20, s[44:47], s64 offen nt lds
s_add_u32 m0, s83, 2048
s_mov_b32 s64, 0x4000
buffer_load_dwordx4 v20, s[44:47], s64 offen nt lds
s_add_u32 m0, s83, 3072
s_mov_b32 s64, 0x24000
buffer_load_dwordx4 v20, s[44:47], s64 offen nt lds
s_add_u32 m0, s83, 16384
s_mov_b32 s64, 0x40000
buffer_load_dwordx4 v20, s[44:47], s64 offen nt lds
s_add_u32 m0, s83, 17408
s_mov_b32 s64, 0x60000
buffer_load_dwordx4 v20, s[44:47], s64 offen nt lds
s_add_u32 m0, s83, 18432
s_mov_b32 s64, 0x44000
buffer_load_dwordx4 v20, s[44:47], s64 offen nt lds
s_add_u32 m0, s83, 19456
s_mov_b32 s64, 0x64000
buffer_load_dwordx4 v20, s[44:47], s64 offen nt lds
s_add_u32 m0, s83, 32768
s_mov_b32 s64, 0x10000
buffer_load_dwordx4 v20, s[44:47], s64 offen nt lds
s_add_u32 m0, s83, 33792
s_mov_b32 s64, 0x30000
buffer_load_dwordx4 v20, s[44:47], s64 offen nt lds
s_add_u32 m0, s83, 34816
s_mov_b32 s64, 0x14000
buffer_load_dwordx4 v20, s[44:47], s64 offen nt lds
s_add_u32 m0, s83, 35840
s_mov_b32 s64, 0x34000
buffer_load_dwordx4 v20, s[44:47], s64 offen nt lds
s_add_u32 m0, s83, 49152
s_mov_b32 s64, 0x50000
buffer_load_dwordx4 v20, s[44:47], s64 offen nt lds
s_add_u32 m0, s83, 50176
s_mov_b32 s64, 0x70000
buffer_load_dwordx4 v20, s[44:47], s64 offen nt lds
s_add_u32 m0, s83, 51200
s_mov_b32 s64, 0x54000
buffer_load_dwordx4 v20, s[44:47], s64 offen nt lds
s_add_u32 m0, s83, 52224
s_mov_b32 s64, 0x74000
buffer_load_dwordx4 v20, s[44:47], s64 offen nt lds
s_add_u32 m0, s83, 65536
s_mov_b32 s64, 0x200000
buffer_load_dwordx4 v20, s[44:47], s64 offen nt lds
s_add_u32 m0, s83, 66560
s_mov_b32 s64, 0x220000
buffer_load_dwordx4 v20, s[44:47], s64 offen nt lds
s_add_u32 m0, s83, 67584
s_mov_b32 s64, 0x204000
buffer_load_dwordx4 v20, s[44:47], s64 offen nt lds
s_add_u32 m0, s83, 68608
s_mov_b32 s64, 0x224000
buffer_load_dwordx4 v20, s[44:47], s64 offen nt lds
s_add_u32 m0, s83, 81920
s_mov_b32 s64, 0x240000
buffer_load_dwordx4 v20, s[44:47], s64 offen nt lds
s_add_u32 m0, s83, 82944
s_mov_b32 s64, 0x260000
buffer_load_dwordx4 v20, s[44:47], s64 offen nt lds
s_add_u32 m0, s83, 83968
s_mov_b32 s64, 0x244000
buffer_load_dwordx4 v20, s[44:47], s64 offen nt lds
s_add_u32 m0, s83, 84992
s_mov_b32 s64, 0x264000
buffer_load_dwordx4 v20, s[44:47], s64 offen nt lds
s_add_u32 m0, s83, 98304
s_mov_b32 s64, 0x210000
buffer_load_dwordx4 v20, s[44:47], s64 offen nt lds
s_add_u32 m0, s83, 99328
s_mov_b32 s64, 0x230000
buffer_load_dwordx4 v20, s[44:47], s64 offen nt lds
s_add_u32 m0, s83, 100352
s_mov_b32 s64, 0x214000
buffer_load_dwordx4 v20, s[44:47], s64 offen nt lds
s_add_u32 m0, s83, 101376
s_mov_b32 s64, 0x234000
buffer_load_dwordx4 v20, s[44:47], s64 offen nt lds
s_add_u32 m0, s83, 114688
s_mov_b32 s64, 0x250000
buffer_load_dwordx4 v20, s[44:47], s64 offen nt lds
s_add_u32 m0, s83, 115712
s_mov_b32 s64, 0x270000
buffer_load_dwordx4 v20, s[44:47], s64 offen nt lds
s_add_u32 m0, s83, 116736
s_mov_b32 s64, 0x254000
buffer_load_dwordx4 v20, s[44:47], s64 offen nt lds
s_add_u32 m0, s83, 117760
s_mov_b32 s64, 0x274000
buffer_load_dwordx4 v20, s[44:47], s64 offen nt lds
s_add_u32 m0, s83, 131072
s_mov_b32 s64, 0x400000
buffer_load_dwordx4 v20, s[44:47], s64 offen nt lds
s_add_u32 m0, s83, 132096
s_mov_b32 s64, 0x420000
buffer_load_dwordx4 v20, s[44:47], s64 offen nt lds
s_add_u32 m0, s83, 133120
s_mov_b32 s64, 0x404000
buffer_load_dwordx4 v20, s[44:47], s64 offen nt lds
s_add_u32 m0, s83, 134144
s_mov_b32 s64, 0x424000
buffer_load_dwordx4 v20, s[44:47], s64 offen nt lds
s_waitcnt vmcnt(32)
s_barrier
ds_read_b64_tr_b16 a[192:193], v96 offset:0
ds_read_b64_tr_b16 a[194:195], v96 offset:2048
ds_read_b64_tr_b16 a[196:197], v96 offset:8192
ds_read_b64_tr_b16 a[198:199], v96 offset:10240
ds_read_b64_tr_b16 a[200:201], v96 offset:8
ds_read_b64_tr_b16 a[202:203], v96 offset:2056
ds_read_b64_tr_b16 a[204:205], v96 offset:8200
ds_read_b64_tr_b16 a[206:207], v96 offset:10248
s_waitcnt vmcnt(28)
s_waitcnt lgkmcnt(0)
s_barrier
s_add_u32 m0, s83, 0
s_mov_b32 s64, 0x440000
buffer_load_dwordx4 v20, s[44:47], s64 offen nt lds
s_add_u32 m0, s83, 1024
s_mov_b32 s64, 0x460000
buffer_load_dwordx4 v20, s[44:47], s64 offen nt lds
s_add_u32 m0, s83, 2048
s_mov_b32 s64, 0x444000
buffer_load_dwordx4 v20, s[44:47], s64 offen nt lds
s_add_u32 m0, s83, 3072
s_mov_b32 s64, 0x464000
buffer_load_dwordx4 v20, s[44:47], s64 offen nt lds
ds_read_b64_tr_b16 a[240:241], v96 offset:16384
ds_read_b64_tr_b16 a[242:243], v96 offset:18432
ds_read_b64_tr_b16 a[244:245], v96 offset:24576
ds_read_b64_tr_b16 a[246:247], v96 offset:26624
ds_read_b64_tr_b16 a[248:249], v96 offset:16392
ds_read_b64_tr_b16 a[250:251], v96 offset:18440
ds_read_b64_tr_b16 a[252:253], v96 offset:24584
ds_read_b64_tr_b16 a[254:255], v96 offset:26632
s_waitcnt vmcnt(28)
s_waitcnt lgkmcnt(0)
s_barrier
s_add_u32 m0, s83, 16384
s_mov_b32 s64, 0x410000
buffer_load_dwordx4 v20, s[44:47], s64 offen nt lds
s_add_u32 m0, s83, 17408
s_mov_b32 s64, 0x430000
buffer_load_dwordx4 v20, s[44:47], s64 offen nt lds
s_add_u32 m0, s83, 18432
s_mov_b32 s64, 0x414000
buffer_load_dwordx4 v20, s[44:47], s64 offen nt lds
s_add_u32 m0, s83, 19456
s_mov_b32 s64, 0x434000
buffer_load_dwordx4 v20, s[44:47], s64 offen nt lds
ds_read_b64_tr_b16 v[160:161], v96 offset:32768
ds_read_b64_tr_b16 v[162:163], v96 offset:34816
ds_read_b64_tr_b16 v[164:165], v96 offset:40960
ds_read_b64_tr_b16 v[166:167], v96 offset:43008
ds_read_b64_tr_b16 v[168:169], v96 offset:32776
ds_read_b64_tr_b16 v[170:171], v96 offset:34824
ds_read_b64_tr_b16 v[172:173], v96 offset:40968
ds_read_b64_tr_b16 v[174:175], v96 offset:43016
s_waitcnt vmcnt(28)
s_waitcnt lgkmcnt(0)
s_barrier
s_add_u32 m0, s83, 32768
s_mov_b32 s64, 0x450000
buffer_load_dwordx4 v20, s[44:47], s64 offen nt lds
s_add_u32 m0, s83, 33792
s_mov_b32 s64, 0x470000
buffer_load_dwordx4 v20, s[44:47], s64 offen nt lds
s_add_u32 m0, s83, 34816
s_mov_b32 s64, 0x454000
buffer_load_dwordx4 v20, s[44:47], s64 offen nt lds
s_add_u32 m0, s83, 35840
s_mov_b32 s64, 0x474000
buffer_load_dwordx4 v20, s[44:47], s64 offen nt lds
ds_read_b64_tr_b16 v[208:209], v96 offset:49152
ds_read_b64_tr_b16 v[210:211], v96 offset:51200
ds_read_b64_tr_b16 v[212:213], v96 offset:57344
ds_read_b64_tr_b16 v[214:215], v96 offset:59392
ds_read_b64_tr_b16 v[216:217], v96 offset:49160
ds_read_b64_tr_b16 v[218:219], v96 offset:51208
ds_read_b64_tr_b16 v[220:221], v96 offset:57352
ds_read_b64_tr_b16 v[222:223], v96 offset:59400
s_waitcnt vmcnt(28)
s_waitcnt lgkmcnt(0)
s_barrier
s_add_u32 m0, s83, 49152
s_mov_b32 s64, 0x600000
buffer_load_dwordx4 v20, s[44:47], s64 offen nt lds
s_add_u32 m0, s83, 50176
s_mov_b32 s64, 0x620000
buffer_load_dwordx4 v20, s[44:47], s64 offen nt lds
s_add_u32 m0, s83, 51200
s_mov_b32 s64, 0x604000
buffer_load_dwordx4 v20, s[44:47], s64 offen nt lds
s_add_u32 m0, s83, 52224
s_mov_b32 s64, 0x624000
buffer_load_dwordx4 v20, s[44:47], s64 offen nt lds
ds_read_b64_tr_b16 a[208:209], v97 offset:0
ds_read_b64_tr_b16 a[210:211], v97 offset:2048
ds_read_b64_tr_b16 a[212:213], v97 offset:8192
ds_read_b64_tr_b16 a[214:215], v97 offset:10240
ds_read_b64_tr_b16 v[32:33], v97 offset:8
ds_read_b64_tr_b16 v[34:35], v97 offset:2056
ds_read_b64_tr_b16 v[36:37], v97 offset:8200
ds_read_b64_tr_b16 v[38:39], v97 offset:10248
s_waitcnt vmcnt(28)
s_waitcnt lgkmcnt(0)
s_barrier
s_add_u32 m0, s83, 65536
s_mov_b32 s64, 0x640000
buffer_load_dwordx4 v20, s[44:47], s64 offen nt lds
s_add_u32 m0, s83, 66560
s_mov_b32 s64, 0x660000
buffer_load_dwordx4 v20, s[44:47], s64 offen nt lds
s_add_u32 m0, s83, 67584
s_mov_b32 s64, 0x644000
buffer_load_dwordx4 v20, s[44:47], s64 offen nt lds
s_add_u32 m0, s83, 68608
s_mov_b32 s64, 0x664000
buffer_load_dwordx4 v20, s[44:47], s64 offen nt lds
ds_read_b64_tr_b16 v[128:129], v97 offset:16384
ds_read_b64_tr_b16 v[130:131], v97 offset:18432
ds_read_b64_tr_b16 v[132:133], v97 offset:24576
ds_read_b64_tr_b16 v[134:135], v97 offset:26624
ds_read_b64_tr_b16 v[48:49], v97 offset:16392
ds_read_b64_tr_b16 v[50:51], v97 offset:18440
ds_read_b64_tr_b16 v[52:53], v97 offset:24584
ds_read_b64_tr_b16 v[54:55], v97 offset:26632
s_waitcnt vmcnt(28)
s_waitcnt lgkmcnt(0)
s_barrier
s_add_u32 m0, s83, 81920
s_mov_b32 s64, 0x610000
buffer_load_dwordx4 v20, s[44:47], s64 offen nt lds
s_add_u32 m0, s83, 82944
s_mov_b32 s64, 0x630000
buffer_load_dwordx4 v20, s[44:47], s64 offen nt lds
s_add_u32 m0, s83, 83968
s_mov_b32 s64, 0x614000
buffer_load_dwordx4 v20, s[44:47], s64 offen nt lds
s_add_u32 m0, s83, 84992
s_mov_b32 s64, 0x634000
buffer_load_dwordx4 v20, s[44:47], s64 offen nt lds
ds_read_b64_tr_b16 v[176:177], v97 offset:32768
ds_read_b64_tr_b16 v[178:179], v97 offset:34816
ds_read_b64_tr_b16 v[180:181], v97 offset:40960
ds_read_b64_tr_b16 v[182:183], v97 offset:43008
ds_read_b64_tr_b16 v[64:65], v97 offset:32776
ds_read_b64_tr_b16 v[66:67], v97 offset:34824
ds_read_b64_tr_b16 v[68:69], v97 offset:40968
ds_read_b64_tr_b16 v[70:71], v97 offset:43016
s_waitcnt vmcnt(28)
s_waitcnt lgkmcnt(0)
s_barrier
s_add_u32 m0, s83, 98304
s_mov_b32 s64, 0x650000
buffer_load_dwordx4 v20, s[44:47], s64 offen nt lds
s_add_u32 m0, s83, 99328
s_mov_b32 s64, 0x670000
buffer_load_dwordx4 v20, s[44:47], s64 offen nt lds
s_add_u32 m0, s83, 100352
s_mov_b32 s64, 0x654000
buffer_load_dwordx4 v20, s[44:47], s64 offen nt lds
s_add_u32 m0, s83, 101376
s_mov_b32 s64, 0x674000
buffer_load_dwordx4 v20, s[44:47], s64 offen nt lds
ds_read_b64_tr_b16 v[224:225], v97 offset:49152
ds_read_b64_tr_b16 v[226:227], v97 offset:51200
ds_read_b64_tr_b16 v[228:229], v97 offset:57344
ds_read_b64_tr_b16 v[230:231], v97 offset:59392
ds_read_b64_tr_b16 v[80:81], v97 offset:49160
ds_read_b64_tr_b16 v[82:83], v97 offset:51208
ds_read_b64_tr_b16 v[84:85], v97 offset:57352
ds_read_b64_tr_b16 v[86:87], v97 offset:59400
s_waitcnt vmcnt(28)
s_waitcnt lgkmcnt(0)
s_barrier
ds_read_b64_tr_b16 a[216:217], v98 offset:0
ds_read_b64_tr_b16 a[218:219], v98 offset:2048
ds_read_b64_tr_b16 a[220:221], v98 offset:8192
ds_read_b64_tr_b16 a[222:223], v98 offset:10240
ds_read_b64_tr_b16 a[224:225], v98 offset:8
ds_read_b64_tr_b16 a[226:227], v98 offset:2056
ds_read_b64_tr_b16 a[228:229], v98 offset:8200
ds_read_b64_tr_b16 a[230:231], v98 offset:10248
s_waitcnt vmcnt(24)
s_waitcnt lgkmcnt(0)
s_barrier
ds_read_b64_tr_b16 v[136:137], v96 offset:0
ds_read_b64_tr_b16 v[138:139], v96 offset:2048
ds_read_b64_tr_b16 v[140:141], v96 offset:8192
ds_read_b64_tr_b16 v[142:143], v96 offset:10240
ds_read_b64_tr_b16 v[144:145], v96 offset:8
ds_read_b64_tr_b16 v[146:147], v96 offset:2056
ds_read_b64_tr_b16 v[148:149], v96 offset:8200
ds_read_b64_tr_b16 v[150:151], v96 offset:10248
s_waitcnt vmcnt(20)
s_waitcnt lgkmcnt(0)
s_barrier
ds_read_b64_tr_b16 v[184:185], v96 offset:16384
ds_read_b64_tr_b16 v[186:187], v96 offset:18432
ds_read_b64_tr_b16 v[188:189], v96 offset:24576
ds_read_b64_tr_b16 v[190:191], v96 offset:26624
ds_read_b64_tr_b16 v[192:193], v96 offset:16392
ds_read_b64_tr_b16 v[194:195], v96 offset:18440
ds_read_b64_tr_b16 v[196:197], v96 offset:24584
ds_read_b64_tr_b16 v[198:199], v96 offset:26632
s_waitcnt vmcnt(16)
s_waitcnt lgkmcnt(0)
s_barrier
ds_read_b64_tr_b16 v[232:233], v96 offset:32768
ds_read_b64_tr_b16 v[234:235], v96 offset:34816
ds_read_b64_tr_b16 v[236:237], v96 offset:40960
ds_read_b64_tr_b16 v[238:239], v96 offset:43008
ds_read_b64_tr_b16 v[240:241], v96 offset:32776
ds_read_b64_tr_b16 v[242:243], v96 offset:34824
ds_read_b64_tr_b16 v[244:245], v96 offset:40968
ds_read_b64_tr_b16 v[246:247], v96 offset:43016
s_waitcnt vmcnt(12)
s_waitcnt lgkmcnt(0)
s_barrier
ds_read_b64_tr_b16 a[232:233], v96 offset:49152
ds_read_b64_tr_b16 a[234:235], v96 offset:51200
ds_read_b64_tr_b16 a[236:237], v96 offset:57344
ds_read_b64_tr_b16 a[238:239], v96 offset:59392
ds_read_b64_tr_b16 v[40:41], v96 offset:49160
ds_read_b64_tr_b16 v[42:43], v96 offset:51208
ds_read_b64_tr_b16 v[44:45], v96 offset:57352
ds_read_b64_tr_b16 v[46:47], v96 offset:59400
s_waitcnt vmcnt(8)
s_waitcnt lgkmcnt(0)
s_barrier
ds_read_b64_tr_b16 v[152:153], v97 offset:0
ds_read_b64_tr_b16 v[154:155], v97 offset:2048
ds_read_b64_tr_b16 v[156:157], v97 offset:8192
ds_read_b64_tr_b16 v[158:159], v97 offset:10240
ds_read_b64_tr_b16 v[56:57], v97 offset:8
ds_read_b64_tr_b16 v[58:59], v97 offset:2056
ds_read_b64_tr_b16 v[60:61], v97 offset:8200
ds_read_b64_tr_b16 v[62:63], v97 offset:10248
s_waitcnt vmcnt(4)
s_waitcnt lgkmcnt(0)
s_barrier
ds_read_b64_tr_b16 v[200:201], v97 offset:16384
ds_read_b64_tr_b16 v[202:203], v97 offset:18432
ds_read_b64_tr_b16 v[204:205], v97 offset:24576
ds_read_b64_tr_b16 v[206:207], v97 offset:26624
ds_read_b64_tr_b16 v[72:73], v97 offset:16392
ds_read_b64_tr_b16 v[74:75], v97 offset:18440
ds_read_b64_tr_b16 v[76:77], v97 offset:24584
ds_read_b64_tr_b16 v[78:79], v97 offset:26632
s_waitcnt vmcnt(0)
s_waitcnt lgkmcnt(0)
s_barrier
ds_read_b64_tr_b16 v[248:249], v97 offset:32768
ds_read_b64_tr_b16 v[250:251], v97 offset:34816
ds_read_b64_tr_b16 v[252:253], v97 offset:40960
ds_read_b64_tr_b16 v[254:255], v97 offset:43008
ds_read_b64_tr_b16 v[88:89], v97 offset:32776
ds_read_b64_tr_b16 v[90:91], v97 offset:34824
ds_read_b64_tr_b16 v[92:93], v97 offset:40968
ds_read_b64_tr_b16 v[94:95], v97 offset:43016
s_waitcnt lgkmcnt(0)
s_barrier
ds_write_b128 v5, v[32:35] offset:16384
ds_write_b128 v5, v[36:39] offset:17408
ds_write_b128 v5, v[40:43] offset:18432
ds_write_b128 v5, v[44:47] offset:19456
ds_write_b128 v5, v[48:51] offset:20480
ds_write_b128 v5, v[52:55] offset:21504
ds_write_b128 v5, v[56:59] offset:22528
ds_write_b128 v5, v[60:63] offset:23552
ds_write_b128 v5, v[64:67] offset:24576
ds_write_b128 v5, v[68:71] offset:25600
ds_write_b128 v5, v[72:75] offset:26624
ds_write_b128 v5, v[76:79] offset:27648
ds_write_b128 v5, v[80:83] offset:28672
ds_write_b128 v5, v[84:87] offset:29696
ds_write_b128 v5, v[88:91] offset:30720
ds_write_b128 v5, v[92:95] offset:31744
s_waitcnt lgkmcnt(0)
s_mov_b32 s64, 0x0
buffer_load_dwordx2 v[124:125], v21, s[48:51], s64 offen nt
s_mov_b32 s64, 0x800
buffer_load_dwordx2 v[126:127], v21, s[48:51], s64 offen nt
s_mov_b32 s64, 0x10000
buffer_load_dwordx2 v[120:121], v21, s[48:51], s64 offen nt
s_mov_b32 s64, 0x10800
buffer_load_dwordx2 v[122:123], v21, s[48:51], s64 offen nt
s_mov_b32 s64, 0x1000
buffer_load_dwordx2 v[116:117], v21, s[48:51], s64 offen nt
s_mov_b32 s64, 0x1800
buffer_load_dwordx2 v[118:119], v21, s[48:51], s64 offen nt
s_mov_b32 s64, 0x11000
buffer_load_dwordx2 v[112:113], v21, s[48:51], s64 offen nt
s_mov_b32 s64, 0x11800
buffer_load_dwordx2 v[114:115], v21, s[48:51], s64 offen nt
s_mov_b32 s64, 0x80000
buffer_load_dwordx2 v[108:109], v21, s[48:51], s64 offen nt
s_mov_b32 s64, 0x80800
buffer_load_dwordx2 v[110:111], v21, s[48:51], s64 offen nt
s_mov_b32 s64, 0x90000
buffer_load_dwordx2 v[104:105], v21, s[48:51], s64 offen nt
s_mov_b32 s64, 0x90800
buffer_load_dwordx2 v[106:107], v21, s[48:51], s64 offen nt
s_mov_b32 s64, 0x81000
buffer_load_dwordx2 v[100:101], v21, s[48:51], s64 offen nt
s_mov_b32 s64, 0x81800
buffer_load_dwordx2 v[102:103], v21, s[48:51], s64 offen nt
s_mov_b32 s64, 0x91000
buffer_load_dwordx2 v[96:97], v21, s[48:51], s64 offen nt
s_mov_b32 s64, 0x91800
buffer_load_dwordx2 v[98:99], v21, s[48:51], s64 offen nt
s_mov_b32 s64, 0x20000
buffer_load_dwordx2 v[92:93], v21, s[48:51], s64 offen nt
s_mov_b32 s64, 0x20800
buffer_load_dwordx2 v[94:95], v21, s[48:51], s64 offen nt
s_mov_b32 s64, 0x30000
buffer_load_dwordx2 v[88:89], v21, s[48:51], s64 offen nt
s_mov_b32 s64, 0x30800
buffer_load_dwordx2 v[90:91], v21, s[48:51], s64 offen nt
s_mov_b32 s64, 0x21000
buffer_load_dwordx2 v[84:85], v21, s[48:51], s64 offen nt
s_mov_b32 s64, 0x21800
buffer_load_dwordx2 v[86:87], v21, s[48:51], s64 offen nt
s_mov_b32 s64, 0x31000
buffer_load_dwordx2 v[80:81], v21, s[48:51], s64 offen nt
s_mov_b32 s64, 0x31800
buffer_load_dwordx2 v[82:83], v21, s[48:51], s64 offen nt
s_mov_b32 s64, 0xa0000
buffer_load_dwordx2 v[76:77], v21, s[48:51], s64 offen nt
s_mov_b32 s64, 0xa0800
buffer_load_dwordx2 v[78:79], v21, s[48:51], s64 offen nt
s_mov_b32 s64, 0xb0000
buffer_load_dwordx2 v[72:73], v21, s[48:51], s64 offen nt
s_mov_b32 s64, 0xb0800
buffer_load_dwordx2 v[74:75], v21, s[48:51], s64 offen nt
s_mov_b32 s64, 0xa1000
buffer_load_dwordx2 v[68:69], v21, s[48:51], s64 offen nt
s_mov_b32 s64, 0xa1800
buffer_load_dwordx2 v[70:71], v21, s[48:51], s64 offen nt
s_mov_b32 s64, 0xb1000
buffer_load_dwordx2 v[64:65], v21, s[48:51], s64 offen nt
s_mov_b32 s64, 0xb1800
buffer_load_dwordx2 v[66:67], v21, s[48:51], s64 offen nt
s_mov_b32 s64, 0x4000
buffer_load_dwordx2 v[60:61], v21, s[48:51], s64 offen nt
s_mov_b32 s64, 0x4800
buffer_load_dwordx2 v[62:63], v21, s[48:51], s64 offen nt
s_mov_b32 s64, 0x14000
buffer_load_dwordx2 v[56:57], v21, s[48:51], s64 offen nt
s_mov_b32 s64, 0x14800
buffer_load_dwordx2 v[58:59], v21, s[48:51], s64 offen nt
s_mov_b32 s64, 0x5000
buffer_load_dwordx2 v[52:53], v21, s[48:51], s64 offen nt
s_mov_b32 s64, 0x5800
buffer_load_dwordx2 v[54:55], v21, s[48:51], s64 offen nt
s_mov_b32 s64, 0x15000
buffer_load_dwordx2 v[48:49], v21, s[48:51], s64 offen nt
s_mov_b32 s64, 0x15800
buffer_load_dwordx2 v[50:51], v21, s[48:51], s64 offen nt
s_mov_b32 s64, 0x84000
buffer_load_dwordx2 v[44:45], v21, s[48:51], s64 offen nt
s_mov_b32 s64, 0x84800
buffer_load_dwordx2 v[46:47], v21, s[48:51], s64 offen nt
s_mov_b32 s64, 0x94000
buffer_load_dwordx2 v[40:41], v21, s[48:51], s64 offen nt
s_mov_b32 s64, 0x94800
buffer_load_dwordx2 v[42:43], v21, s[48:51], s64 offen nt
s_mov_b32 s64, 0x85000
buffer_load_dwordx2 v[36:37], v21, s[48:51], s64 offen nt
s_mov_b32 s64, 0x85800
buffer_load_dwordx2 v[38:39], v21, s[48:51], s64 offen nt
s_mov_b32 s64, 0x95000
buffer_load_dwordx2 v[32:33], v21, s[48:51], s64 offen nt
s_mov_b32 s64, 0x95800
buffer_load_dwordx2 v[34:35], v21, s[48:51], s64 offen nt
s_waitcnt vmcnt(44)
v_perm_b32 v16, v126, v124, s52
v_accvgpr_write_b32 a0, v16
v_perm_b32 v17, v126, v124, s53
v_accvgpr_write_b32 a8, v17
v_perm_b32 v18, v127, v125, s52
v_accvgpr_write_b32 a16, v18
v_perm_b32 v24, v127, v125, s53
s_mov_b32 s64, 0x24000
buffer_load_dwordx2 v[124:125], v21, s[48:51], s64 offen nt
s_mov_b32 s64, 0x24800
buffer_load_dwordx2 v[126:127], v21, s[48:51], s64 offen nt
v_perm_b32 v19, v122, v120, s52
v_accvgpr_write_b32 a1, v19
v_perm_b32 v16, v122, v120, s53
v_accvgpr_write_b32 a9, v16
v_perm_b32 v17, v123, v121, s52
v_accvgpr_write_b32 a17, v17
v_perm_b32 v25, v123, v121, s53
s_mov_b32 s64, 0x34000
buffer_load_dwordx2 v[120:121], v21, s[48:51], s64 offen nt
s_mov_b32 s64, 0x34800
buffer_load_dwordx2 v[122:123], v21, s[48:51], s64 offen nt
s_waitcnt vmcnt(44)
v_perm_b32 v18, v118, v116, s52
v_accvgpr_write_b32 a2, v18
v_perm_b32 v19, v118, v116, s53
v_accvgpr_write_b32 a10, v19
v_perm_b32 v16, v119, v117, s52
v_accvgpr_write_b32 a18, v16
v_perm_b32 v26, v119, v117, s53
s_mov_b32 s64, 0x25000
buffer_load_dwordx2 v[116:117], v21, s[48:51], s64 offen nt
s_mov_b32 s64, 0x25800
buffer_load_dwordx2 v[118:119], v21, s[48:51], s64 offen nt
v_perm_b32 v17, v114, v112, s52
v_accvgpr_write_b32 a3, v17
v_perm_b32 v18, v114, v112, s53
v_accvgpr_write_b32 a11, v18
v_perm_b32 v19, v115, v113, s52
v_accvgpr_write_b32 a19, v19
v_perm_b32 v27, v115, v113, s53
ds_write_b128 v5, v[24:27] offset:0
s_mov_b32 s64, 0x35000
buffer_load_dwordx2 v[112:113], v21, s[48:51], s64 offen nt
s_mov_b32 s64, 0x35800
buffer_load_dwordx2 v[114:115], v21, s[48:51], s64 offen nt
s_waitcnt vmcnt(44)
v_perm_b32 v16, v110, v108, s52
v_accvgpr_write_b32 a4, v16
v_perm_b32 v17, v110, v108, s53
v_accvgpr_write_b32 a12, v17
v_perm_b32 v18, v111, v109, s52
v_accvgpr_write_b32 a20, v18
v_perm_b32 v28, v111, v109, s53
s_mov_b32 s64, 0xa4000
buffer_load_dwordx2 v[108:109], v21, s[48:51], s64 offen nt
s_mov_b32 s64, 0xa4800
buffer_load_dwordx2 v[110:111], v21, s[48:51], s64 offen nt
v_perm_b32 v19, v106, v104, s52
v_accvgpr_write_b32 a5, v19
v_perm_b32 v16, v106, v104, s53
v_accvgpr_write_b32 a13, v16
v_perm_b32 v17, v107, v105, s52
v_accvgpr_write_b32 a21, v17
v_perm_b32 v29, v107, v105, s53
s_mov_b32 s64, 0xb4000
buffer_load_dwordx2 v[104:105], v21, s[48:51], s64 offen nt
s_mov_b32 s64, 0xb4800
buffer_load_dwordx2 v[106:107], v21, s[48:51], s64 offen nt
s_waitcnt vmcnt(44)
v_perm_b32 v18, v102, v100, s52
v_accvgpr_write_b32 a6, v18
v_perm_b32 v19, v102, v100, s53
v_accvgpr_write_b32 a14, v19
v_perm_b32 v16, v103, v101, s52
v_accvgpr_write_b32 a22, v16
v_perm_b32 v30, v103, v101, s53
s_mov_b32 s64, 0xa5000
buffer_load_dwordx2 v[100:101], v21, s[48:51], s64 offen nt
s_mov_b32 s64, 0xa5800
buffer_load_dwordx2 v[102:103], v21, s[48:51], s64 offen nt
v_perm_b32 v17, v98, v96, s52
v_accvgpr_write_b32 a7, v17
v_perm_b32 v18, v98, v96, s53
v_accvgpr_write_b32 a15, v18
v_perm_b32 v19, v99, v97, s52
v_accvgpr_write_b32 a23, v19
v_perm_b32 v31, v99, v97, s53
ds_write_b128 v5, v[28:31] offset:1024
s_mov_b32 s64, 0xb5000
buffer_load_dwordx2 v[96:97], v21, s[48:51], s64 offen nt
s_mov_b32 s64, 0xb5800
buffer_load_dwordx2 v[98:99], v21, s[48:51], s64 offen nt
s_waitcnt vmcnt(44)
v_perm_b32 v16, v94, v92, s52
v_accvgpr_write_b32 a24, v16
v_perm_b32 v17, v94, v92, s53
v_accvgpr_write_b32 a32, v17
v_perm_b32 v18, v95, v93, s52
v_accvgpr_write_b32 a40, v18
v_perm_b32 v24, v95, v93, s53
s_mov_b32 s64, 0x8000
buffer_load_dwordx2 v[92:93], v21, s[48:51], s64 offen nt
s_mov_b32 s64, 0x8800
buffer_load_dwordx2 v[94:95], v21, s[48:51], s64 offen nt
v_perm_b32 v19, v90, v88, s52
v_accvgpr_write_b32 a25, v19
v_perm_b32 v16, v90, v88, s53
v_accvgpr_write_b32 a33, v16
v_perm_b32 v17, v91, v89, s52
v_accvgpr_write_b32 a41, v17
v_perm_b32 v25, v91, v89, s53
s_mov_b32 s64, 0x18000
buffer_load_dwordx2 v[88:89], v21, s[48:51], s64 offen nt
s_mov_b32 s64, 0x18800
buffer_load_dwordx2 v[90:91], v21, s[48:51], s64 offen nt
s_waitcnt vmcnt(44)
v_perm_b32 v18, v86, v84, s52
v_accvgpr_write_b32 a26, v18
v_perm_b32 v19, v86, v84, s53
v_accvgpr_write_b32 a34, v19
v_perm_b32 v16, v87, v85, s52
v_accvgpr_write_b32 a42, v16
v_perm_b32 v26, v87, v85, s53
s_mov_b32 s64, 0x9000
buffer_load_dwordx2 v[84:85], v21, s[48:51], s64 offen nt
s_mov_b32 s64, 0x9800
buffer_load_dwordx2 v[86:87], v21, s[48:51], s64 offen nt
v_perm_b32 v17, v82, v80, s52
v_accvgpr_write_b32 a27, v17
v_perm_b32 v18, v82, v80, s53
v_accvgpr_write_b32 a35, v18
v_perm_b32 v19, v83, v81, s52
v_accvgpr_write_b32 a43, v19
v_perm_b32 v27, v83, v81, s53
ds_write_b128 v5, v[24:27] offset:2048
s_mov_b32 s64, 0x19000
buffer_load_dwordx2 v[80:81], v21, s[48:51], s64 offen nt
s_mov_b32 s64, 0x19800
buffer_load_dwordx2 v[82:83], v21, s[48:51], s64 offen nt
s_waitcnt vmcnt(44)
v_perm_b32 v16, v78, v76, s52
v_accvgpr_write_b32 a28, v16
v_perm_b32 v17, v78, v76, s53
v_accvgpr_write_b32 a36, v17
v_perm_b32 v18, v79, v77, s52
v_accvgpr_write_b32 a44, v18
v_perm_b32 v28, v79, v77, s53
s_mov_b32 s64, 0x88000
buffer_load_dwordx2 v[76:77], v21, s[48:51], s64 offen nt
s_mov_b32 s64, 0x88800
buffer_load_dwordx2 v[78:79], v21, s[48:51], s64 offen nt
v_perm_b32 v19, v74, v72, s52
v_accvgpr_write_b32 a29, v19
v_perm_b32 v16, v74, v72, s53
v_accvgpr_write_b32 a37, v16
v_perm_b32 v17, v75, v73, s52
v_accvgpr_write_b32 a45, v17
v_perm_b32 v29, v75, v73, s53
s_mov_b32 s64, 0x98000
buffer_load_dwordx2 v[72:73], v21, s[48:51], s64 offen nt
s_mov_b32 s64, 0x98800
buffer_load_dwordx2 v[74:75], v21, s[48:51], s64 offen nt
s_waitcnt vmcnt(44)
v_perm_b32 v18, v70, v68, s52
v_accvgpr_write_b32 a30, v18
v_perm_b32 v19, v70, v68, s53
v_accvgpr_write_b32 a38, v19
v_perm_b32 v16, v71, v69, s52
v_accvgpr_write_b32 a46, v16
v_perm_b32 v30, v71, v69, s53
s_mov_b32 s64, 0x89000
buffer_load_dwordx2 v[68:69], v21, s[48:51], s64 offen nt
s_mov_b32 s64, 0x89800
buffer_load_dwordx2 v[70:71], v21, s[48:51], s64 offen nt
v_perm_b32 v17, v66, v64, s52
v_accvgpr_write_b32 a31, v17
v_perm_b32 v18, v66, v64, s53
v_accvgpr_write_b32 a39, v18
v_perm_b32 v19, v67, v65, s52
v_accvgpr_write_b32 a47, v19
v_perm_b32 v31, v67, v65, s53
ds_write_b128 v5, v[28:31] offset:3072
s_mov_b32 s64, 0x99000
buffer_load_dwordx2 v[64:65], v21, s[48:51], s64 offen nt
s_mov_b32 s64, 0x99800
buffer_load_dwordx2 v[66:67], v21, s[48:51], s64 offen nt
s_waitcnt vmcnt(44)
v_perm_b32 v16, v62, v60, s52
v_accvgpr_write_b32 a48, v16
v_perm_b32 v17, v62, v60, s53
v_accvgpr_write_b32 a56, v17
v_perm_b32 v18, v63, v61, s52
v_accvgpr_write_b32 a64, v18
v_perm_b32 v24, v63, v61, s53
s_mov_b32 s64, 0x28000
buffer_load_dwordx2 v[60:61], v21, s[48:51], s64 offen nt
s_mov_b32 s64, 0x28800
buffer_load_dwordx2 v[62:63], v21, s[48:51], s64 offen nt
v_perm_b32 v19, v58, v56, s52
v_accvgpr_write_b32 a49, v19
v_perm_b32 v16, v58, v56, s53
v_accvgpr_write_b32 a57, v16
v_perm_b32 v17, v59, v57, s52
v_accvgpr_write_b32 a65, v17
v_perm_b32 v25, v59, v57, s53
s_mov_b32 s64, 0x38000
buffer_load_dwordx2 v[56:57], v21, s[48:51], s64 offen nt
s_mov_b32 s64, 0x38800
buffer_load_dwordx2 v[58:59], v21, s[48:51], s64 offen nt
s_waitcnt vmcnt(44)
v_perm_b32 v18, v54, v52, s52
v_accvgpr_write_b32 a50, v18
v_perm_b32 v19, v54, v52, s53
v_accvgpr_write_b32 a58, v19
v_perm_b32 v16, v55, v53, s52
v_accvgpr_write_b32 a66, v16
v_perm_b32 v26, v55, v53, s53
s_mov_b32 s64, 0x29000
buffer_load_dwordx2 v[52:53], v21, s[48:51], s64 offen nt
s_mov_b32 s64, 0x29800
buffer_load_dwordx2 v[54:55], v21, s[48:51], s64 offen nt
v_perm_b32 v17, v50, v48, s52
v_accvgpr_write_b32 a51, v17
v_perm_b32 v18, v50, v48, s53
v_accvgpr_write_b32 a59, v18
v_perm_b32 v19, v51, v49, s52
v_accvgpr_write_b32 a67, v19
v_perm_b32 v27, v51, v49, s53
ds_write_b128 v5, v[24:27] offset:4096
s_mov_b32 s64, 0x39000
buffer_load_dwordx2 v[48:49], v21, s[48:51], s64 offen nt
s_mov_b32 s64, 0x39800
buffer_load_dwordx2 v[50:51], v21, s[48:51], s64 offen nt
s_waitcnt vmcnt(44)
v_perm_b32 v16, v46, v44, s52
v_accvgpr_write_b32 a52, v16
v_perm_b32 v17, v46, v44, s53
v_accvgpr_write_b32 a60, v17
v_perm_b32 v18, v47, v45, s52
v_accvgpr_write_b32 a68, v18
v_perm_b32 v28, v47, v45, s53
s_mov_b32 s64, 0xa8000
buffer_load_dwordx2 v[44:45], v21, s[48:51], s64 offen nt
s_mov_b32 s64, 0xa8800
buffer_load_dwordx2 v[46:47], v21, s[48:51], s64 offen nt
v_perm_b32 v19, v42, v40, s52
v_accvgpr_write_b32 a53, v19
v_perm_b32 v16, v42, v40, s53
v_accvgpr_write_b32 a61, v16
v_perm_b32 v17, v43, v41, s52
v_accvgpr_write_b32 a69, v17
v_perm_b32 v29, v43, v41, s53
s_mov_b32 s64, 0xb8000
buffer_load_dwordx2 v[40:41], v21, s[48:51], s64 offen nt
s_mov_b32 s64, 0xb8800
buffer_load_dwordx2 v[42:43], v21, s[48:51], s64 offen nt
s_waitcnt vmcnt(44)
v_perm_b32 v18, v38, v36, s52
v_accvgpr_write_b32 a54, v18
v_perm_b32 v19, v38, v36, s53
v_accvgpr_write_b32 a62, v19
v_perm_b32 v16, v39, v37, s52
v_accvgpr_write_b32 a70, v16
v_perm_b32 v30, v39, v37, s53
s_mov_b32 s64, 0xa9000
buffer_load_dwordx2 v[36:37], v21, s[48:51], s64 offen nt
s_mov_b32 s64, 0xa9800
buffer_load_dwordx2 v[38:39], v21, s[48:51], s64 offen nt
v_perm_b32 v17, v34, v32, s52
v_accvgpr_write_b32 a55, v17
v_perm_b32 v18, v34, v32, s53
v_accvgpr_write_b32 a63, v18
v_perm_b32 v19, v35, v33, s52
v_accvgpr_write_b32 a71, v19
v_perm_b32 v31, v35, v33, s53
ds_write_b128 v5, v[28:31] offset:5120
s_mov_b32 s64, 0xb9000
buffer_load_dwordx2 v[32:33], v21, s[48:51], s64 offen nt
s_mov_b32 s64, 0xb9800
buffer_load_dwordx2 v[34:35], v21, s[48:51], s64 offen nt
s_waitcnt vmcnt(44)
v_perm_b32 v16, v126, v124, s52
v_accvgpr_write_b32 a72, v16
v_perm_b32 v17, v126, v124, s53
v_accvgpr_write_b32 a80, v17
v_perm_b32 v18, v127, v125, s52
v_accvgpr_write_b32 a88, v18
v_perm_b32 v24, v127, v125, s53
s_mov_b32 s64, 0xc000
buffer_load_dwordx2 v[124:125], v21, s[48:51], s64 offen nt
s_mov_b32 s64, 0xc800
buffer_load_dwordx2 v[126:127], v21, s[48:51], s64 offen nt
v_perm_b32 v19, v122, v120, s52
v_accvgpr_write_b32 a73, v19
v_perm_b32 v16, v122, v120, s53
v_accvgpr_write_b32 a81, v16
v_perm_b32 v17, v123, v121, s52
v_accvgpr_write_b32 a89, v17
v_perm_b32 v25, v123, v121, s53
s_mov_b32 s64, 0x1c000
buffer_load_dwordx2 v[120:121], v21, s[48:51], s64 offen nt
s_mov_b32 s64, 0x1c800
buffer_load_dwordx2 v[122:123], v21, s[48:51], s64 offen nt
s_waitcnt vmcnt(44)
v_perm_b32 v18, v118, v116, s52
v_accvgpr_write_b32 a74, v18
v_perm_b32 v19, v118, v116, s53
v_accvgpr_write_b32 a82, v19
v_perm_b32 v16, v119, v117, s52
v_accvgpr_write_b32 a90, v16
v_perm_b32 v26, v119, v117, s53
s_mov_b32 s64, 0xd000
buffer_load_dwordx2 v[116:117], v21, s[48:51], s64 offen nt
s_mov_b32 s64, 0xd800
buffer_load_dwordx2 v[118:119], v21, s[48:51], s64 offen nt
v_perm_b32 v17, v114, v112, s52
v_accvgpr_write_b32 a75, v17
v_perm_b32 v18, v114, v112, s53
v_accvgpr_write_b32 a83, v18
v_perm_b32 v19, v115, v113, s52
v_accvgpr_write_b32 a91, v19
v_perm_b32 v27, v115, v113, s53
ds_write_b128 v5, v[24:27] offset:6144
s_mov_b32 s64, 0x1d000
buffer_load_dwordx2 v[112:113], v21, s[48:51], s64 offen nt
s_mov_b32 s64, 0x1d800
buffer_load_dwordx2 v[114:115], v21, s[48:51], s64 offen nt
s_waitcnt vmcnt(44)
v_perm_b32 v16, v110, v108, s52
v_accvgpr_write_b32 a76, v16
v_perm_b32 v17, v110, v108, s53
v_accvgpr_write_b32 a84, v17
v_perm_b32 v18, v111, v109, s52
v_accvgpr_write_b32 a92, v18
v_perm_b32 v28, v111, v109, s53
s_mov_b32 s64, 0x8c000
buffer_load_dwordx2 v[108:109], v21, s[48:51], s64 offen nt
s_mov_b32 s64, 0x8c800
buffer_load_dwordx2 v[110:111], v21, s[48:51], s64 offen nt
v_perm_b32 v19, v106, v104, s52
v_accvgpr_write_b32 a77, v19
v_perm_b32 v16, v106, v104, s53
v_accvgpr_write_b32 a85, v16
v_perm_b32 v17, v107, v105, s52
v_accvgpr_write_b32 a93, v17
v_perm_b32 v29, v107, v105, s53
s_mov_b32 s64, 0x9c000
buffer_load_dwordx2 v[104:105], v21, s[48:51], s64 offen nt
s_mov_b32 s64, 0x9c800
buffer_load_dwordx2 v[106:107], v21, s[48:51], s64 offen nt
s_waitcnt vmcnt(44)
v_perm_b32 v18, v102, v100, s52
v_accvgpr_write_b32 a78, v18
v_perm_b32 v19, v102, v100, s53
v_accvgpr_write_b32 a86, v19
v_perm_b32 v16, v103, v101, s52
v_accvgpr_write_b32 a94, v16
v_perm_b32 v30, v103, v101, s53
s_mov_b32 s64, 0x8d000
buffer_load_dwordx2 v[100:101], v21, s[48:51], s64 offen nt
s_mov_b32 s64, 0x8d800
buffer_load_dwordx2 v[102:103], v21, s[48:51], s64 offen nt
v_perm_b32 v17, v98, v96, s52
v_accvgpr_write_b32 a79, v17
v_perm_b32 v18, v98, v96, s53
v_accvgpr_write_b32 a87, v18
v_perm_b32 v19, v99, v97, s52
v_accvgpr_write_b32 a95, v19
v_perm_b32 v31, v99, v97, s53
ds_write_b128 v5, v[28:31] offset:7168
s_mov_b32 s64, 0x9d000
buffer_load_dwordx2 v[96:97], v21, s[48:51], s64 offen nt
s_mov_b32 s64, 0x9d800
buffer_load_dwordx2 v[98:99], v21, s[48:51], s64 offen nt
s_waitcnt vmcnt(44)
v_perm_b32 v16, v94, v92, s52
v_accvgpr_write_b32 a96, v16
v_perm_b32 v17, v94, v92, s53
v_accvgpr_write_b32 a104, v17
v_perm_b32 v18, v95, v93, s52
v_accvgpr_write_b32 a112, v18
v_perm_b32 v24, v95, v93, s53
s_mov_b32 s64, 0x2c000
buffer_load_dwordx2 v[92:93], v21, s[48:51], s64 offen nt
s_mov_b32 s64, 0x2c800
buffer_load_dwordx2 v[94:95], v21, s[48:51], s64 offen nt
v_perm_b32 v19, v90, v88, s52
v_accvgpr_write_b32 a97, v19
v_perm_b32 v16, v90, v88, s53
v_accvgpr_write_b32 a105, v16
v_perm_b32 v17, v91, v89, s52
v_accvgpr_write_b32 a113, v17
v_perm_b32 v25, v91, v89, s53
s_mov_b32 s64, 0x3c000
buffer_load_dwordx2 v[88:89], v21, s[48:51], s64 offen nt
s_mov_b32 s64, 0x3c800
buffer_load_dwordx2 v[90:91], v21, s[48:51], s64 offen nt
s_waitcnt vmcnt(44)
v_perm_b32 v18, v86, v84, s52
v_accvgpr_write_b32 a98, v18
v_perm_b32 v19, v86, v84, s53
v_accvgpr_write_b32 a106, v19
v_perm_b32 v16, v87, v85, s52
v_accvgpr_write_b32 a114, v16
v_perm_b32 v26, v87, v85, s53
s_mov_b32 s64, 0x2d000
buffer_load_dwordx2 v[84:85], v21, s[48:51], s64 offen nt
s_mov_b32 s64, 0x2d800
buffer_load_dwordx2 v[86:87], v21, s[48:51], s64 offen nt
v_perm_b32 v17, v82, v80, s52
v_accvgpr_write_b32 a99, v17
v_perm_b32 v18, v82, v80, s53
v_accvgpr_write_b32 a107, v18
v_perm_b32 v19, v83, v81, s52
v_accvgpr_write_b32 a115, v19
v_perm_b32 v27, v83, v81, s53
ds_write_b128 v5, v[24:27] offset:8192
s_mov_b32 s64, 0x3d000
buffer_load_dwordx2 v[80:81], v21, s[48:51], s64 offen nt
s_mov_b32 s64, 0x3d800
buffer_load_dwordx2 v[82:83], v21, s[48:51], s64 offen nt
s_waitcnt vmcnt(44)
v_perm_b32 v16, v78, v76, s52
v_accvgpr_write_b32 a100, v16
v_perm_b32 v17, v78, v76, s53
v_accvgpr_write_b32 a108, v17
v_perm_b32 v18, v79, v77, s52
v_accvgpr_write_b32 a116, v18
v_perm_b32 v28, v79, v77, s53
s_mov_b32 s64, 0xac000
buffer_load_dwordx2 v[76:77], v21, s[48:51], s64 offen nt
s_mov_b32 s64, 0xac800
buffer_load_dwordx2 v[78:79], v21, s[48:51], s64 offen nt
v_perm_b32 v19, v74, v72, s52
v_accvgpr_write_b32 a101, v19
v_perm_b32 v16, v74, v72, s53
v_accvgpr_write_b32 a109, v16
v_perm_b32 v17, v75, v73, s52
v_accvgpr_write_b32 a117, v17
v_perm_b32 v29, v75, v73, s53
s_mov_b32 s64, 0xbc000
buffer_load_dwordx2 v[72:73], v21, s[48:51], s64 offen nt
s_mov_b32 s64, 0xbc800
buffer_load_dwordx2 v[74:75], v21, s[48:51], s64 offen nt
s_waitcnt vmcnt(44)
v_perm_b32 v18, v70, v68, s52
v_accvgpr_write_b32 a102, v18
v_perm_b32 v19, v70, v68, s53
v_accvgpr_write_b32 a110, v19
v_perm_b32 v16, v71, v69, s52
v_accvgpr_write_b32 a118, v16
v_perm_b32 v30, v71, v69, s53
s_mov_b32 s64, 0xad000
buffer_load_dwordx2 v[68:69], v21, s[48:51], s64 offen nt
s_mov_b32 s64, 0xad800
buffer_load_dwordx2 v[70:71], v21, s[48:51], s64 offen nt
v_perm_b32 v17, v66, v64, s52
v_accvgpr_write_b32 a103, v17
v_perm_b32 v18, v66, v64, s53
v_accvgpr_write_b32 a111, v18
v_perm_b32 v19, v67, v65, s52
v_accvgpr_write_b32 a119, v19
v_perm_b32 v31, v67, v65, s53
ds_write_b128 v5, v[28:31] offset:9216
s_mov_b32 s64, 0xbd000
buffer_load_dwordx2 v[64:65], v21, s[48:51], s64 offen nt
s_mov_b32 s64, 0xbd800
buffer_load_dwordx2 v[66:67], v21, s[48:51], s64 offen nt
s_waitcnt vmcnt(44)
v_perm_b32 v16, v62, v60, s52
v_accvgpr_write_b32 a120, v16
v_perm_b32 v17, v62, v60, s53
v_accvgpr_write_b32 a128, v17
v_perm_b32 v18, v63, v61, s52
v_accvgpr_write_b32 a136, v18
v_perm_b32 v24, v63, v61, s53
v_perm_b32 v19, v58, v56, s52
v_accvgpr_write_b32 a121, v19
v_perm_b32 v16, v58, v56, s53
v_accvgpr_write_b32 a129, v16
v_perm_b32 v17, v59, v57, s52
v_accvgpr_write_b32 a137, v17
v_perm_b32 v25, v59, v57, s53
s_waitcnt vmcnt(40)
v_perm_b32 v18, v54, v52, s52
v_accvgpr_write_b32 a122, v18
v_perm_b32 v19, v54, v52, s53
v_accvgpr_write_b32 a130, v19
v_perm_b32 v16, v55, v53, s52
v_accvgpr_write_b32 a138, v16
v_perm_b32 v26, v55, v53, s53
v_perm_b32 v17, v50, v48, s52
v_accvgpr_write_b32 a123, v17
v_perm_b32 v18, v50, v48, s53
v_accvgpr_write_b32 a131, v18
v_perm_b32 v19, v51, v49, s52
v_accvgpr_write_b32 a139, v19
v_perm_b32 v27, v51, v49, s53
ds_write_b128 v5, v[24:27] offset:10240
s_waitcnt vmcnt(36)
v_perm_b32 v16, v46, v44, s52
v_accvgpr_write_b32 a124, v16
v_perm_b32 v17, v46, v44, s53
v_accvgpr_write_b32 a132, v17
v_perm_b32 v18, v47, v45, s52
v_accvgpr_write_b32 a140, v18
v_perm_b32 v28, v47, v45, s53
v_perm_b32 v19, v42, v40, s52
v_accvgpr_write_b32 a125, v19
v_perm_b32 v16, v42, v40, s53
v_accvgpr_write_b32 a133, v16
v_perm_b32 v17, v43, v41, s52
v_accvgpr_write_b32 a141, v17
v_perm_b32 v29, v43, v41, s53
s_waitcnt vmcnt(32)
v_perm_b32 v18, v38, v36, s52
v_accvgpr_write_b32 a126, v18
v_perm_b32 v19, v38, v36, s53
v_accvgpr_write_b32 a134, v19
v_perm_b32 v16, v39, v37, s52
v_accvgpr_write_b32 a142, v16
v_perm_b32 v30, v39, v37, s53
v_perm_b32 v17, v34, v32, s52
v_accvgpr_write_b32 a127, v17
v_perm_b32 v18, v34, v32, s53
v_accvgpr_write_b32 a135, v18
v_perm_b32 v19, v35, v33, s52
v_accvgpr_write_b32 a143, v19
v_perm_b32 v31, v35, v33, s53
ds_write_b128 v5, v[28:31] offset:11264
s_waitcnt vmcnt(28)
v_perm_b32 v16, v126, v124, s52
v_accvgpr_write_b32 a144, v16
v_perm_b32 v17, v126, v124, s53
v_accvgpr_write_b32 a152, v17
v_perm_b32 v18, v127, v125, s52
v_accvgpr_write_b32 a160, v18
v_perm_b32 v24, v127, v125, s53
v_perm_b32 v19, v122, v120, s52
v_accvgpr_write_b32 a145, v19
v_perm_b32 v16, v122, v120, s53
v_accvgpr_write_b32 a153, v16
v_perm_b32 v17, v123, v121, s52
v_accvgpr_write_b32 a161, v17
v_perm_b32 v25, v123, v121, s53
s_waitcnt vmcnt(24)
v_perm_b32 v18, v118, v116, s52
v_accvgpr_write_b32 a146, v18
v_perm_b32 v19, v118, v116, s53
v_accvgpr_write_b32 a154, v19
v_perm_b32 v16, v119, v117, s52
v_accvgpr_write_b32 a162, v16
v_perm_b32 v26, v119, v117, s53
v_perm_b32 v17, v114, v112, s52
v_accvgpr_write_b32 a147, v17
v_perm_b32 v18, v114, v112, s53
v_accvgpr_write_b32 a155, v18
v_perm_b32 v19, v115, v113, s52
v_accvgpr_write_b32 a163, v19
v_perm_b32 v27, v115, v113, s53
ds_write_b128 v5, v[24:27] offset:12288
s_waitcnt vmcnt(20)
v_perm_b32 v16, v110, v108, s52
v_accvgpr_write_b32 a148, v16
v_perm_b32 v17, v110, v108, s53
v_accvgpr_write_b32 a156, v17
v_perm_b32 v18, v111, v109, s52
v_accvgpr_write_b32 a164, v18
v_perm_b32 v28, v111, v109, s53
v_perm_b32 v19, v106, v104, s52
v_accvgpr_write_b32 a149, v19
v_perm_b32 v16, v106, v104, s53
v_accvgpr_write_b32 a157, v16
v_perm_b32 v17, v107, v105, s52
v_accvgpr_write_b32 a165, v17
v_perm_b32 v29, v107, v105, s53
s_waitcnt vmcnt(16)
v_perm_b32 v18, v102, v100, s52
v_accvgpr_write_b32 a150, v18
v_perm_b32 v19, v102, v100, s53
v_accvgpr_write_b32 a158, v19
v_perm_b32 v16, v103, v101, s52
v_accvgpr_write_b32 a166, v16
v_perm_b32 v30, v103, v101, s53
v_perm_b32 v17, v98, v96, s52
v_accvgpr_write_b32 a151, v17
v_perm_b32 v18, v98, v96, s53
v_accvgpr_write_b32 a159, v18
v_perm_b32 v19, v99, v97, s52
v_accvgpr_write_b32 a167, v19
v_perm_b32 v31, v99, v97, s53
ds_write_b128 v5, v[28:31] offset:13312
s_waitcnt vmcnt(12)
v_perm_b32 v16, v94, v92, s52
v_accvgpr_write_b32 a168, v16
v_perm_b32 v17, v94, v92, s53
v_accvgpr_write_b32 a176, v17
v_perm_b32 v18, v95, v93, s52
v_accvgpr_write_b32 a184, v18
v_perm_b32 v24, v95, v93, s53
v_perm_b32 v19, v90, v88, s52
v_accvgpr_write_b32 a169, v19
v_perm_b32 v16, v90, v88, s53
v_accvgpr_write_b32 a177, v16
v_perm_b32 v17, v91, v89, s52
v_accvgpr_write_b32 a185, v17
v_perm_b32 v25, v91, v89, s53
s_waitcnt vmcnt(8)
v_perm_b32 v18, v86, v84, s52
v_accvgpr_write_b32 a170, v18
v_perm_b32 v19, v86, v84, s53
v_accvgpr_write_b32 a178, v19
v_perm_b32 v16, v87, v85, s52
v_accvgpr_write_b32 a186, v16
v_perm_b32 v26, v87, v85, s53
v_perm_b32 v17, v82, v80, s52
v_accvgpr_write_b32 a171, v17
v_perm_b32 v18, v82, v80, s53
v_accvgpr_write_b32 a179, v18
v_perm_b32 v19, v83, v81, s52
v_accvgpr_write_b32 a187, v19
v_perm_b32 v27, v83, v81, s53
ds_write_b128 v5, v[24:27] offset:14336
s_waitcnt vmcnt(4)
v_perm_b32 v16, v78, v76, s52
v_accvgpr_write_b32 a172, v16
v_perm_b32 v17, v78, v76, s53
v_accvgpr_write_b32 a180, v17
v_perm_b32 v18, v79, v77, s52
v_accvgpr_write_b32 a188, v18
v_perm_b32 v28, v79, v77, s53
v_perm_b32 v19, v74, v72, s52
v_accvgpr_write_b32 a173, v19
v_perm_b32 v16, v74, v72, s53
v_accvgpr_write_b32 a181, v16
v_perm_b32 v17, v75, v73, s52
v_accvgpr_write_b32 a189, v17
v_perm_b32 v29, v75, v73, s53
s_waitcnt vmcnt(0)
v_perm_b32 v18, v70, v68, s52
v_accvgpr_write_b32 a174, v18
v_perm_b32 v19, v70, v68, s53
v_accvgpr_write_b32 a182, v19
v_perm_b32 v16, v71, v69, s52
v_accvgpr_write_b32 a190, v16
v_perm_b32 v30, v71, v69, s53
v_perm_b32 v17, v66, v64, s52
v_accvgpr_write_b32 a175, v17
v_perm_b32 v18, v66, v64, s53
v_accvgpr_write_b32 a183, v18
v_perm_b32 v19, v67, v65, s52
v_accvgpr_write_b32 a191, v19
v_perm_b32 v31, v67, v65, s53
ds_write_b128 v5, v[28:31] offset:15360
s_waitcnt lgkmcnt(0)
s_mov_b32 s44, s10
s_and_b32 s45, s11, 0xffff
s_mov_b32 s46, 0x4000
s_mov_b32 s47, 0x20000
buffer_load_dword v16, v12, s[44:47], 0 offen
s_cmp_lg_u32 s62, 0
s_cbranch_scc1 L_cd_45
v_mbcnt_lo_u32_b32 v17, -1, 0
v_mbcnt_hi_u32_b32 v17, -1, v17
v_lshlrev_b32 v17, 2, v17
L_ct_46:
buffer_load_dword v18, v17, s[40:43], 0 offen sc1
s_mov_b32 s64, 0x10001000
s_mov_b32 s65, 0x10001000
s_waitcnt vmcnt(0)
v_cmp_ne_u32 vcc, 64, v18
s_nop 0
s_and_b64 s[64:65], s[64:65], vcc
s_cbranch_scc0 L_co_47
s_sleep 12
s_add_u32 s63, s63, 1
s_cmp_lt_u32 s63, 0x20000
s_cbranch_scc1 L_ct_46
s_branch L_giveup
L_co_47:
v_cmp_ne_u32 vcc, 32, v18
s_mov_b32 s64, 0x110011
s_mov_b32 s65, 0x110011
s_and_b64 s[64:65], s[64:65], vcc
s_cbranch_scc1 L_recensus
L_sd_48:
v_readlane_b32 s64, v18, 2
s_nop 0
s_cmp_lg_u32 s64, 0
s_cbranch_scc1 L_sk_49
s_sleep 4
buffer_load_dword v18, v17, s[40:43], 0 offen sc1
s_waitcnt vmcnt(0)
s_add_u32 s63, s63, 1
s_cmp_lt_u32 s63, 0x20000
s_cbranch_scc1 L_sd_48
s_branch L_giveup
L_sk_49:
s_cmp_eq_u32 s64, 2
s_cselect_b32 s64, 0x200000, 0
s_add_u32 s64, s64, 0x6000
s_add_u32 s36, s34, s64
s_addc_u32 s37, s35, 0
s_and_b32 s37, s37, 0xffff
L_cd_45:
s_lshl_b32 s84, s80, 15
s_xor_b32 s85, s84, 0x8000
s_add_u32 s84, s84, 0x3e000
s_add_u32 s85, s85, 0x3c000
s_sub_u32 s88, s84, 0x2000
s_cmp_eq_u32 s80, 0
s_cselect_b32 s64, -1, 0
s_waitcnt vmcnt(0)
v_and_b32 v16, s64, v16
v_min_u32 v16, s54, v16
buffer_store_dword v16, v13, s[36:39], s88 offen sc1
s_cmp_lg_u32 s58, 0
s_cbranch_scc1 L_sl_50
buffer_store_dword v16, v13, s[36:39], s84 offen
s_branch L_sd_51
L_sl_50:
buffer_store_dword v16, v13, s[36:39], s84 offen sc1
L_sd_51:
s_mov_b32 s59, 0
L_vo_top:
s_and_b32 s66, s59, 3
s_lshr_b32 s64, s66, 1
s_add_u32 s64, s64, s66
s_lshl_b32 s64, s64, 16
s_add_u32 s91, s84, s64
s_add_u32 s92, s85, s64
s_mul_i32 s64, s66, 0x10000
s_add_u32 s93, s86, s64
s_add_u32 s94, s87, s64
s_xor_b32 s65, s66, 2
s_mul_i32 s64, s65, 0x10000
s_add_u32 s90, s87, s64
s_lshr_b32 s64, s65, 1
s_add_u32 s64, s64, s65
s_lshl_b32 s64, s64, 16
s_add_u32 s97, s88, s64
s_add_u32 s89, s84, s64
s_add_u32 s66, s66, 1
s_and_b32 s66, s66, 3
s_lshr_b32 s64, s66, 1
s_add_u32 s64, s64, s66
s_lshl_b32 s64, s64, 16
s_add_u32 s95, s88, s64
s_add_u32 s96, s84, s64
buffer_load_dwordx4 v[96:99], v2, s[36:39], s91 offen offset:0 sc1
buffer_load_dwordx4 v[100:103], v2, s[36:39], s91 offen offset:512 sc1
v_mov_b32 v64, 0
v_mov_b32 v65, 0
v_mov_b32 v66, 0
v_mov_b32 v67, 0
v_mov_b32 v68, 0
v_mov_b32 v69, 0
v_mov_b32 v70, 0
v_mov_b32 v71, 0
L_pl_52:
buffer_load_dwordx4 v[104:107], v2, s[36:39], s91 offen offset:128 sc1
buffer_load_dwordx4 v[108:111], v2, s[36:39], s91 offen offset:640 sc1
s_waitcnt vmcnt(2)
v_max3_u32 v12, v96, v97, v98
v_max3_u32 v12, v12, v99, v100
v_max3_u32 v12, v12, v101, v102
v_max_u32 v12, v12, v103
v_cmp_eq_u32 vcc, -1, v12
s_cbranch_vccz L_plg_53
buffer_load_dwordx4 v[96:99], v2, s[36:39], s91 offen offset:0 sc1
buffer_load_dwordx4 v[100:103], v2, s[36:39], s91 offen offset:512 sc1
s_waitcnt vmcnt(2)
v_max3_u32 v12, v104, v105, v106
v_max3_u32 v12, v12, v107, v108
v_max3_u32 v12, v12, v109, v110
v_max_u32 v12, v12, v111
v_cmp_eq_u32 vcc, -1, v12
s_cbranch_vccz L_plg_53
s_add_u32 s63, s63, 1
s_cmp_lt_u32 s63, 0x20000
s_cbranch_scc1 L_pl_52
s_branch L_giveup
L_plg_53:
buffer_load_dwordx4 v[48:51], v2, s[36:39], s92 offen offset:0 sc1
buffer_load_dwordx4 v[52:55], v2, s[36:39], s92 offen offset:512 sc1
buffer_load_dwordx4 v[56:59], v2, s[36:39], s92 offen offset:128 sc1
buffer_load_dwordx4 v[60:63], v2, s[36:39], s92 offen offset:640 sc1
s_waitcnt vmcnt(4)
v_max3_u32 v12, v96, v97, v98
v_max3_u32 v12, v12, v99, v100
v_max3_u32 v12, v12, v101, v102
v_max3_u32 v12, v12, v103, v104
v_max3_u32 v12, v12, v105, v106
v_max3_u32 v12, v12, v107, v108
v_max3_u32 v12, v12, v109, v110
v_max_u32 v12, v12, v111
v_cmp_eq_u32 vcc, -1, v12
s_cbranch_vccnz L_lm_55
L_lb_54:
s_waitcnt lgkmcnt(0)
v_mfma_f32_4x4x4_16b_bf16 v[16:19], v[10:11], v[96:97], 0
v_mfma_f32_4x4x4_16b_bf16 v[20:23], v[10:11], v[98:99], 0
v_mfma_f32_4x4x4_16b_bf16 v[24:27], v[10:11], v[100:101], 0
v_mfma_f32_4x4x4_16b_bf16 v[28:31], v[10:11], v[102:103], 0
v_mfma_f32_4x4x4_16b_bf16 v[32:35], v[10:11], v[104:105], 0
v_mfma_f32_4x4x4_16b_bf16 v[36:39], v[10:11], v[106:107], 0
v_mfma_f32_4x4x4_16b_bf16 v[40:43], v[10:11], v[108:109], 0
v_mfma_f32_4x4x4_16b_bf16 v[44:47], v[10:11], v[110:111], 0
v_mov_b32 v14, -1
v_mov_b32 v15, -1
ds_read_b128 v[112:115], v5 offset:16384
ds_read_b128 v[116:119], v5 offset:17408
ds_read_b128 v[120:123], v5 offset:18432
ds_read_b128 v[124:127], v5 offset:19456
ds_read_b128 v[96:99], v5 offset:20480
ds_read_b128 v[100:103], v5 offset:21504
ds_read_b128 v[104:107], v5 offset:22528
ds_read_b128 v[108:111], v5 offset:23552
L_rc_56:
s_waitcnt vmcnt(3)
v_max3_u32 v12, v48, v49, v50
v_max_u32 v12, v12, v51
v_cmp_eq_u32 vcc, -1, v12
v_mfma_f32_4x4x4_16b_bf16 v[72:75], v[10:11], v[48:49], v[16:19]
v_mfma_f32_4x4x4_16b_bf16 v[76:79], v[10:11], v[50:51], v[20:23]
s_cbranch_vccnz L_ra_57
s_waitcnt vmcnt(2)
v_max3_u32 v12, v52, v53, v54
v_max_u32 v12, v12, v55
v_cmp_eq_u32 vcc, -1, v12
v_cvt_pk_bf16_f32 v48, v72, v73
v_cvt_pk_bf16_f32 v49, v74, v75
v_cvt_pk_bf16_f32 v50, v76, v77
v_cvt_pk_bf16_f32 v51, v78, v79
ds_write_b128 v0, v[48:51] offset:0
s_cbranch_vccnz L_gm_59
L_gb_58:
v_mfma_f32_4x4x4_16b_bf16 v[24:27], v[10:11], v[52:53], v[24:27]
v_mfma_f32_4x4x4_16b_bf16 v[28:31], v[10:11], v[54:55], v[28:31]
s_waitcnt lgkmcnt(0)
s_barrier
ds_read_b128 v[80:83], v4 offset:0
ds_read_b128 v[84:87], v4 offset:4096
ds_read_b128 v[88:91], v4 offset:8192
ds_read_b128 v[92:95], v4 offset:12288
s_waitcnt vmcnt(0)
v_max3_u32 v12, v56, v57, v58
v_max3_u32 v12, v12, v59, v60
v_max3_u32 v12, v12, v61, v62
v_max_u32 v12, v12, v63
v_cmp_eq_u32 vcc, -1, v12
v_cvt_pk_bf16_f32 v52, v24, v25
v_cvt_pk_bf16_f32 v53, v26, v27
v_cvt_pk_bf16_f32 v54, v28, v29
v_cvt_pk_bf16_f32 v55, v30, v31
ds_write_b128 v0, v[52:55] offset:1024
s_cbranch_vccnz L_gm_61
L_gb_60:
v_mfma_f32_4x4x4_16b_bf16 v[32:35], v[10:11], v[56:57], v[32:35]
v_mfma_f32_4x4x4_16b_bf16 v[36:39], v[10:11], v[58:59], v[36:39]
v_mfma_f32_4x4x4_16b_bf16 v[40:43], v[10:11], v[60:61], v[40:43]
v_mfma_f32_4x4x4_16b_bf16 v[44:47], v[10:11], v[62:63], v[44:47]
s_waitcnt lgkmcnt(4)
v_smfmac_f32_16x16x64_bf16 v[64:67], v[80:83], a[192:199], v3
v_smfmac_f32_16x16x64_bf16 v[68:71], v[80:83], a[200:207], v3
v_cvt_pk_bf16_f32 v56, v32, v33
v_cvt_pk_bf16_f32 v57, v34, v35
s_waitcnt lgkmcnt(0)
s_barrier
ds_read_b128 v[80:83], v4 offset:1024
v_smfmac_f32_16x16x64_bf16 v[64:67], v[84:87], a[208:215], v3
v_cvt_pk_bf16_f32 v58, v36, v37
v_cvt_pk_bf16_f32 v59, v38, v39
v_smfmac_f32_16x16x64_bf16 v[68:71], v[84:87], v[112:119], v3
ds_write_b128 v0, v[56:59] offset:2048
ds_read_b128 v[84:87], v4 offset:5120
v_smfmac_f32_16x16x64_bf16 v[64:67], v[88:91], a[216:223], v3
v_cvt_pk_bf16_f32 v60, v40, v41
v_cvt_pk_bf16_f32 v61, v42, v43
v_smfmac_f32_16x16x64_bf16 v[68:71], v[88:91], a[224:231], v3
v_cvt_pk_bf16_f32 v62, v44, v45
ds_read_b128 v[88:91], v4 offset:9216
v_smfmac_f32_16x16x64_bf16 v[64:67], v[92:95], a[232:239], v3
v_cvt_pk_bf16_f32 v63, v46, v47
ds_write_b128 v0, v[60:63] offset:3072
v_smfmac_f32_16x16x64_bf16 v[68:71], v[92:95], v[120:127], v3
ds_read_b128 v[92:95], v4 offset:13312
s_waitcnt lgkmcnt(5)
v_smfmac_f32_16x16x64_bf16 v[64:67], v[80:83], a[240:247], v3
ds_read_b128 v[112:115], v5 offset:24576
v_smfmac_f32_16x16x64_bf16 v[68:71], v[80:83], a[248:255], v3
s_waitcnt lgkmcnt(2)
s_barrier
ds_read_b128 v[80:83], v4 offset:2048
v_smfmac_f32_16x16x64_bf16 v[64:67], v[84:87], v[128:135], v3
buffer_store_dword v14, v13, s[36:39], s97 offen sc1
v_smfmac_f32_16x16x64_bf16 v[68:71], v[84:87], v[96:103], v3
ds_read_b128 v[84:87], v4 offset:6144
v_smfmac_f32_16x16x64_bf16 v[64:67], v[88:91], v[136:143], v3
ds_read_b128 v[116:119], v5 offset:25600
v_smfmac_f32_16x16x64_bf16 v[68:71], v[88:91], v[144:151], v3
ds_read_b128 v[88:91], v4 offset:10240
s_waitcnt lgkmcnt(5)
v_smfmac_f32_16x16x64_bf16 v[64:67], v[92:95], v[152:159], v3
ds_read_b128 v[120:123], v5 offset:26624
v_smfmac_f32_16x16x64_bf16 v[68:71], v[92:95], v[104:111], v3
ds_read_b128 v[92:95], v4 offset:14336
s_waitcnt lgkmcnt(5)
v_smfmac_f32_16x16x64_bf16 v[64:67], v[80:83], v[160:167], v3
ds_read_b128 v[124:127], v5 offset:27648
v_smfmac_f32_16x16x64_bf16 v[68:71], v[80:83], v[168:175], v3
ds_read_b128 v[80:83], v4 offset:3072
s_waitcnt lgkmcnt(6)
v_smfmac_f32_16x16x64_bf16 v[64:67], v[84:87], v[176:183], v3
ds_read_b128 v[96:99], v5 offset:28672
s_waitcnt lgkmcnt(6)
v_smfmac_f32_16x16x64_bf16 v[68:71], v[84:87], v[112:119], v3
ds_read_b128 v[84:87], v4 offset:7168
s_waitcnt lgkmcnt(6)
v_smfmac_f32_16x16x64_bf16 v[64:67], v[88:91], v[184:191], v3
ds_read_b128 v[100:103], v5 offset:29696
v_smfmac_f32_16x16x64_bf16 v[68:71], v[88:91], v[192:199], v3
ds_read_b128 v[88:91], v4 offset:11264
s_waitcnt lgkmcnt(6)
v_smfmac_f32_16x16x64_bf16 v[64:67], v[92:95], v[200:207], v3
ds_read_b128 v[104:107], v5 offset:30720
s_waitcnt lgkmcnt(6)
v_smfmac_f32_16x16x64_bf16 v[68:71], v[92:95], v[120:127], v3
ds_read_b128 v[92:95], v4 offset:15360
s_waitcnt lgkmcnt(6)
v_smfmac_f32_16x16x64_bf16 v[64:67], v[80:83], v[208:215], v3
ds_read_b128 v[108:111], v5 offset:31744
v_smfmac_f32_16x16x64_bf16 v[68:71], v[80:83], v[216:223], v3
s_waitcnt lgkmcnt(5)
v_smfmac_f32_16x16x64_bf16 v[64:67], v[84:87], v[224:231], v3
s_waitcnt lgkmcnt(4)
v_smfmac_f32_16x16x64_bf16 v[68:71], v[84:87], v[96:103], v3
s_waitcnt lgkmcnt(3)
v_smfmac_f32_16x16x64_bf16 v[64:67], v[88:91], v[232:239], v3
v_smfmac_f32_16x16x64_bf16 v[68:71], v[88:91], v[240:247], v3
s_waitcnt lgkmcnt(1)
v_smfmac_f32_16x16x64_bf16 v[64:67], v[92:95], v[248:255], v3
s_waitcnt lgkmcnt(0)
v_smfmac_f32_16x16x64_bf16 v[68:71], v[92:95], v[104:111], v3
s_nop 7
v_permlane32_swap_b32 v64, v68
v_permlane32_swap_b32 v65, v69
v_permlane32_swap_b32 v66, v70
v_permlane32_swap_b32 v67, v71
v_pk_add_f32 v[64:65], v[64:65], v[68:69]
v_pk_add_f32 v[66:67], v[66:67], v[70:71]
v_cvt_pk_bf16_f32 v16, v64, v65
v_min_u32 v16, s54, v16
v_cvt_pk_bf16_f32 v17, v66, v67
v_min_u32 v17, s54, v17
s_cmp_lg_u32 s58, 0
s_cbranch_scc1 L_sl_62
buffer_store_dwordx2 v[16:17], v6, s[36:39], s94 offen
buffer_store_dwordx2 v[14:15], v6, s[36:39], s90 offen
buffer_store_dword v14, v13, s[36:39], s89 offen
L_sd_63:
s_cmp_eq_u32 s59, 63
s_cbranch_scc1 L_end
ds_read_b128 v[48:51], v5 offset:0
ds_read_b128 v[52:55], v5 offset:1024
ds_read_b128 v[56:59], v5 offset:2048
ds_read_b128 v[60:63], v5 offset:3072
ds_read_b128 v[80:83], v5 offset:4096
ds_read_b128 v[84:87], v5 offset:5120
ds_read_b128 v[88:91], v5 offset:6144
ds_read_b128 v[92:95], v5 offset:7168
ds_read_b128 v[96:99], v5 offset:8192
ds_read_b128 v[100:103], v5 offset:9216
ds_read_b128 v[104:107], v5 offset:10240
ds_read_b128 v[108:111], v5 offset:11264
ds_read_b128 v[112:115], v5 offset:12288
ds_read_b128 v[116:119], v5 offset:13312
ds_read_b128 v[120:123], v5 offset:14336
ds_read_b128 v[124:127], v5 offset:15360
s_waitcnt lgkmcnt(0)
s_mov_b64 exec, s[2:3]
buffer_load_dword v12, v7, s[36:39], s93 offen sc1
s_waitcnt vmcnt(0)
v_cmp_eq_u32 vcc, -1, v12
s_cbranch_vccz L_lt_69
buffer_load_dword v12, v7, s[36:39], s93 offen sc1
s_waitcnt vmcnt(0)
v_cmp_eq_u32 vcc, -1, v12
s_cbranch_vccz L_lt_69
buffer_load_dword v12, v7, s[36:39], s93 offen sc1
s_waitcnt vmcnt(0)
v_cmp_eq_u32 vcc, -1, v12
s_cbranch_vccz L_lt_69
buffer_load_dword v12, v7, s[36:39], s93 offen sc1
s_waitcnt vmcnt(0)
L_lt_69:
s_mov_b64 exec, -1
buffer_load_dwordx4 v[16:19], v7, s[36:39], s93 offen offset:0 sc1
buffer_load_dwordx4 v[20:23], v7, s[36:39], s93 offen offset:1024 sc1
v_mov_b32 v64, 0
v_mov_b32 v65, 0
v_mov_b32 v66, 0
v_mov_b32 v67, 0
v_mov_b32 v68, 0
v_mov_b32 v69, 0
v_mov_b32 v70, 0
v_mov_b32 v71, 0
v_mov_b32 v72, 0
v_mov_b32 v73, 0
v_mov_b32 v74, 0
v_mov_b32 v75, 0
v_mov_b32 v76, 0
v_mov_b32 v77, 0
v_mov_b32 v78, 0
v_mov_b32 v79, 0
L_oa_64:
buffer_load_dwordx4 v[24:27], v7, s[36:39], s93 offen offset:128 sc1
buffer_load_dwordx4 v[28:31], v7, s[36:39], s93 offen offset:1152 sc1
s_waitcnt vmcnt(2)
v_max3_u32 v12, v16, v17, v18
v_max3_u32 v12, v12, v19, v20
v_max3_u32 v12, v12, v21, v22
v_max_u32 v12, v12, v23
v_cmp_eq_u32 vcc, -1, v12
s_cbranch_vccz L_oa_66
buffer_load_dwordx4 v[16:19], v7, s[36:39], s93 offen offset:0 sc1
buffer_load_dwordx4 v[20:23], v7, s[36:39], s93 offen offset:1024 sc1
s_waitcnt vmcnt(2)
v_max3_u32 v12, v24, v25, v26
v_max3_u32 v12, v12, v27, v28
v_max3_u32 v12, v12, v29, v30
v_max_u32 v12, v12, v31
v_cmp_eq_u32 vcc, -1, v12
s_cbranch_vccz L_ob_67
s_add_u32 s63, s63, 1
s_cmp_lt_u32 s63, 0x20000
s_cbranch_scc1 L_oa_64
s_branch L_giveup
L_ob_67:
buffer_load_dwordx4 v[32:35], v7, s[36:39], s93 offen offset:256 sc1
v_smfmac_f32_16x16x64_bf16 v[64:67], v[24:27], a[48:55], v3
buffer_load_dwordx4 v[36:39], v7, s[36:39], s93 offen offset:1280 sc1
v_smfmac_f32_16x16x64_bf16 v[68:71], v[24:27], a[56:63], v3
buffer_load_dwordx4 v[40:43], v7, s[36:39], s93 offen offset:384 sc1
v_smfmac_f32_16x16x64_bf16 v[72:75], v[24:27], a[64:71], v3
buffer_load_dwordx4 v[44:47], v7, s[36:39], s93 offen offset:1408 sc1
v_smfmac_f32_16x16x64_bf16 v[76:79], v[24:27], v[80:87], v3
v_smfmac_f32_16x16x64_bf16 v[64:67], v[28:31], a[72:79], v3
s_waitcnt vmcnt(5)
v_max3_u32 v12, v16, v17, v18
v_smfmac_f32_16x16x64_bf16 v[68:71], v[28:31], a[80:87], v3
v_max_u32 v12, v12, v19
v_cmp_eq_u32 vcc, -1, v12
v_smfmac_f32_16x16x64_bf16 v[72:75], v[28:31], a[88:95], v3
v_smfmac_f32_16x16x64_bf16 v[76:79], v[28:31], v[88:95], v3
s_cbranch_vccnz L_om_73
L_ob_72:
v_smfmac_f32_16x16x64_bf16 v[64:67], v[16:19], a[0:7], v3
s_waitcnt vmcnt(4)
v_max3_u32 v12, v20, v21, v22
v_smfmac_f32_16x16x64_bf16 v[68:71], v[16:19], a[8:15], v3
v_max_u32 v12, v12, v23
v_cmp_eq_u32 vcc, -1, v12
v_smfmac_f32_16x16x64_bf16 v[72:75], v[16:19], a[16:23], v3
v_smfmac_f32_16x16x64_bf16 v[76:79], v[16:19], v[48:55], v3
s_cbranch_vccnz L_om_75
L_ob_74:
v_smfmac_f32_16x16x64_bf16 v[64:67], v[20:23], a[24:31], v3
s_waitcnt vmcnt(3)
v_max3_u32 v12, v32, v33, v34
v_smfmac_f32_16x16x64_bf16 v[68:71], v[20:23], a[32:39], v3
v_max_u32 v12, v12, v35
v_cmp_eq_u32 vcc, -1, v12
v_smfmac_f32_16x16x64_bf16 v[72:75], v[20:23], a[40:47], v3
v_smfmac_f32_16x16x64_bf16 v[76:79], v[20:23], v[56:63], v3
s_cbranch_vccnz L_om_77
L_ob_76:
v_smfmac_f32_16x16x64_bf16 v[64:67], v[32:35], a[96:103], v3
s_waitcnt vmcnt(2)
v_max3_u32 v12, v36, v37, v38
v_smfmac_f32_16x16x64_bf16 v[68:71], v[32:35], a[104:111], v3
v_max_u32 v12, v12, v39
v_cmp_eq_u32 vcc, -1, v12
v_smfmac_f32_16x16x64_bf16 v[72:75], v[32:35], a[112:119], v3
v_smfmac_f32_16x16x64_bf16 v[76:79], v[32:35], v[96:103], v3
s_cbranch_vccnz L_om_79
L_ob_78:
v_smfmac_f32_16x16x64_bf16 v[64:67], v[36:39], a[120:127], v3
s_waitcnt vmcnt(1)
v_max3_u32 v12, v40, v41, v42
v_smfmac_f32_16x16x64_bf16 v[68:71], v[36:39], a[128:135], v3
v_max_u32 v12, v12, v43
v_cmp_eq_u32 vcc, -1, v12
v_smfmac_f32_16x16x64_bf16 v[72:75], v[36:39], a[136:143], v3
v_smfmac_f32_16x16x64_bf16 v[76:79], v[36:39], v[104:111], v3
s_cbranch_vccnz L_om_81
L_ob_80:
v_smfmac_f32_16x16x64_bf16 v[64:67], v[40:43], a[144:151], v3
s_waitcnt vmcnt(0)
v_max3_u32 v12, v44, v45, v46
v_smfmac_f32_16x16x64_bf16 v[68:71], v[40:43], a[152:159], v3
v_max_u32 v12, v12, v47
v_cmp_eq_u32 vcc, -1, v12
v_smfmac_f32_16x16x64_bf16 v[72:75], v[40:43], a[160:167], v3
v_smfmac_f32_16x16x64_bf16 v[76:79], v[40:43], v[112:119], v3
s_cbranch_vccnz L_om_83
L_ob_82:
v_smfmac_f32_16x16x64_bf16 v[64:67], v[44:47], a[168:175], v3
v_smfmac_f32_16x16x64_bf16 v[68:71], v[44:47], a[176:183], v3
v_smfmac_f32_16x16x64_bf16 v[72:75], v[44:47], a[184:191], v3
v_smfmac_f32_16x16x64_bf16 v[76:79], v[44:47], v[120:127], v3
s_branch L_oj_68
L_oa_66:
buffer_load_dwordx4 v[32:35], v7, s[36:39], s93 offen offset:256 sc1
v_smfmac_f32_16x16x64_bf16 v[64:67], v[16:19], a[0:7], v3
buffer_load_dwordx4 v[36:39], v7, s[36:39], s93 offen offset:1280 sc1
v_smfmac_f32_16x16x64_bf16 v[68:71], v[16:19], a[8:15], v3
buffer_load_dwordx4 v[40:43], v7, s[36:39], s93 offen offset:384 sc1
v_smfmac_f32_16x16x64_bf16 v[72:75], v[16:19], a[16:23], v3
buffer_load_dwordx4 v[44:47], v7, s[36:39], s93 offen offset:1408 sc1
v_smfmac_f32_16x16x64_bf16 v[76:79], v[16:19], v[48:55], v3
v_smfmac_f32_16x16x64_bf16 v[64:67], v[20:23], a[24:31], v3
s_waitcnt vmcnt(5)
v_max3_u32 v12, v24, v25, v26
v_smfmac_f32_16x16x64_bf16 v[68:71], v[20:23], a[32:39], v3
v_max_u32 v12, v12, v27
v_cmp_eq_u32 vcc, -1, v12
v_smfmac_f32_16x16x64_bf16 v[72:75], v[20:23], a[40:47], v3
v_smfmac_f32_16x16x64_bf16 v[76:79], v[20:23], v[56:63], v3
s_cbranch_vccnz L_om_89
L_ob_88:
v_smfmac_f32_16x16x64_bf16 v[64:67], v[24:27], a[48:55], v3
s_waitcnt vmcnt(4)
v_max3_u32 v12, v28, v29, v30
v_smfmac_f32_16x16x64_bf16 v[68:71], v[24:27], a[56:63], v3
v_max_u32 v12, v12, v31
v_cmp_eq_u32 vcc, -1, v12
v_smfmac_f32_16x16x64_bf16 v[72:75], v[24:27], a[64:71], v3
v_smfmac_f32_16x16x64_bf16 v[76:79], v[24:27], v[80:87], v3
s_cbranch_vccnz L_om_91
L_ob_90:
v_smfmac_f32_16x16x64_bf16 v[64:67], v[28:31], a[72:79], v3
s_waitcnt vmcnt(3)
v_max3_u32 v12, v32, v33, v34
v_smfmac_f32_16x16x64_bf16 v[68:71], v[28:31], a[80:87], v3
v_max_u32 v12, v12, v35
v_cmp_eq_u32 vcc, -1, v12
v_smfmac_f32_16x16x64_bf16 v[72:75], v[28:31], a[88:95], v3
v_smfmac_f32_16x16x64_bf16 v[76:79], v[28:31], v[88:95], v3
s_cbranch_vccnz L_om_93
L_ob_92:
v_smfmac_f32_16x16x64_bf16 v[64:67], v[32:35], a[96:103], v3
s_waitcnt vmcnt(2)
v_max3_u32 v12, v36, v37, v38
v_smfmac_f32_16x16x64_bf16 v[68:71], v[32:35], a[104:111], v3
v_max_u32 v12, v12, v39
v_cmp_eq_u32 vcc, -1, v12
v_smfmac_f32_16x16x64_bf16 v[72:75], v[32:35], a[112:119], v3
v_smfmac_f32_16x16x64_bf16 v[76:79], v[32:35], v[96:103], v3
s_cbranch_vccnz L_om_95
L_ob_94:
v_smfmac_f32_16x16x64_bf16 v[64:67], v[36:39], a[120:127], v3
s_waitcnt vmcnt(1)
v_max3_u32 v12, v40, v41, v42
v_smfmac_f32_16x16x64_bf16 v[68:71], v[36:39], a[128:135], v3
v_max_u32 v12, v12, v43
v_cmp_eq_u32 vcc, -1, v12
v_smfmac_f32_16x16x64_bf16 v[72:75], v[36:39], a[136:143], v3
v_smfmac_f32_16x16x64_bf16 v[76:79], v[36:39], v[104:111], v3
s_cbranch_vccnz L_om_97
L_ob_96:
v_smfmac_f32_16x16x64_bf16 v[64:67], v[40:43], a[144:151], v3
s_waitcnt vmcnt(0)
v_max3_u32 v12, v44, v45, v46
v_smfmac_f32_16x16x64_bf16 v[68:71], v[40:43], a[152:159], v3
v_max_u32 v12, v12, v47
v_cmp_eq_u32 vcc, -1, v12
v_smfmac_f32_16x16x64_bf16 v[72:75], v[40:43], a[160:167], v3
v_smfmac_f32_16x16x64_bf16 v[76:79], v[40:43], v[112:119], v3
s_cbranch_vccnz L_om_99
L_ob_98:
v_smfmac_f32_16x16x64_bf16 v[64:67], v[44:47], a[168:175], v3
v_smfmac_f32_16x16x64_bf16 v[68:71], v[44:47], a[176:183], v3
v_smfmac_f32_16x16x64_bf16 v[72:75], v[44:47], a[184:191], v3
v_smfmac_f32_16x16x64_bf16 v[76:79], v[44:47], v[120:127], v3
L_oj_68:
s_nop 4
v_permlane32_swap_b32 v64, v66
v_permlane32_swap_b32 v68, v70
v_add_f32 v16, v64, v66
v_permlane32_swap_b32 v72, v74
v_add_f32 v17, v68, v70
v_permlane32_swap_b32 v76, v78
v_add_f32 v18, v72, v74
v_add_f32 v19, v76, v78
ds_write_b128 v8, v[16:19] offset:0
v_permlane32_swap_b32 v65, v67
v_permlane32_swap_b32 v69, v71
v_add_f32 v20, v65, v67
v_permlane32_swap_b32 v73, v75
v_add_f32 v21, v69, v71
v_permlane32_swap_b32 v77, v79
v_add_f32 v22, v73, v75
v_add_f32 v23, v77, v79
ds_write_b128 v8, v[20:23] offset:288
s_waitcnt lgkmcnt(0)
s_barrier
ds_read_b64 v[64:65], v9 offset:0
ds_read_b64 v[66:67], v9 offset:2304
ds_read_b64 v[68:69], v9 offset:4608
ds_read_b64 v[70:71], v9 offset:6912
s_cmp_lg_u32 s58, 0
s_waitcnt lgkmcnt(2)
v_pk_add_f32 v[64:65], v[64:65], v[66:67]
s_waitcnt lgkmcnt(0)
v_pk_add_f32 v[68:69], v[68:69], v[70:71]
v_pk_add_f32 v[64:65], v[64:65], v[68:69]
v_cvt_pk_bf16_f32 v64, v64, v65
v_min_u32 v64, s54, v64
buffer_store_dword v64, v13, s[36:39], s95 offen sc1
s_cbranch_scc1 L_sl_102
buffer_store_dword v64, v13, s[36:39], s96 offen
L_sd_103:
s_add_u32 s59, s59, 1
s_branch L_vo_top
L_lm_55:
L_lr_104:
buffer_load_dwordx4 v[96:99], v2, s[36:39], s91 offen offset:0 sc1
buffer_load_dwordx4 v[100:103], v2, s[36:39], s91 offen offset:512 sc1
buffer_load_dwordx4 v[104:107], v2, s[36:39], s91 offen offset:128 sc1
buffer_load_dwordx4 v[108:111], v2, s[36:39], s91 offen offset:640 sc1
s_waitcnt vmcnt(0)
v_max3_u32 v12, v96, v97, v98
v_max3_u32 v12, v12, v99, v100
v_max3_u32 v12, v12, v101, v102
v_max3_u32 v12, v12, v103, v104
v_max3_u32 v12, v12, v105, v106
v_max3_u32 v12, v12, v107, v108
v_max3_u32 v12, v12, v109, v110
v_max_u32 v12, v12, v111
v_cmp_eq_u32 vcc, -1, v12
s_cbranch_vccz L_lr_ok_105
s_add_u32 s63, s63, 1
s_cmp_lt_u32 s63, 0x20000
s_cbranch_scc1 L_lr_104
s_branch L_giveup
L_lr_ok_105:
s_branch L_lb_54
L_ra_57:
buffer_load_dwordx4 v[48:51], v2, s[36:39], s92 offen offset:0 sc1
buffer_load_dwordx4 v[52:55], v2, s[36:39], s92 offen offset:512 sc1
buffer_load_dwordx4 v[56:59], v2, s[36:39], s92 offen offset:128 sc1
buffer_load_dwordx4 v[60:63], v2, s[36:39], s92 offen offset:640 sc1
s_add_u32 s63, s63, 1
s_cmp_lt_u32 s63, 0x20000
s_cbranch_scc1 L_rc_56
s_branch L_giveup
L_gm_59:
L_gr_106:
buffer_load_dwordx4 v[52:55], v2, s[36:39], s92 offen offset:512 sc1
buffer_load_dwordx4 v[56:59], v2, s[36:39], s92 offen offset:128 sc1
buffer_load_dwordx4 v[60:63], v2, s[36:39], s92 offen offset:640 sc1
s_waitcnt vmcnt(0)
v_max3_u32 v12, v52, v53, v54
v_max3_u32 v12, v12, v55, v56
v_max3_u32 v12, v12, v57, v58
v_max3_u32 v12, v12, v59, v60
v_max3_u32 v12, v12, v61, v62
v_max_u32 v12, v12, v63
v_cmp_eq_u32 vcc, -1, v12
s_cbranch_vccz L_gr_ok_107
s_add_u32 s63, s63, 1
s_cmp_lt_u32 s63, 0x20000
s_cbranch_scc1 L_gr_106
s_branch L_giveup
L_gr_ok_107:
s_branch L_gb_58
L_gm_61:
L_gr_108:
buffer_load_dwordx4 v[56:59], v2, s[36:39], s92 offen offset:128 sc1
buffer_load_dwordx4 v[60:63], v2, s[36:39], s92 offen offset:640 sc1
s_waitcnt vmcnt(0)
v_max3_u32 v12, v56, v57, v58
v_max3_u32 v12, v12, v59, v60
v_max3_u32 v12, v12, v61, v62
v_max_u32 v12, v12, v63
v_cmp_eq_u32 vcc, -1, v12
s_cbranch_vccz L_gr_ok_109
s_add_u32 s63, s63, 1
s_cmp_lt_u32 s63, 0x20000
s_cbranch_scc1 L_gr_108
s_branch L_giveup
L_gr_ok_109:
s_branch L_gb_60
L_sl_62:
buffer_store_dwordx2 v[16:17], v6, s[36:39], s94 offen sc1
buffer_store_dwordx2 v[14:15], v6, s[36:39], s90 offen sc1
buffer_store_dword v14, v13, s[36:39], s89 offen sc1
s_branch L_sd_63
L_om_73:
L_por_110:
buffer_load_dwordx4 v[16:19], v7, s[36:39], s93 offen offset:0 sc1
buffer_load_dwordx4 v[20:23], v7, s[36:39], s93 offen offset:1024 sc1
buffer_load_dwordx4 v[32:35], v7, s[36:39], s93 offen offset:256 sc1
buffer_load_dwordx4 v[36:39], v7, s[36:39], s93 offen offset:1280 sc1
buffer_load_dwordx4 v[40:43], v7, s[36:39], s93 offen offset:384 sc1
buffer_load_dwordx4 v[44:47], v7, s[36:39], s93 offen offset:1408 sc1
s_waitcnt vmcnt(0)
v_max3_u32 v12, v16, v17, v18
v_max3_u32 v12, v12, v19, v20
v_max3_u32 v12, v12, v21, v22
v_max3_u32 v12, v12, v23, v32
v_max3_u32 v12, v12, v33, v34
v_max3_u32 v12, v12, v35, v36
v_max3_u32 v12, v12, v37, v38
v_max3_u32 v12, v12, v39, v40
v_max3_u32 v12, v12, v41, v42
v_max3_u32 v12, v12, v43, v44
v_max3_u32 v12, v12, v45, v46
v_max_u32 v12, v12, v47
v_cmp_eq_u32 vcc, -1, v12
s_cbranch_vccz L_por_ok_111
s_add_u32 s63, s63, 1
s_cmp_lt_u32 s63, 0x20000
s_cbranch_scc1 L_por_110
s_branch L_giveup
L_por_ok_111:
s_branch L_ob_72
L_om_75:
L_por_112:
buffer_load_dwordx4 v[20:23], v7, s[36:39], s93 offen offset:1024 sc1
buffer_load_dwordx4 v[32:35], v7, s[36:39], s93 offen offset:256 sc1
buffer_load_dwordx4 v[36:39], v7, s[36:39], s93 offen offset:1280 sc1
buffer_load_dwordx4 v[40:43], v7, s[36:39], s93 offen offset:384 sc1
buffer_load_dwordx4 v[44:47], v7, s[36:39], s93 offen offset:1408 sc1
s_waitcnt vmcnt(0)
v_max3_u32 v12, v20, v21, v22
v_max3_u32 v12, v12, v23, v32
v_max3_u32 v12, v12, v33, v34
v_max3_u32 v12, v12, v35, v36
v_max3_u32 v12, v12, v37, v38
v_max3_u32 v12, v12, v39, v40
v_max3_u32 v12, v12, v41, v42
v_max3_u32 v12, v12, v43, v44
v_max3_u32 v12, v12, v45, v46
v_max_u32 v12, v12, v47
v_cmp_eq_u32 vcc, -1, v12
s_cbranch_vccz L_por_ok_113
s_add_u32 s63, s63, 1
s_cmp_lt_u32 s63, 0x20000
s_cbranch_scc1 L_por_112
s_branch L_giveup
L_por_ok_113:
s_branch L_ob_74
L_om_77:
L_por_114:
buffer_load_dwordx4 v[32:35], v7, s[36:39], s93 offen offset:256 sc1
buffer_load_dwordx4 v[36:39], v7, s[36:39], s93 offen offset:1280 sc1
buffer_load_dwordx4 v[40:43], v7, s[36:39], s93 offen offset:384 sc1
buffer_load_dwordx4 v[44:47], v7, s[36:39], s93 offen offset:1408 sc1
s_waitcnt vmcnt(0)
v_max3_u32 v12, v32, v33, v34
v_max3_u32 v12, v12, v35, v36
v_max3_u32 v12, v12, v37, v38
v_max3_u32 v12, v12, v39, v40
v_max3_u32 v12, v12, v41, v42
v_max3_u32 v12, v12, v43, v44
v_max3_u32 v12, v12, v45, v46
v_max_u32 v12, v12, v47
v_cmp_eq_u32 vcc, -1, v12
s_cbranch_vccz L_por_ok_115
s_add_u32 s63, s63, 1
s_cmp_lt_u32 s63, 0x20000
s_cbranch_scc1 L_por_114
s_branch L_giveup
L_por_ok_115:
s_branch L_ob_76
L_om_79:
L_por_116:
buffer_load_dwordx4 v[36:39], v7, s[36:39], s93 offen offset:1280 sc1
buffer_load_dwordx4 v[40:43], v7, s[36:39], s93 offen offset:384 sc1
buffer_load_dwordx4 v[44:47], v7, s[36:39], s93 offen offset:1408 sc1
s_waitcnt vmcnt(0)
v_max3_u32 v12, v36, v37, v38
v_max3_u32 v12, v12, v39, v40
v_max3_u32 v12, v12, v41, v42
v_max3_u32 v12, v12, v43, v44
v_max3_u32 v12, v12, v45, v46
v_max_u32 v12, v12, v47
v_cmp_eq_u32 vcc, -1, v12
s_cbranch_vccz L_por_ok_117
s_add_u32 s63, s63, 1
s_cmp_lt_u32 s63, 0x20000
s_cbranch_scc1 L_por_116
s_branch L_giveup
L_por_ok_117:
s_branch L_ob_78
L_om_81:
L_por_118:
buffer_load_dwordx4 v[40:43], v7, s[36:39], s93 offen offset:384 sc1
buffer_load_dwordx4 v[44:47], v7, s[36:39], s93 offen offset:1408 sc1
s_waitcnt vmcnt(0)
v_max3_u32 v12, v40, v41, v42
v_max3_u32 v12, v12, v43, v44
v_max3_u32 v12, v12, v45, v46
v_max_u32 v12, v12, v47
v_cmp_eq_u32 vcc, -1, v12
s_cbranch_vccz L_por_ok_119
s_add_u32 s63, s63, 1
s_cmp_lt_u32 s63, 0x20000
s_cbranch_scc1 L_por_118
s_branch L_giveup
L_por_ok_119:
s_branch L_ob_80
L_om_83:
L_por_120:
buffer_load_dwordx4 v[44:47], v7, s[36:39], s93 offen offset:1408 sc1
s_waitcnt vmcnt(0)
v_max3_u32 v12, v44, v45, v46
v_max_u32 v12, v12, v47
v_cmp_eq_u32 vcc, -1, v12
s_cbranch_vccz L_por_ok_121
s_add_u32 s63, s63, 1
s_cmp_lt_u32 s63, 0x20000
s_cbranch_scc1 L_por_120
s_branch L_giveup
L_por_ok_121:
s_branch L_ob_82
L_om_89:
L_por_122:
buffer_load_dwordx4 v[24:27], v7, s[36:39], s93 offen offset:128 sc1
buffer_load_dwordx4 v[28:31], v7, s[36:39], s93 offen offset:1152 sc1
buffer_load_dwordx4 v[32:35], v7, s[36:39], s93 offen offset:256 sc1
buffer_load_dwordx4 v[36:39], v7, s[36:39], s93 offen offset:1280 sc1
buffer_load_dwordx4 v[40:43], v7, s[36:39], s93 offen offset:384 sc1
buffer_load_dwordx4 v[44:47], v7, s[36:39], s93 offen offset:1408 sc1
s_waitcnt vmcnt(0)
v_max3_u32 v12, v24, v25, v26
v_max3_u32 v12, v12, v27, v28
v_max3_u32 v12, v12, v29, v30
v_max3_u32 v12, v12, v31, v32
v_max3_u32 v12, v12, v33, v34
v_max3_u32 v12, v12, v35, v36
v_max3_u32 v12, v12, v37, v38
v_max3_u32 v12, v12, v39, v40
v_max3_u32 v12, v12, v41, v42
v_max3_u32 v12, v12, v43, v44
v_max3_u32 v12, v12, v45, v46
v_max_u32 v12, v12, v47
v_cmp_eq_u32 vcc, -1, v12
s_cbranch_vccz L_por_ok_123
s_add_u32 s63, s63, 1
s_cmp_lt_u32 s63, 0x20000
s_cbranch_scc1 L_por_122
s_branch L_giveup
L_por_ok_123:
s_branch L_ob_88
L_om_91:
L_por_124:
buffer_load_dwordx4 v[28:31], v7, s[36:39], s93 offen offset:1152 sc1
buffer_load_dwordx4 v[32:35], v7, s[36:39], s93 offen offset:256 sc1
buffer_load_dwordx4 v[36:39], v7, s[36:39], s93 offen offset:1280 sc1
buffer_load_dwordx4 v[40:43], v7, s[36:39], s93 offen offset:384 sc1
buffer_load_dwordx4 v[44:47], v7, s[36:39], s93 offen offset:1408 sc1
s_waitcnt vmcnt(0)
v_max3_u32 v12, v28, v29, v30
v_max3_u32 v12, v12, v31, v32
v_max3_u32 v12, v12, v33, v34
v_max3_u32 v12, v12, v35, v36
v_max3_u32 v12, v12, v37, v38
v_max3_u32 v12, v12, v39, v40
v_max3_u32 v12, v12, v41, v42
v_max3_u32 v12, v12, v43, v44
v_max3_u32 v12, v12, v45, v46
v_max_u32 v12, v12, v47
v_cmp_eq_u32 vcc, -1, v12
s_cbranch_vccz L_por_ok_125
s_add_u32 s63, s63, 1
s_cmp_lt_u32 s63, 0x20000
s_cbranch_scc1 L_por_124
s_branch L_giveup
L_por_ok_125:
s_branch L_ob_90
L_om_93:
L_por_126:
buffer_load_dwordx4 v[32:35], v7, s[36:39], s93 offen offset:256 sc1
buffer_load_dwordx4 v[36:39], v7, s[36:39], s93 offen offset:1280 sc1
buffer_load_dwordx4 v[40:43], v7, s[36:39], s93 offen offset:384 sc1
buffer_load_dwordx4 v[44:47], v7, s[36:39], s93 offen offset:1408 sc1
s_waitcnt vmcnt(0)
v_max3_u32 v12, v32, v33, v34
v_max3_u32 v12, v12, v35, v36
v_max3_u32 v12, v12, v37, v38
v_max3_u32 v12, v12, v39, v40
v_max3_u32 v12, v12, v41, v42
v_max3_u32 v12, v12, v43, v44
v_max3_u32 v12, v12, v45, v46
v_max_u32 v12, v12, v47
v_cmp_eq_u32 vcc, -1, v12
s_cbranch_vccz L_por_ok_127
s_add_u32 s63, s63, 1
s_cmp_lt_u32 s63, 0x20000
s_cbranch_scc1 L_por_126
s_branch L_giveup
L_por_ok_127:
s_branch L_ob_92
L_om_95:
L_por_128:
buffer_load_dwordx4 v[36:39], v7, s[36:39], s93 offen offset:1280 sc1
buffer_load_dwordx4 v[40:43], v7, s[36:39], s93 offen offset:384 sc1
buffer_load_dwordx4 v[44:47], v7, s[36:39], s93 offen offset:1408 sc1
s_waitcnt vmcnt(0)
v_max3_u32 v12, v36, v37, v38
v_max3_u32 v12, v12, v39, v40
v_max3_u32 v12, v12, v41, v42
v_max3_u32 v12, v12, v43, v44
v_max3_u32 v12, v12, v45, v46
v_max_u32 v12, v12, v47
v_cmp_eq_u32 vcc, -1, v12
s_cbranch_vccz L_por_ok_129
s_add_u32 s63, s63, 1
s_cmp_lt_u32 s63, 0x20000
s_cbranch_scc1 L_por_128
s_branch L_giveup
L_por_ok_129:
s_branch L_ob_94
L_om_97:
L_por_130:
buffer_load_dwordx4 v[40:43], v7, s[36:39], s93 offen offset:384 sc1
buffer_load_dwordx4 v[44:47], v7, s[36:39], s93 offen offset:1408 sc1
s_waitcnt vmcnt(0)
v_max3_u32 v12, v40, v41, v42
v_max3_u32 v12, v12, v43, v44
v_max3_u32 v12, v12, v45, v46
v_max_u32 v12, v12, v47
v_cmp_eq_u32 vcc, -1, v12
s_cbranch_vccz L_por_ok_131
s_add_u32 s63, s63, 1
s_cmp_lt_u32 s63, 0x20000
s_cbranch_scc1 L_por_130
s_branch L_giveup
L_por_ok_131:
s_branch L_ob_96
L_om_99:
L_por_132:
buffer_load_dwordx4 v[44:47], v7, s[36:39], s93 offen offset:1408 sc1
s_waitcnt vmcnt(0)
v_max3_u32 v12, v44, v45, v46
v_max_u32 v12, v12, v47
v_cmp_eq_u32 vcc, -1, v12
s_cbranch_vccz L_por_ok_133
s_add_u32 s63, s63, 1
s_cmp_lt_u32 s63, 0x20000
s_cbranch_scc1 L_por_132
s_branch L_giveup
L_por_ok_133:
s_branch L_ob_98
L_sl_102:
buffer_store_dword v64, v13, s[36:39], s96 offen sc1
s_branch L_sd_103
L_role_wo:
s_and_b32 s80, s57, 1
s_bfe_u32 s81, s57, 0x10005
s_lshl_b32 s81, s81, 3
s_bfe_u32 s64, s57, 0x30001
s_add_u32 s81, s81, s64
s_mov_b32 s44, s18
s_and_b32 s45, s19, 0xffff
s_mov_b32 s46, 0x800000
s_mov_b32 s47, 0x20000
s_lshl_b32 s82, s80, 2
s_add_u32 s82, s82, s56
v_lshrrev_b32 v20, 3, v0
v_lshlrev_b32 v20, 11, v20
v_and_b32 v21, 7, v0
v_lshl_add_u32 v20, v21, 4, v20
s_mul_i32 s64, s82, 1048576
s_lshl_b32 s65, s81, 7
s_add_u32 s64, s64, s65
v_add_u32 v20, s64, v20
v_lshrrev_b32 v22, 5, v0
v_bfe_u32 v21, v0, 2, 2
v_lshlrev_b32 v21, 7, v21
v_lshl_add_u32 v21, v22, 10, v21
v_bfe_u32 v23, v0, 4, 1
v_lshl_add_u32 v21, v23, 6, v21
v_and_b32 v23, 3, v0
v_lshl_add_u32 v21, v23, 4, v21
s_mul_i32 s83, s56, 40960
v_add_u32 v21, s83, v21
s_lshl_b32 s64, s57, 7
s_lshl_b32 s65, s56, 2
s_add_u32 s64, s64, s65
v_mov_b32 v3, 0x7fff0000
v_mov_b32 v255, s64
v_cmp_eq_u32 vcc, 0, v0
s_nop 1
v_cndmask_b32 v3, v3, v255, vcc
v_lshlrev_b32 v2, 4, v0
s_lshl_b32 s64, s82, 16
v_add_u32 v5, s64, v2
s_lshl_b32 s64, s80, 5
s_mul_i32 s65, s56, 4
s_add_u32 s64, s64, s65
v_lshrrev_b32 v24, 2, v0
v_min_u32 v24, 3, v24
v_add_u32 v24, s64, v24
v_lshlrev_b32 v24, 7, v24
v_and_b32 v4, 3, v0
v_lshl_add_u32 v4, v4, 2, v24
v_and_b32 v23, 31, v0
v_lshlrev_b32 v24, 10, v22
v_lshl_add_u32 v24, v23, 4, v24
s_lshl_b32 s64, s56, 13
v_add_u32 v6, s64, v24
s_lshl_b32 s64, s56, 11
v_add_u32 v7, s64, v24
s_lshl_b32 s65, s81, 13
s_add_u32 s64, s64, s65
v_add_u32 v8, s64, v24
s_lshr_b32 s64, s64, 10
v_add_u32 v25, s64, v22
v_lshlrev_b32 v26, 4, v23
v_lshl_add_u32 v10, v25, 9, v26
v_and_b32 v27, 0xe000, v10
v_add_u32 v10, v27, v10
v_lshlrev_b32 v26, 11, v23
v_lshl_add_u32 v11, v25, 4, v26
s_lshr_b32 s88, s56, 1
s_xor_b32 s88, s88, s80
v_lshlrev_b32 v9, 2, v0
s_lshl_b32 s96, s81, 2
s_add_u32 s96, s96, s56
s_lshl_b32 s96, s96, 8
s_add_u32 s96, s96, 0xb400000
s_mov_b32 s48, s8
s_and_b32 s49, s9, 0xffff
s_mov_b32 s50, 0x400000
s_mov_b32 s51, 0x20000
s_cmp_lg_u32 s57, 64
s_cbranch_scc1 L_ts_134
s_mov_b64 exec, 1
s_lshl_b32 s64, s56, 8
s_add_u32 s64, s64, 0x8000
v_mov_b32 v30, s64
s_mov_b32 s86, -1
s_mov_b32 s87, -1
s_mov_b32 s89, 0
L_tt_135:
s_memtime s[64:65]
s_waitcnt lgkmcnt(0)
buffer_store_dword v30, v30, s[36:39], 0 offen sc1
s_waitcnt vmcnt(0)
s_memtime s[66:67]
v_xor_b32 v30, 0x200000, v30
s_waitcnt lgkmcnt(0)
s_sub_u32 s64, s66, s64
s_min_u32 s86, s86, s64
s_memtime s[64:65]
s_waitcnt lgkmcnt(0)
buffer_store_dword v30, v30, s[36:39], 0 offen sc1
s_waitcnt vmcnt(0)
s_memtime s[66:67]
v_xor_b32 v30, 0x200000, v30
s_waitcnt lgkmcnt(0)
s_sub_u32 s64, s66, s64
s_min_u32 s87, s87, s64
s_add_u32 s89, s89, 1
s_cmp_lt_u32 s89, 7
s_cbranch_scc1 L_tt_135
s_lshl_b32 s64, s56, 3
v_mov_b32 v30, s64
v_mov_b32 v32, s86
v_mov_b32 v33, s87
ds_write_b64 v30, v[32:33]
s_waitcnt lgkmcnt(0)
s_barrier
s_cmp_lg_u32 s56, 0
s_cbranch_scc1 L_td_136
ds_read_b128 v[32:35], v30
ds_read_b128 v[36:39], v30 offset:16
s_waitcnt lgkmcnt(0)
v_min3_u32 v32, v32, v34, v36
v_min3_u32 v33, v33, v35, v37
v_min_u32 v32, v32, v38
v_min_u32 v33, v33, v39
v_cmp_le_u32 vcc, v32, v33
s_nop 1
v_cndmask_b32 v30, 2, 1, vcc
v_mov_b32 v31, 8
buffer_store_dword v30, v31, s[40:43], 0 offen sc1
L_td_136:
s_mov_b64 exec, -1
s_barrier
L_ts_134:
s_cmp_lg_u32 s62, 0
s_cbranch_scc1 L_cd_137
v_mbcnt_lo_u32_b32 v17, -1, 0
v_mbcnt_hi_u32_b32 v17, -1, v17
v_lshlrev_b32 v17, 2, v17
L_ct_138:
buffer_load_dword v18, v17, s[40:43], 0 offen sc1
s_mov_b32 s64, 0x10001000
s_mov_b32 s65, 0x10001000
s_waitcnt vmcnt(0)
v_cmp_ne_u32 vcc, 64, v18
s_nop 0
s_and_b64 s[64:65], s[64:65], vcc
s_cbranch_scc0 L_co_139
s_sleep 12
s_add_u32 s63, s63, 1
s_cmp_lt_u32 s63, 0x20000
s_cbranch_scc1 L_ct_138
s_branch L_giveup
L_co_139:
v_cmp_ne_u32 vcc, 32, v18
s_mov_b32 s64, 0x110011
s_mov_b32 s65, 0x110011
s_and_b64 s[64:65], s[64:65], vcc
s_cbranch_scc1 L_recensus
L_sd_140:
v_readlane_b32 s64, v18, 2
s_nop 0
s_cmp_lg_u32 s64, 0
s_cbranch_scc1 L_sk_141
s_sleep 4
buffer_load_dword v18, v17, s[40:43], 0 offen sc1
s_waitcnt vmcnt(0)
s_add_u32 s63, s63, 1
s_cmp_lt_u32 s63, 0x20000
s_cbranch_scc1 L_sd_140
s_branch L_giveup
L_sk_141:
s_cmp_eq_u32 s64, 2
s_cselect_b32 s64, 0x200000, 0
s_add_u32 s64, s64, 0x6000
s_add_u32 s36, s34, s64
s_addc_u32 s37, s35, 0
s_and_b32 s37, s37, 0xffff
L_cd_137:
s_cmp_eq_u32 s88, 0
s_cbranch_scc1 L_rx_142
v_mov_b32 v56, -1
v_mov_b32 v57, -1
v_mov_b32 v58, -1
v_mov_b32 v59, -1
s_mov_b32 s64, 0xb600000
buffer_store_dwordx4 v[56:59], v8, s[36:39], s64 offen offset:0 sc1
buffer_store_dwordx4 v[56:59], v8, s[36:39], s64 offen offset:512 sc1
s_mov_b32 s64, 0xb620000
buffer_store_dwordx4 v[56:59], v8, s[36:39], s64 offen offset:0 sc1
buffer_store_dwordx4 v[56:59], v8, s[36:39], s64 offen offset:512 sc1
s_mov_b32 s64, 0xb640000
buffer_store_dwordx4 v[56:59], v8, s[36:39], s64 offen offset:0 sc1
buffer_store_dwordx4 v[56:59], v8, s[36:39], s64 offen offset:512 sc1
s_mov_b32 s64, 0xb660000
buffer_store_dwordx4 v[56:59], v8, s[36:39], s64 offen offset:0 sc1
buffer_store_dwordx4 v[56:59], v8, s[36:39], s64 offen offset:512 sc1
v_mov_b32 v48, 1
s_waitcnt vmcnt(0)
buffer_store_dword v48, v3, s[36:39], 0 offen offset:64 sc1
L_rx_142:
v_mov_b32 v30, 0
s_mov_b32 s86, 1
L_late_143:
buffer_load_dword v31, v30, s[36:39], 0 offen sc1
s_waitcnt vmcnt(0)
v_cmp_gt_u32 vcc, s86, v31
s_cbranch_vccz L_late_ok_144
s_sleep 24
s_add_u32 s63, s63, 1
s_cmp_lt_u32 s63, 0x20000
s_cbranch_scc1 L_late_143
s_branch L_giveup
L_late_ok_144:
s_add_u32 m0, s83, 0
s_mov_b32 s64, 0x0
buffer_load_dwordx4 v20, s[44:47], s64 offen nt lds
s_add_u32 m0, s83, 1024
s_mov_b32 s64, 0x4000
buffer_load_dwordx4 v20, s[44:47], s64 offen nt lds
s_add_u32 m0, s83, 2048
s_mov_b32 s64, 0x8000
buffer_load_dwordx4 v20, s[44:47], s64 offen nt lds
s_add_u32 m0, s83, 3072
s_mov_b32 s64, 0xc000
buffer_load_dwordx4 v20, s[44:47], s64 offen nt lds
s_add_u32 m0, s83, 4096
s_mov_b32 s64, 0x10000
buffer_load_dwordx4 v20, s[44:47], s64 offen nt lds
s_add_u32 m0, s83, 5120
s_mov_b32 s64, 0x14000
buffer_load_dwordx4 v20, s[44:47], s64 offen nt lds
s_waitcnt vmcnt(4)
ds_read_b64_tr_b16 a[0:1], v21 offset:0
ds_read_b64_tr_b16 a[2:3], v21 offset:512
ds_read_b64_tr_b16 a[4:5], v21 offset:8
ds_read_b64_tr_b16 a[6:7], v21 offset:520
s_waitcnt vmcnt(2)
ds_read_b64_tr_b16 a[8:9], v21 offset:2048
ds_read_b64_tr_b16 a[10:11], v21 offset:2560
ds_read_b64_tr_b16 a[12:13], v21 offset:2056
ds_read_b64_tr_b16 a[14:15], v21 offset:2568
s_waitcnt lgkmcnt(4)
s_add_u32 m0, s83, 0
s_mov_b32 s64, 0x18000
buffer_load_dwordx4 v20, s[44:47], s64 offen nt lds
s_add_u32 m0, s83, 1024
s_mov_b32 s64, 0x1c000
buffer_load_dwordx4 v20, s[44:47], s64 offen nt lds
s_waitcnt vmcnt(2)
ds_read_b64_tr_b16 a[16:17], v21 offset:4096
ds_read_b64_tr_b16 a[18:19], v21 offset:4608
ds_read_b64_tr_b16 a[20:21], v21 offset:4104
ds_read_b64_tr_b16 a[22:23], v21 offset:4616
s_waitcnt lgkmcnt(4)
s_add_u32 m0, s83, 2048
s_mov_b32 s64, 0x20000
buffer_load_dwordx4 v20, s[44:47], s64 offen nt lds
s_add_u32 m0, s83, 3072
s_mov_b32 s64, 0x24000
buffer_load_dwordx4 v20, s[44:47], s64 offen nt lds
s_waitcnt vmcnt(2)
ds_read_b64_tr_b16 a[24:25], v21 offset:0
ds_read_b64_tr_b16 a[26:27], v21 offset:512
ds_read_b64_tr_b16 a[28:29], v21 offset:8
ds_read_b64_tr_b16 a[30:31], v21 offset:520
s_waitcnt lgkmcnt(4)
s_add_u32 m0, s83, 4096
s_mov_b32 s64, 0x28000
buffer_load_dwordx4 v20, s[44:47], s64 offen nt lds
s_add_u32 m0, s83, 5120
s_mov_b32 s64, 0x2c000
buffer_load_dwordx4 v20, s[44:47], s64 offen nt lds
s_waitcnt vmcnt(2)
ds_read_b64_tr_b16 a[32:33], v21 offset:2048
ds_read_b64_tr_b16 a[34:35], v21 offset:2560
ds_read_b64_tr_b16 a[36:37], v21 offset:2056
ds_read_b64_tr_b16 a[38:39], v21 offset:2568
s_waitcnt lgkmcnt(4)
s_add_u32 m0, s83, 0
s_mov_b32 s64, 0x30000
buffer_load_dwordx4 v20, s[44:47], s64 offen nt lds
s_add_u32 m0, s83, 1024
s_mov_b32 s64, 0x34000
buffer_load_dwordx4 v20, s[44:47], s64 offen nt lds
s_waitcnt vmcnt(2)
ds_read_b64_tr_b16 a[40:41], v21 offset:4096
ds_read_b64_tr_b16 a[42:43], v21 offset:4608
ds_read_b64_tr_b16 a[44:45], v21 offset:4104
ds_read_b64_tr_b16 a[46:47], v21 offset:4616
s_waitcnt lgkmcnt(4)
s_add_u32 m0, s83, 2048
s_mov_b32 s64, 0x38000
buffer_load_dwordx4 v20, s[44:47], s64 offen nt lds
s_add_u32 m0, s83, 3072
s_mov_b32 s64, 0x3c000
buffer_load_dwordx4 v20, s[44:47], s64 offen nt lds
s_waitcnt vmcnt(2)
ds_read_b64_tr_b16 a[48:49], v21 offset:0
ds_read_b64_tr_b16 a[50:51], v21 offset:512
ds_read_b64_tr_b16 a[52:53], v21 offset:8
ds_read_b64_tr_b16 a[54:55], v21 offset:520
s_waitcnt lgkmcnt(4)
s_add_u32 m0, s83, 4096
s_mov_b32 s64, 0x40000
buffer_load_dwordx4 v20, s[44:47], s64 offen nt lds
s_add_u32 m0, s83, 5120
s_mov_b32 s64, 0x44000
buffer_load_dwordx4 v20, s[44:47], s64 offen nt lds
s_waitcnt vmcnt(2)
ds_read_b64_tr_b16 a[56:57], v21 offset:2048
ds_read_b64_tr_b16 a[58:59], v21 offset:2560
ds_read_b64_tr_b16 a[60:61], v21 offset:2056
ds_read_b64_tr_b16 a[62:63], v21 offset:2568
s_waitcnt lgkmcnt(4)
s_add_u32 m0, s83, 0
s_mov_b32 s64, 0x48000
buffer_load_dwordx4 v20, s[44:47], s64 offen nt lds
s_add_u32 m0, s83, 1024
s_mov_b32 s64, 0x4c000
buffer_load_dwordx4 v20, s[44:47], s64 offen nt lds
s_waitcnt vmcnt(2)
ds_read_b64_tr_b16 a[64:65], v21 offset:4096
ds_read_b64_tr_b16 a[66:67], v21 offset:4608
ds_read_b64_tr_b16 a[68:69], v21 offset:4104
ds_read_b64_tr_b16 a[70:71], v21 offset:4616
s_waitcnt lgkmcnt(4)
s_add_u32 m0, s83, 2048
s_mov_b32 s64, 0x50000
buffer_load_dwordx4 v20, s[44:47], s64 offen nt lds
s_add_u32 m0, s83, 3072
s_mov_b32 s64, 0x54000
buffer_load_dwordx4 v20, s[44:47], s64 offen nt lds
s_waitcnt vmcnt(2)
ds_read_b64_tr_b16 a[72:73], v21 offset:0
ds_read_b64_tr_b16 a[74:75], v21 offset:512
ds_read_b64_tr_b16 a[76:77], v21 offset:8
ds_read_b64_tr_b16 a[78:79], v21 offset:520
s_waitcnt lgkmcnt(4)
s_add_u32 m0, s83, 4096
s_mov_b32 s64, 0x58000
buffer_load_dwordx4 v20, s[44:47], s64 offen nt lds
s_add_u32 m0, s83, 5120
s_mov_b32 s64, 0x5c000
buffer_load_dwordx4 v20, s[44:47], s64 offen nt lds
s_waitcnt vmcnt(2)
ds_read_b64_tr_b16 a[80:81], v21 offset:2048
ds_read_b64_tr_b16 a[82:83], v21 offset:2560
ds_read_b64_tr_b16 a[84:85], v21 offset:2056
ds_read_b64_tr_b16 a[86:87], v21 offset:2568
s_waitcnt lgkmcnt(4)
s_add_u32 m0, s83, 0
s_mov_b32 s64, 0x60000
buffer_load_dwordx4 v20, s[44:47], s64 offen nt lds
s_add_u32 m0, s83, 1024
s_mov_b32 s64, 0x64000
buffer_load_dwordx4 v20, s[44:47], s64 offen nt lds
s_waitcnt vmcnt(2)
ds_read_b64_tr_b16 a[88:89], v21 offset:4096
ds_read_b64_tr_b16 a[90:91], v21 offset:4608
ds_read_b64_tr_b16 a[92:93], v21 offset:4104
ds_read_b64_tr_b16 a[94:95], v21 offset:4616
s_waitcnt lgkmcnt(4)
s_add_u32 m0, s83, 2048
s_mov_b32 s64, 0x68000
buffer_load_dwordx4 v20, s[44:47], s64 offen nt lds
s_add_u32 m0, s83, 3072
s_mov_b32 s64, 0x6c000
buffer_load_dwordx4 v20, s[44:47], s64 offen nt lds
s_waitcnt vmcnt(2)
ds_read_b64_tr_b16 a[96:97], v21 offset:0
ds_read_b64_tr_b16 a[98:99], v21 offset:512
ds_read_b64_tr_b16 a[100:101], v21 offset:8
ds_read_b64_tr_b16 a[102:103], v21 offset:520
s_waitcnt lgkmcnt(4)
s_add_u32 m0, s83, 4096
s_mov_b32 s64, 0x70000
buffer_load_dwordx4 v20, s[44:47], s64 offen nt lds
s_add_u32 m0, s83, 5120
s_mov_b32 s64, 0x74000
buffer_load_dwordx4 v20, s[44:47], s64 offen nt lds
s_waitcnt vmcnt(2)
ds_read_b64_tr_b16 a[104:105], v21 offset:2048
ds_read_b64_tr_b16 a[106:107], v21 offset:2560
ds_read_b64_tr_b16 a[108:109], v21 offset:2056
ds_read_b64_tr_b16 a[110:111], v21 offset:2568
s_waitcnt lgkmcnt(4)
s_add_u32 m0, s83, 0
s_mov_b32 s64, 0x78000
buffer_load_dwordx4 v20, s[44:47], s64 offen nt lds
s_add_u32 m0, s83, 1024
s_mov_b32 s64, 0x7c000
buffer_load_dwordx4 v20, s[44:47], s64 offen nt lds
s_waitcnt vmcnt(2)
ds_read_b64_tr_b16 a[112:113], v21 offset:4096
ds_read_b64_tr_b16 a[114:115], v21 offset:4608
ds_read_b64_tr_b16 a[116:117], v21 offset:4104
ds_read_b64_tr_b16 a[118:119], v21 offset:4616
s_waitcnt lgkmcnt(4)
s_add_u32 m0, s83, 2048
s_mov_b32 s64, 0x80000
buffer_load_dwordx4 v20, s[44:47], s64 offen nt lds
s_add_u32 m0, s83, 3072
s_mov_b32 s64, 0x84000
buffer_load_dwordx4 v20, s[44:47], s64 offen nt lds
s_waitcnt vmcnt(2)
ds_read_b64_tr_b16 a[120:121], v21 offset:0
ds_read_b64_tr_b16 a[122:123], v21 offset:512
ds_read_b64_tr_b16 a[124:125], v21 offset:8
ds_read_b64_tr_b16 a[126:127], v21 offset:520
s_waitcnt lgkmcnt(4)
s_add_u32 m0, s83, 4096
s_mov_b32 s64, 0x88000
buffer_load_dwordx4 v20, s[44:47], s64 offen nt lds
s_add_u32 m0, s83, 5120
s_mov_b32 s64, 0x8c000
buffer_load_dwordx4 v20, s[44:47], s64 offen nt lds
s_waitcnt vmcnt(2)
ds_read_b64_tr_b16 a[128:129], v21 offset:2048
ds_read_b64_tr_b16 a[130:131], v21 offset:2560
ds_read_b64_tr_b16 a[132:133], v21 offset:2056
ds_read_b64_tr_b16 a[134:135], v21 offset:2568
s_waitcnt lgkmcnt(4)
s_add_u32 m0, s83, 0
s_mov_b32 s64, 0x90000
buffer_load_dwordx4 v20, s[44:47], s64 offen nt lds
s_add_u32 m0, s83, 1024
s_mov_b32 s64, 0x94000
buffer_load_dwordx4 v20, s[44:47], s64 offen nt lds
s_waitcnt vmcnt(2)
ds_read_b64_tr_b16 a[136:137], v21 offset:4096
ds_read_b64_tr_b16 a[138:139], v21 offset:4608
ds_read_b64_tr_b16 a[140:141], v21 offset:4104
ds_read_b64_tr_b16 a[142:143], v21 offset:4616
s_waitcnt lgkmcnt(4)
s_add_u32 m0, s83, 2048
s_mov_b32 s64, 0x98000
buffer_load_dwordx4 v20, s[44:47], s64 offen nt lds
s_add_u32 m0, s83, 3072
s_mov_b32 s64, 0x9c000
buffer_load_dwordx4 v20, s[44:47], s64 offen nt lds
s_waitcnt vmcnt(2)
ds_read_b64_tr_b16 a[144:145], v21 offset:0
ds_read_b64_tr_b16 a[146:147], v21 offset:512
ds_read_b64_tr_b16 a[148:149], v21 offset:8
ds_read_b64_tr_b16 a[150:151], v21 offset:520
s_waitcnt lgkmcnt(4)
s_add_u32 m0, s83, 4096
s_mov_b32 s64, 0xa0000
buffer_load_dwordx4 v20, s[44:47], s64 offen nt lds
s_add_u32 m0, s83, 5120
s_mov_b32 s64, 0xa4000
buffer_load_dwordx4 v20, s[44:47], s64 offen nt lds
s_waitcnt vmcnt(2)
ds_read_b64_tr_b16 a[152:153], v21 offset:2048
ds_read_b64_tr_b16 a[154:155], v21 offset:2560
ds_read_b64_tr_b16 a[156:157], v21 offset:2056
ds_read_b64_tr_b16 a[158:159], v21 offset:2568
s_waitcnt lgkmcnt(4)
s_add_u32 m0, s83, 0
s_mov_b32 s64, 0xa8000
buffer_load_dwordx4 v20, s[44:47], s64 offen nt lds
s_add_u32 m0, s83, 1024
s_mov_b32 s64, 0xac000
buffer_load_dwordx4 v20, s[44:47], s64 offen nt lds
s_waitcnt vmcnt(2)
ds_read_b64_tr_b16 a[160:161], v21 offset:4096
ds_read_b64_tr_b16 a[162:163], v21 offset:4608
ds_read_b64_tr_b16 a[164:165], v21 offset:4104
ds_read_b64_tr_b16 a[166:167], v21 offset:4616
s_waitcnt lgkmcnt(4)
s_add_u32 m0, s83, 2048
s_mov_b32 s64, 0xb0000
buffer_load_dwordx4 v20, s[44:47], s64 offen nt lds
s_add_u32 m0, s83, 3072
s_mov_b32 s64, 0xb4000
buffer_load_dwordx4 v20, s[44:47], s64 offen nt lds
s_waitcnt vmcnt(2)
ds_read_b64_tr_b16 a[168:169], v21 offset:0
ds_read_b64_tr_b16 a[170:171], v21 offset:512
ds_read_b64_tr_b16 a[172:173], v21 offset:8
ds_read_b64_tr_b16 a[174:175], v21 offset:520
s_waitcnt lgkmcnt(4)
s_add_u32 m0, s83, 4096
s_mov_b32 s64, 0xb8000
buffer_load_dwordx4 v20, s[44:47], s64 offen nt lds
s_add_u32 m0, s83, 5120
s_mov_b32 s64, 0xbc000
buffer_load_dwordx4 v20, s[44:47], s64 offen nt lds
s_waitcnt vmcnt(2)
ds_read_b64_tr_b16 a[176:177], v21 offset:2048
ds_read_b64_tr_b16 a[178:179], v21 offset:2560
ds_read_b64_tr_b16 a[180:181], v21 offset:2056
ds_read_b64_tr_b16 a[182:183], v21 offset:2568
s_waitcnt lgkmcnt(4)
s_add_u32 m0, s83, 0
s_mov_b32 s64, 0xc0000
buffer_load_dwordx4 v20, s[44:47], s64 offen nt lds
s_add_u32 m0, s83, 1024
s_mov_b32 s64, 0xc4000
buffer_load_dwordx4 v20, s[44:47], s64 offen nt lds
s_waitcnt vmcnt(2)
ds_read_b64_tr_b16 a[184:185], v21 offset:4096
ds_read_b64_tr_b16 a[186:187], v21 offset:4608
ds_read_b64_tr_b16 a[188:189], v21 offset:4104
ds_read_b64_tr_b16 a[190:191], v21 offset:4616
s_waitcnt lgkmcnt(4)
s_add_u32 m0, s83, 2048
s_mov_b32 s64, 0xc8000
buffer_load_dwordx4 v20, s[44:47], s64 offen nt lds
s_add_u32 m0, s83, 3072
s_mov_b32 s64, 0xcc000
buffer_load_dwordx4 v20, s[44:47], s64 offen nt lds
s_waitcnt vmcnt(2)
ds_read_b64_tr_b16 a[192:193], v21 offset:0
ds_read_b64_tr_b16 a[194:195], v21 offset:512
ds_read_b64_tr_b16 a[196:197], v21 offset:8
ds_read_b64_tr_b16 a[198:199], v21 offset:520
s_waitcnt lgkmcnt(4)
s_add_u32 m0, s83, 4096
s_mov_b32 s64, 0xd0000
buffer_load_dwordx4 v20, s[44:47], s64 offen nt lds
s_add_u32 m0, s83, 5120
s_mov_b32 s64, 0xd4000
buffer_load_dwordx4 v20, s[44:47], s64 offen nt lds
s_waitcnt vmcnt(2)
ds_read_b64_tr_b16 a[200:201], v21 offset:2048
ds_read_b64_tr_b16 a[202:203], v21 offset:2560
ds_read_b64_tr_b16 a[204:205], v21 offset:2056
ds_read_b64_tr_b16 a[206:207], v21 offset:2568
s_waitcnt lgkmcnt(4)
s_add_u32 m0, s83, 0
s_mov_b32 s64, 0xd8000
buffer_load_dwordx4 v20, s[44:47], s64 offen nt lds
s_add_u32 m0, s83, 1024
s_mov_b32 s64, 0xdc000
buffer_load_dwordx4 v20, s[44:47], s64 offen nt lds
s_waitcnt vmcnt(2)
ds_read_b64_tr_b16 a[208:209], v21 offset:4096
ds_read_b64_tr_b16 a[210:211], v21 offset:4608
ds_read_b64_tr_b16 a[212:213], v21 offset:4104
ds_read_b64_tr_b16 a[214:215], v21 offset:4616
s_waitcnt lgkmcnt(4)
s_add_u32 m0, s83, 2048
s_mov_b32 s64, 0xe0000
buffer_load_dwordx4 v20, s[44:47], s64 offen nt lds
s_add_u32 m0, s83, 3072
s_mov_b32 s64, 0xe4000
buffer_load_dwordx4 v20, s[44:47], s64 offen nt lds
s_waitcnt vmcnt(2)
ds_read_b64_tr_b16 a[216:217], v21 offset:0
ds_read_b64_tr_b16 a[218:219], v21 offset:512
ds_read_b64_tr_b16 a[220:221], v21 offset:8
ds_read_b64_tr_b16 a[222:223], v21 offset:520
s_waitcnt lgkmcnt(4)
s_add_u32 m0, s83, 4096
s_mov_b32 s64, 0xe8000
buffer_load_dwordx4 v20, s[44:47], s64 offen nt lds
s_add_u32 m0, s83, 5120
s_mov_b32 s64, 0xec000
buffer_load_dwordx4 v20, s[44:47], s64 offen nt lds
s_waitcnt vmcnt(2)
ds_read_b64_tr_b16 a[224:225], v21 offset:2048
ds_read_b64_tr_b16 a[226:227], v21 offset:2560
ds_read_b64_tr_b16 a[228:229], v21 offset:2056
ds_read_b64_tr_b16 a[230:231], v21 offset:2568
s_waitcnt lgkmcnt(4)
s_add_u32 m0, s83, 0
s_mov_b32 s64, 0xf0000
buffer_load_dwordx4 v20, s[44:47], s64 offen nt lds
s_add_u32 m0, s83, 1024
s_mov_b32 s64, 0xf4000
buffer_load_dwordx4 v20, s[44:47], s64 offen nt lds
s_waitcnt vmcnt(2)
ds_read_b64_tr_b16 a[232:233], v21 offset:4096
ds_read_b64_tr_b16 a[234:235], v21 offset:4608
ds_read_b64_tr_b16 a[236:237], v21 offset:4104
ds_read_b64_tr_b16 a[238:239], v21 offset:4616
s_waitcnt lgkmcnt(4)
s_add_u32 m0, s83, 2048
s_mov_b32 s64, 0xf8000
buffer_load_dwordx4 v20, s[44:47], s64 offen nt lds
s_add_u32 m0, s83, 3072
s_mov_b32 s64, 0xfc000
buffer_load_dwordx4 v20, s[44:47], s64 offen nt lds
s_waitcnt vmcnt(2)
ds_read_b64_tr_b16 a[240:241], v21 offset:0
ds_read_b64_tr_b16 a[242:243], v21 offset:512
ds_read_b64_tr_b16 a[244:245], v21 offset:8
ds_read_b64_tr_b16 a[246:247], v21 offset:520
s_waitcnt vmcnt(0)
ds_read_b64_tr_b16 a[248:249], v21 offset:2048
ds_read_b64_tr_b16 a[250:251], v21 offset:2560
ds_read_b64_tr_b16 a[252:253], v21 offset:2056
ds_read_b64_tr_b16 a[254:255], v21 offset:2568
s_waitcnt lgkmcnt(0)
s_xor_b32 s64, s57, 1
s_lshl_b32 s64, s64, 7
s_lshl_b32 s65, s56, 2
s_add_u32 s64, s64, s65
s_add_u32 s64, s64, 64
v_mov_b32 v30, s64
s_cmp_eq_u32 s88, 0
s_cselect_b32 s86, 1, 0
L_rxw_145:
buffer_load_dword v31, v30, s[36:39], 0 offen sc1
s_waitcnt vmcnt(0)
v_cmp_gt_u32 vcc, s86, v31
s_cbranch_vccz L_rxw_ok_146
s_add_u32 s63, s63, 1
s_cmp_lt_u32 s63, 0x20000
s_cbranch_scc1 L_rxw_145
s_branch L_giveup
L_rxw_ok_146:
s_barrier
s_mov_b32 s59, 0
s_mov_b32 s84, 0x8ffc000
s_mov_b32 s92, 0
s_mov_b32 s93, 0
L_wo_wait:
s_add_u32 s86, s59, 1
buffer_load_dword v48, v4, s[36:39], 0 offen sc1
s_waitcnt vmcnt(0)
v_mov_b32 v49, s59
buffer_store_dword v49, v3, s[36:39], 0 offen sc1
s_mov_b32 s93, s59
s_cmp_eq_u32 s59, 64
s_cbranch_scc1 L_end
s_waitcnt vmcnt(1)
v_cmp_gt_u32 vcc, s86, v48
s_cbranch_vccz L_fp_ok_148
L_fp_147:
buffer_load_dword v48, v4, s[36:39], 0 offen sc1
s_waitcnt vmcnt(0)
v_cmp_gt_u32 vcc, s86, v48
s_cbranch_vccz L_fp_ok_148
s_add_u32 s63, s63, 1
s_cmp_lt_u32 s63, 0x20000
s_cbranch_scc1 L_fp_147
s_branch L_giveup
L_fp_ok_148:
L_wo_go:
s_add_u32 s97, s84, 0
buffer_load_dwordx4 v[64:67], v5, s[36:39], s97 offen offset:0 sc1
buffer_load_dwordx4 v[68:71], v5, s[36:39], s97 offen offset:1024 sc1
buffer_load_dwordx4 v[72:75], v5, s[36:39], s97 offen offset:2048 sc1
buffer_load_dwordx4 v[76:79], v5, s[36:39], s97 offen offset:3072 sc1
s_add_u32 s97, s84, 4096
buffer_load_dwordx4 v[80:83], v5, s[36:39], s97 offen offset:0 sc1
buffer_load_dwordx4 v[84:87], v5, s[36:39], s97 offen offset:1024 sc1
buffer_load_dwordx4 v[88:91], v5, s[36:39], s97 offen offset:2048 sc1
buffer_load_dwordx4 v[92:95], v5, s[36:39], s97 offen offset:3072 sc1
s_add_u32 s97, s84, 16384
buffer_load_dwordx4 v[96:99], v5, s[36:39], s97 offen offset:0 sc1
buffer_load_dwordx4 v[100:103], v5, s[36:39], s97 offen offset:1024 sc1
buffer_load_dwordx4 v[104:107], v5, s[36:39], s97 offen offset:2048 sc1
buffer_load_dwordx4 v[108:111], v5, s[36:39], s97 offen offset:3072 sc1
L_wo_top:
s_lshl_b32 s64, s59, 16
buffer_load_dwordx4 v[52:55], v11, s[48:51], s64 offen
buffer_load_dword v48, v4, s[36:39], 0 offen sc1
s_add_u32 s86, s59, 2
s_and_b32 s85, s59, 3
s_lshl_b32 s85, s85, 17
s_xor_b32 s91, s85, 0x40000
s_add_u32 s85, s85, 0xb600000
s_add_u32 s91, s91, 0xb600000
s_waitcnt vmcnt(13)
v_mfma_f32_32x32x16_bf16 v[16:31], a[0:3], v[64:67], 0
s_add_u32 s97, s84, 20480
buffer_load_dwordx4 v[112:115], v5, s[36:39], s97 offen offset:0 sc1
v_mfma_f32_32x32x16_bf16 v[32:47], a[4:7], v[64:67], 0
s_waitcnt vmcnt(13)
v_mfma_f32_32x32x16_bf16 v[16:31], a[8:11], v[68:71], v[16:31]
buffer_load_dwordx4 v[116:119], v5, s[36:39], s97 offen offset:1024 sc1
v_mfma_f32_32x32x16_bf16 v[32:47], a[12:15], v[68:71], v[32:47]
s_waitcnt vmcnt(13)
v_mfma_f32_32x32x16_bf16 v[16:31], a[16:19], v[72:75], v[16:31]
buffer_load_dwordx4 v[120:123], v5, s[36:39], s97 offen offset:2048 sc1
v_mfma_f32_32x32x16_bf16 v[32:47], a[20:23], v[72:75], v[32:47]
s_waitcnt vmcnt(13)
v_mfma_f32_32x32x16_bf16 v[16:31], a[24:27], v[76:79], v[16:31]
buffer_load_dwordx4 v[124:127], v5, s[36:39], s97 offen offset:3072 sc1
v_mfma_f32_32x32x16_bf16 v[32:47], a[28:31], v[76:79], v[32:47]
s_waitcnt vmcnt(13)
v_mfma_f32_32x32x16_bf16 v[16:31], a[32:35], v[80:83], v[16:31]
s_add_u32 s97, s84, 32768
buffer_load_dwordx4 v[128:131], v5, s[36:39], s97 offen offset:0 sc1
v_mfma_f32_32x32x16_bf16 v[32:47], a[36:39], v[80:83], v[32:47]
s_waitcnt vmcnt(13)
v_mfma_f32_32x32x16_bf16 v[16:31], a[40:43], v[84:87], v[16:31]
buffer_load_dwordx4 v[132:135], v5, s[36:39], s97 offen offset:1024 sc1
v_mfma_f32_32x32x16_bf16 v[32:47], a[44:47], v[84:87], v[32:47]
s_waitcnt vmcnt(13)
v_mfma_f32_32x32x16_bf16 v[16:31], a[48:51], v[88:91], v[16:31]
buffer_load_dwordx4 v[136:139], v5, s[36:39], s97 offen offset:2048 sc1
v_mfma_f32_32x32x16_bf16 v[32:47], a[52:55], v[88:91], v[32:47]
s_cmp_eq_u32 s93, s92
s_cbranch_scc1 L_told_149
s_waitcnt vmcnt(9)
v_mov_b32 v49, s92
buffer_store_dword v49, v3, s[36:39], 0 offen sc1
s_mov_b32 s93, s92
L_told_149:
s_waitcnt vmcnt(13)
v_mfma_f32_32x32x16_bf16 v[16:31], a[56:59], v[92:95], v[16:31]
buffer_load_dwordx4 v[140:143], v5, s[36:39], s97 offen offset:3072 sc1
v_mfma_f32_32x32x16_bf16 v[32:47], a[60:63], v[92:95], v[32:47]
s_waitcnt vmcnt(13)
v_mfma_f32_32x32x16_bf16 v[16:31], a[64:67], v[96:99], v[16:31]
s_add_u32 s97, s84, 36864
buffer_load_dwordx4 v[144:147], v5, s[36:39], s97 offen offset:0 sc1
v_mfma_f32_32x32x16_bf16 v[32:47], a[68:71], v[96:99], v[32:47]
s_waitcnt vmcnt(13)
v_mfma_f32_32x32x16_bf16 v[16:31], a[72:75], v[100:103], v[16:31]
buffer_load_dwordx4 v[148:151], v5, s[36:39], s97 offen offset:1024 sc1
v_mfma_f32_32x32x16_bf16 v[32:47], a[76:79], v[100:103], v[32:47]
s_waitcnt vmcnt(13)
v_mfma_f32_32x32x16_bf16 v[16:31], a[80:83], v[104:107], v[16:31]
buffer_load_dwordx4 v[152:155], v5, s[36:39], s97 offen offset:2048 sc1
v_mfma_f32_32x32x16_bf16 v[32:47], a[84:87], v[104:107], v[32:47]
s_waitcnt vmcnt(13)
v_mfma_f32_32x32x16_bf16 v[16:31], a[88:91], v[108:111], v[16:31]
buffer_load_dwordx4 v[156:159], v5, s[36:39], s97 offen offset:3072 sc1
v_mfma_f32_32x32x16_bf16 v[32:47], a[92:95], v[108:111], v[32:47]
s_waitcnt vmcnt(11)
v_mfma_f32_32x32x16_bf16 v[16:31], a[96:99], v[112:115], v[16:31]
s_add_u32 s97, s84, 49152
buffer_load_dwordx4 v[160:163], v5, s[36:39], s97 offen offset:0 sc1
v_mfma_f32_32x32x16_bf16 v[32:47], a[100:103], v[112:115], v[32:47]
s_waitcnt vmcnt(11)
v_mfma_f32_32x32x16_bf16 v[16:31], a[104:107], v[116:119], v[16:31]
buffer_load_dwordx4 v[164:167], v5, s[36:39], s97 offen offset:1024 sc1
v_mfma_f32_32x32x16_bf16 v[32:47], a[108:111], v[116:119], v[32:47]
s_waitcnt vmcnt(11)
v_mfma_f32_32x32x16_bf16 v[16:31], a[112:115], v[120:123], v[16:31]
buffer_load_dwordx4 v[168:171], v5, s[36:39], s97 offen offset:2048 sc1
v_mfma_f32_32x32x16_bf16 v[32:47], a[116:119], v[120:123], v[32:47]
s_waitcnt vmcnt(11)
v_mfma_f32_32x32x16_bf16 v[16:31], a[120:123], v[124:127], v[16:31]
buffer_load_dwordx4 v[172:175], v5, s[36:39], s97 offen offset:3072 sc1
v_mfma_f32_32x32x16_bf16 v[32:47], a[124:127], v[124:127], v[32:47]
s_waitcnt vmcnt(11)
v_mfma_f32_32x32x16_bf16 v[16:31], a[128:131], v[128:131], v[16:31]
s_add_u32 s97, s84, 53248
buffer_load_dwordx4 v[176:179], v5, s[36:39], s97 offen offset:0 sc1
v_mfma_f32_32x32x16_bf16 v[32:47], a[132:135], v[128:131], v[32:47]
s_waitcnt vmcnt(11)
v_mfma_f32_32x32x16_bf16 v[16:31], a[136:139], v[132:135], v[16:31]
buffer_load_dwordx4 v[180:183], v5, s[36:39], s97 offen offset:1024 sc1
v_mfma_f32_32x32x16_bf16 v[32:47], a[140:143], v[132:135], v[32:47]
v_cmp_gt_u32 vcc, s86, v48
s_waitcnt vmcnt(11)
v_mfma_f32_32x32x16_bf16 v[16:31], a[144:147], v[136:139], v[16:31]
buffer_load_dwordx4 v[184:187], v5, s[36:39], s97 offen offset:2048 sc1
v_mfma_f32_32x32x16_bf16 v[32:47], a[148:151], v[136:139], v[32:47]
s_waitcnt vmcnt(11)
v_mfma_f32_32x32x16_bf16 v[16:31], a[152:155], v[140:143], v[16:31]
buffer_load_dwordx4 v[188:191], v5, s[36:39], s97 offen offset:3072 sc1
v_mfma_f32_32x32x16_bf16 v[32:47], a[156:159], v[140:143], v[32:47]
s_add_u32 s64, s59, 1
s_lshl_b32 s84, s64, 19
s_lshl_b32 s64, s64, 11
s_and_b32 s64, s64, 0x2000
s_add_u32 s84, s84, s64
s_add_u32 s84, s84, 0x8ffc000
s_cmp_eq_u64 vcc, 0
s_cselect_b32 s87, 1, 0
s_cselect_b32 s90, s84, 0x7fff0000
s_waitcnt vmcnt(11)
v_mfma_f32_32x32x16_bf16 v[16:31], a[160:163], v[144:147], v[16:31]
s_add_u32 s97, s90, 0
buffer_load_dwordx4 v[64:67], v5, s[36:39], s97 offen offset:0 sc1
v_mfma_f32_32x32x16_bf16 v[32:47], a[164:167], v[144:147], v[32:47]
s_waitcnt vmcnt(11)
v_mfma_f32_32x32x16_bf16 v[16:31], a[168:171], v[148:151], v[16:31]
buffer_load_dwordx4 v[68:71], v5, s[36:39], s97 offen offset:1024 sc1
v_mfma_f32_32x32x16_bf16 v[32:47], a[172:175], v[148:151], v[32:47]
s_waitcnt vmcnt(11)
v_mfma_f32_32x32x16_bf16 v[16:31], a[176:179], v[152:155], v[16:31]
buffer_load_dwordx4 v[72:75], v5, s[36:39], s97 offen offset:2048 sc1
v_mfma_f32_32x32x16_bf16 v[32:47], a[180:183], v[152:155], v[32:47]
s_waitcnt vmcnt(11)
v_mfma_f32_32x32x16_bf16 v[16:31], a[184:187], v[156:159], v[16:31]
buffer_load_dwordx4 v[76:79], v5, s[36:39], s97 offen offset:3072 sc1
v_mfma_f32_32x32x16_bf16 v[32:47], a[188:191], v[156:159], v[32:47]
s_waitcnt vmcnt(11)
v_mfma_f32_32x32x16_bf16 v[16:31], a[192:195], v[160:163], v[16:31]
s_add_u32 s97, s90, 4096
buffer_load_dwordx4 v[80:83], v5, s[36:39], s97 offen offset:0 sc1
v_mfma_f32_32x32x16_bf16 v[32:47], a[196:199], v[160:163], v[32:47]
s_waitcnt vmcnt(11)
v_mfma_f32_32x32x16_bf16 v[16:31], a[200:203], v[164:167], v[16:31]
buffer_load_dwordx4 v[84:87], v5, s[36:39], s97 offen offset:1024 sc1
v_mfma_f32_32x32x16_bf16 v[32:47], a[204:207], v[164:167], v[32:47]
buffer_load_dword v51, v4, s[36:39], 0 offen sc1
s_waitcnt vmcnt(11)
v_mfma_f32_32x32x16_bf16 v[16:31], a[208:211], v[168:171], v[16:31]
buffer_load_dwordx4 v[88:91], v5, s[36:39], s97 offen offset:2048 sc1
v_mfma_f32_32x32x16_bf16 v[32:47], a[212:215], v[168:171], v[32:47]
s_waitcnt vmcnt(11)
v_mfma_f32_32x32x16_bf16 v[16:31], a[216:219], v[172:175], v[16:31]
buffer_load_dwordx4 v[92:95], v5, s[36:39], s97 offen offset:3072 sc1
v_mfma_f32_32x32x16_bf16 v[32:47], a[220:223], v[172:175], v[32:47]
s_waitcnt vmcnt(11)
v_mfma_f32_32x32x16_bf16 v[16:31], a[224:227], v[176:179], v[16:31]
s_add_u32 s97, s90, 16384
buffer_load_dwordx4 v[96:99], v5, s[36:39], s97 offen offset:0 sc1
v_mfma_f32_32x32x16_bf16 v[32:47], a[228:231], v[176:179], v[32:47]
s_waitcnt vmcnt(11)
v_mfma_f32_32x32x16_bf16 v[16:31], a[232:235], v[180:183], v[16:31]
buffer_load_dwordx4 v[100:103], v5, s[36:39], s97 offen offset:1024 sc1
v_mfma_f32_32x32x16_bf16 v[32:47], a[236:239], v[180:183], v[32:47]
s_waitcnt vmcnt(11)
v_mfma_f32_32x32x16_bf16 v[16:31], a[240:243], v[184:187], v[16:31]
buffer_load_dwordx4 v[104:107], v5, s[36:39], s97 offen offset:2048 sc1
v_mfma_f32_32x32x16_bf16 v[32:47], a[244:247], v[184:187], v[32:47]
s_waitcnt vmcnt(11)
v_mfma_f32_32x32x16_bf16 v[16:31], a[248:251], v[188:191], v[16:31]
buffer_load_dwordx4 v[108:111], v5, s[36:39], s97 offen offset:3072 sc1
v_mfma_f32_32x32x16_bf16 v[32:47], a[252:255], v[188:191], v[32:47]
buffer_load_dword v48, v4, s[36:39], 0 offen sc1
s_nop 8
ds_write_b128 v6, v[16:19] offset:0
ds_write_b128 v6, v[20:23] offset:2048
ds_write_b128 v6, v[24:27] offset:4096
ds_write_b128 v6, v[28:31] offset:6144
ds_write_b128 v6, v[32:35] offset:512
ds_write_b128 v6, v[36:39] offset:2560
ds_write_b128 v6, v[40:43] offset:4608
ds_write_b128 v6, v[44:47] offset:6656
s_waitcnt lgkmcnt(0)
s_barrier
ds_read_b128 v[16:19], v7 offset:0
ds_read_b128 v[20:23], v7 offset:8192
ds_read_b128 v[24:27], v7 offset:16384
ds_read_b128 v[28:31], v7 offset:24576
ds_read_b128 v[32:35], v7 offset:512
ds_read_b128 v[36:39], v7 offset:8704
ds_read_b128 v[40:43], v7 offset:16896
ds_read_b128 v[44:47], v7 offset:25088
s_waitcnt lgkmcnt(4)
v_pk_add_f32 v[16:17], v[16:17], v[20:21]
v_pk_add_f32 v[18:19], v[18:19], v[22:23]
v_pk_add_f32 v[24:25], v[24:25], v[28:29]
v_pk_add_f32 v[26:27], v[26:27], v[30:31]
v_pk_add_f32 v[16:17], v[16:17], v[24:25]
v_pk_add_f32 v[18:19], v[18:19], v[26:27]
s_waitcnt lgkmcnt(0)
v_pk_add_f32 v[32:33], v[32:33], v[36:37]
v_pk_add_f32 v[34:35], v[34:35], v[38:39]
v_pk_add_f32 v[40:41], v[40:41], v[44:45]
v_pk_add_f32 v[42:43], v[42:43], v[46:47]
v_pk_add_f32 v[32:33], v[32:33], v[40:41]
v_pk_add_f32 v[34:35], v[34:35], v[42:43]
v_xor_b32 v6, 0x8000, v6
v_xor_b32 v7, 0x8000, v7
s_cmp_eq_u32 s88, 0
s_cbranch_scc1 L_fin_150
v_min_u32 v16, s54, v16
v_min_u32 v17, s54, v17
v_min_u32 v18, s54, v18
v_min_u32 v19, s54, v19
v_min_u32 v32, s54, v32
v_min_u32 v33, s54, v33
v_min_u32 v34, s54, v34
v_min_u32 v35, s54, v35
v_mov_b32 v56, -1
v_mov_b32 v57, -1
v_mov_b32 v58, -1
v_mov_b32 v59, -1
s_cmp_lg_u32 s58, 0
s_cbranch_scc1 L_sl_152
buffer_store_dwordx4 v[16:19], v8, s[36:39], s85 offen offset:0
buffer_store_dwordx4 v[32:35], v8, s[36:39], s85 offen offset:512
buffer_store_dwordx4 v[56:59], v8, s[36:39], s91 offen offset:0
buffer_store_dwordx4 v[56:59], v8, s[36:39], s91 offen offset:512
s_branch L_sd_153
L_sl_152:
buffer_store_dwordx4 v[16:19], v8, s[36:39], s85 offen offset:0 sc1
buffer_store_dwordx4 v[32:35], v8, s[36:39], s85 offen offset:512 sc1
buffer_store_dwordx4 v[56:59], v8, s[36:39], s91 offen offset:0 sc1
buffer_store_dwordx4 v[56:59], v8, s[36:39], s91 offen offset:512 sc1
L_sd_153:
s_add_u32 s92, s92, 1
s_cmp_lg_u32 s87, 0
s_cbranch_scc1 L_np_154
s_waitcnt vmcnt(4)
v_cmp_gt_u32 vcc, s86, v48
s_cbranch_vccnz L_np_154
s_add_u32 s97, s84, 0
buffer_load_dwordx4 v[64:67], v5, s[36:39], s97 offen offset:0 sc1
buffer_load_dwordx4 v[68:71], v5, s[36:39], s97 offen offset:1024 sc1
buffer_load_dwordx4 v[72:75], v5, s[36:39], s97 offen offset:2048 sc1
buffer_load_dwordx4 v[76:79], v5, s[36:39], s97 offen offset:3072 sc1
s_add_u32 s97, s84, 4096
buffer_load_dwordx4 v[80:83], v5, s[36:39], s97 offen offset:0 sc1
buffer_load_dwordx4 v[84:87], v5, s[36:39], s97 offen offset:1024 sc1
buffer_load_dwordx4 v[88:91], v5, s[36:39], s97 offen offset:2048 sc1
buffer_load_dwordx4 v[92:95], v5, s[36:39], s97 offen offset:3072 sc1
s_add_u32 s97, s84, 16384
buffer_load_dwordx4 v[96:99], v5, s[36:39], s97 offen offset:0 sc1
buffer_load_dwordx4 v[100:103], v5, s[36:39], s97 offen offset:1024 sc1
buffer_load_dwordx4 v[104:107], v5, s[36:39], s97 offen offset:2048 sc1
buffer_load_dwordx4 v[108:111], v5, s[36:39], s97 offen offset:3072 sc1
s_mov_b32 s87, 1
L_np_154:
s_branch L_join_151
L_fin_150:
s_mov_b32 s95, s85
v_lshlrev_b32 v192, 16, v52
v_and_b32 v193, 0xffff0000, v52
v_pk_add_f32 v[192:193], v[192:193], v[16:17]
v_lshlrev_b32 v194, 16, v53
v_and_b32 v195, 0xffff0000, v53
v_pk_add_f32 v[194:195], v[194:195], v[18:19]
v_lshlrev_b32 v196, 16, v54
v_and_b32 v197, 0xffff0000, v54
v_pk_add_f32 v[196:197], v[196:197], v[32:33]
v_lshlrev_b32 v198, 16, v55
v_and_b32 v199, 0xffff0000, v55
v_pk_add_f32 v[198:199], v[198:199], v[34:35]
buffer_load_dwordx4 v[56:59], v8, s[36:39], s95 offen offset:0 sc1
buffer_load_dwordx4 v[60:63], v8, s[36:39], s95 offen offset:512 sc1
s_waitcnt vmcnt(0)
v_max3_u32 v50, v56, v57, v58
v_max3_u32 v50, v50, v59, v60
v_max3_u32 v50, v50, v61, v62
v_max_u32 v50, v50, v63
v_cmp_eq_u32 vcc, -1, v50
s_cbranch_vccz L_got_155
L_px_156:
buffer_load_dwordx4 v[56:59], v8, s[36:39], s95 offen offset:0 sc1
buffer_load_dwordx4 v[60:63], v8, s[36:39], s95 offen offset:512 sc1
s_waitcnt vmcnt(0)
v_max3_u32 v50, v56, v57, v58
v_max3_u32 v50, v50, v59, v60
v_max3_u32 v50, v50, v61, v62
v_max_u32 v50, v50, v63
v_cmp_eq_u32 vcc, -1, v50
s_cbranch_vccz L_px_ok_157
s_add_u32 s63, s63, 1
s_cmp_lt_u32 s63, 0x20000
s_cbranch_scc1 L_px_156
s_branch L_giveup
L_px_ok_157:
L_got_155:
s_lshl_b32 s64, s92, 16
v_pk_add_f32 v[192:193], v[192:193], v[56:57]
v_cvt_pk_bf16_f32 v56, v192, v193
v_pk_add_f32 v[194:195], v[194:195], v[58:59]
v_cvt_pk_bf16_f32 v57, v194, v195
v_pk_add_f32 v[196:197], v[196:197], v[60:61]
v_cvt_pk_bf16_f32 v58, v196, v197
v_pk_add_f32 v[198:199], v[198:199], v[62:63]
v_cvt_pk_bf16_f32 v59, v198, v199
s_lshl_b32 s65, s92, 9
s_and_b32 s65, s65, 0x2000
s_lshl_b32 s66, s92, 17
s_add_u32 s66, s66, s65
s_add_u32 s66, s66, 0xd7fa000
buffer_store_dwordx4 v[56:59], v10, s[36:39], s66 offen sc1
v_lshlrev_b32 v192, 16, v56
v_and_b32 v193, 0xffff0000, v56
v_lshlrev_b32 v194, 16, v57
v_and_b32 v195, 0xffff0000, v57
v_lshlrev_b32 v196, 16, v58
v_and_b32 v197, 0xffff0000, v58
v_lshlrev_b32 v198, 16, v59
v_and_b32 v199, 0xffff0000, v59
v_pk_mul_f32 v[62:63], v[192:193], v[192:193]
v_pk_fma_f32 v[62:63], v[194:195], v[194:195], v[62:63]
v_pk_add_f32 v[192:193], v[192:193], v[194:195]
v_pk_fma_f32 v[62:63], v[196:197], v[196:197], v[62:63]
v_pk_add_f32 v[192:193], v[192:193], v[196:197]
v_pk_fma_f32 v[62:63], v[198:199], v[198:199], v[62:63]
v_pk_add_f32 v[192:193], v[192:193], v[198:199]
v_add_f32 v192, v192, v193
v_add_f32 v193, v62, v63
s_lshr_b32 s64, s64, 2
s_add_u32 s64, s64, s96
v_permlane32_swap_b32 v192, v193
v_add_f32 v192, v192, v193
buffer_store_dword v192, v9, s[36:39], s64 offen sc1
s_add_u32 s92, s92, 1
L_join_151:
s_add_u32 s59, s59, 1
s_cmp_lg_u32 s87, 0
s_cbranch_scc1 L_wo_top
s_cmp_eq_u32 s59, 64
s_cbranch_scc1 L_wo_last
s_waitcnt vmcnt(2)
v_cmp_gt_u32 vcc, s86, v48
s_cbranch_vccz L_wo_go
s_branch L_wo_wait
L_wo_last:
s_waitcnt vmcnt(0)
v_mov_b32 v49, s59
buffer_store_dword v49, v3, s[36:39], 0 offen sc1
s_endpgm
L_role_f2:
s_and_b32 s80, s57, 1
s_bfe_u32 s81, s57, 0x10005
s_lshl_b32 s81, s81, 3
s_bfe_u32 s64, s57, 0x30001
s_add_u32 s81, s81, s64
s_mov_b32 s44, s28
s_and_b32 s45, s29, 0xffff
s_mov_b32 s46, 0x700000
s_mov_b32 s47, 0x20000
s_lshl_b32 s82, s80, 2
s_add_u32 s82, s82, s56
v_lshrrev_b32 v20, 3, v0
v_lshlrev_b32 v20, 11, v20
v_and_b32 v21, 7, v0
v_lshl_add_u32 v20, v21, 4, v20
s_mul_i32 s64, s82, 917504
s_lshl_b32 s65, s81, 7
s_add_u32 s64, s64, s65
v_add_u32 v20, s64, v20
v_lshrrev_b32 v22, 5, v0
v_bfe_u32 v21, v0, 2, 2
v_lshlrev_b32 v21, 7, v21
v_lshl_add_u32 v21, v22, 9, v21
v_bfe_u32 v23, v0, 4, 1
v_lshl_add_u32 v21, v23, 6, v21
v_and_b32 v23, 3, v0
v_lshl_add_u32 v21, v23, 4, v21
s_mul_i32 s83, s56, 40960
v_add_u32 v21, s83, v21
s_lshl_b32 s64, s57, 7
s_lshl_b32 s65, s56, 2
s_add_u32 s64, s64, s65
v_mov_b32 v3, 0x7fff0000
v_mov_b32 v255, s64
v_cmp_eq_u32 vcc, 0, v0
s_nop 1
v_cndmask_b32 v3, v3, v255, vcc
v_lshlrev_b32 v2, 4, v0
v_mov_b32 v5, v2
s_mul_i32 s64, s82, 7
s_add_u32 s64, s64, 0
s_lshr_b32 s65, s64, 1
s_lshl_b32 s65, s65, 14
s_and_b32 s64, s64, 1
s_lshl_b32 s64, s64, 12
s_add_u32 s20, s64, s65
s_mul_i32 s64, s82, 7
s_add_u32 s64, s64, 1
s_lshr_b32 s65, s64, 1
s_lshl_b32 s65, s65, 14
s_and_b32 s64, s64, 1
s_lshl_b32 s64, s64, 12
s_add_u32 s21, s64, s65
s_mul_i32 s64, s82, 7
s_add_u32 s64, s64, 2
s_lshr_b32 s65, s64, 1
s_lshl_b32 s65, s65, 14
s_and_b32 s64, s64, 1
s_lshl_b32 s64, s64, 12
s_add_u32 s22, s64, s65
s_mul_i32 s64, s82, 7
s_add_u32 s64, s64, 3
s_lshr_b32 s65, s64, 1
s_lshl_b32 s65, s65, 14
s_and_b32 s64, s64, 1
s_lshl_b32 s64, s64, 12
s_add_u32 s23, s64, s65
s_mul_i32 s64, s82, 7
s_add_u32 s64, s64, 4
s_lshr_b32 s65, s64, 1
s_lshl_b32 s65, s65, 14
s_and_b32 s64, s64, 1
s_lshl_b32 s64, s64, 12
s_add_u32 s6, s64, s65
s_mul_i32 s64, s82, 7
s_add_u32 s64, s64, 5
s_lshr_b32 s65, s64, 1
s_lshl_b32 s65, s65, 14
s_and_b32 s64, s64, 1
s_lshl_b32 s64, s64, 12
s_add_u32 s7, s64, s65
s_mul_i32 s64, s82, 7
s_add_u32 s64, s64, 6
s_lshr_b32 s65, s64, 1
s_lshl_b32 s65, s65, 14
s_and_b32 s64, s64, 1
s_lshl_b32 s64, s64, 12
s_add_u32 s3, s64, s65
s_lshl_b32 s64, s80, 5
s_mul_i32 s65, s56, 7
s_add_u32 s64, s64, s65
s_add_u32 s64, s64, 192
v_lshrrev_b32 v24, 2, v0
v_min_u32 v24, 6, v24
v_add_u32 v24, s64, v24
v_lshlrev_b32 v24, 7, v24
v_and_b32 v4, 3, v0
v_lshl_add_u32 v4, v4, 2, v24
v_and_b32 v23, 31, v0
v_lshlrev_b32 v24, 10, v22
v_lshl_add_u32 v24, v23, 4, v24
s_lshl_b32 s64, s56, 13
v_add_u32 v6, s64, v24
s_lshl_b32 s64, s56, 11
v_add_u32 v7, s64, v24
s_lshl_b32 s65, s81, 13
s_add_u32 s64, s64, s65
v_add_u32 v8, s64, v24
s_lshr_b32 s64, s64, 10
v_add_u32 v25, s64, v22
v_lshlrev_b32 v26, 4, v23
v_lshl_add_u32 v10, v25, 9, v26
v_and_b32 v27, 0xe000, v10
v_add_u32 v10, v27, v10
v_lshlrev_b32 v26, 11, v23
v_lshl_add_u32 v11, v25, 4, v26
s_lshr_b32 s88, s56, 1
s_xor_b32 s88, s88, s80
v_lshlrev_b32 v9, 2, v0
s_lshl_b32 s96, s81, 2
s_add_u32 s96, s96, s56
s_lshl_b32 s96, s96, 8
s_add_u32 s96, s96, 0xb400000
s_mov_b32 s48, s30
s_and_b32 s49, s31, 0xffff
s_mov_b32 s50, 0x400000
s_mov_b32 s51, 0x20000
s_cmp_lg_u32 s62, 0
s_cbranch_scc1 L_cd_158
v_mbcnt_lo_u32_b32 v17, -1, 0
v_mbcnt_hi_u32_b32 v17, -1, v17
v_lshlrev_b32 v17, 2, v17
L_ct_159:
buffer_load_dword v18, v17, s[40:43], 0 offen sc1
s_mov_b32 s64, 0x10001000
s_mov_b32 s65, 0x10001000
s_waitcnt vmcnt(0)
v_cmp_ne_u32 vcc, 64, v18
s_nop 0
s_and_b64 s[64:65], s[64:65], vcc
s_cbranch_scc0 L_co_160
s_sleep 12
s_add_u32 s63, s63, 1
s_cmp_lt_u32 s63, 0x20000
s_cbranch_scc1 L_ct_159
s_branch L_giveup
L_co_160:
v_cmp_ne_u32 vcc, 32, v18
s_mov_b32 s64, 0x110011
s_mov_b32 s65, 0x110011
s_and_b64 s[64:65], s[64:65], vcc
s_cbranch_scc1 L_recensus
L_sd_161:
v_readlane_b32 s64, v18, 2
s_nop 0
s_cmp_lg_u32 s64, 0
s_cbranch_scc1 L_sk_162
s_sleep 4
buffer_load_dword v18, v17, s[40:43], 0 offen sc1
s_waitcnt vmcnt(0)
s_add_u32 s63, s63, 1
s_cmp_lt_u32 s63, 0x20000
s_cbranch_scc1 L_sd_161
s_branch L_giveup
L_sk_162:
s_cmp_eq_u32 s64, 2
s_cselect_b32 s64, 0x200000, 0
s_add_u32 s64, s64, 0x6000
s_add_u32 s36, s34, s64
s_addc_u32 s37, s35, 0
s_and_b32 s37, s37, 0xffff
L_cd_158:
s_cmp_eq_u32 s88, 0
s_cbranch_scc1 L_rx_163
v_mov_b32 v56, -1
v_mov_b32 v57, -1
v_mov_b32 v58, -1
v_mov_b32 v59, -1
s_mov_b32 s64, 0xb680000
buffer_store_dwordx4 v[56:59], v8, s[36:39], s64 offen offset:0 sc1
buffer_store_dwordx4 v[56:59], v8, s[36:39], s64 offen offset:512 sc1
s_mov_b32 s64, 0xb6a0000
buffer_store_dwordx4 v[56:59], v8, s[36:39], s64 offen offset:0 sc1
buffer_store_dwordx4 v[56:59], v8, s[36:39], s64 offen offset:512 sc1
s_mov_b32 s64, 0xb6c0000
buffer_store_dwordx4 v[56:59], v8, s[36:39], s64 offen offset:0 sc1
buffer_store_dwordx4 v[56:59], v8, s[36:39], s64 offen offset:512 sc1
s_mov_b32 s64, 0xb6e0000
buffer_store_dwordx4 v[56:59], v8, s[36:39], s64 offen offset:0 sc1
buffer_store_dwordx4 v[56:59], v8, s[36:39], s64 offen offset:512 sc1
v_mov_b32 v48, 1
s_waitcnt vmcnt(0)
buffer_store_dword v48, v3, s[36:39], 0 offen offset:64 sc1
L_rx_163:
v_mov_b32 v30, 0
s_mov_b32 s86, 1
L_late_164:
buffer_load_dword v31, v30, s[36:39], 0 offen sc1
s_waitcnt vmcnt(0)
v_cmp_gt_u32 vcc, s86, v31
s_cbranch_vccz L_late_ok_165
s_sleep 24
s_add_u32 s63, s63, 1
s_cmp_lt_u32 s63, 0x20000
s_cbranch_scc1 L_late_164
s_branch L_giveup
L_late_ok_165:
s_add_u32 m0, s83, 0
s_mov_b32 s64, 0x0
buffer_load_dwordx4 v20, s[44:47], s64 offen nt lds
s_add_u32 m0, s83, 1024
s_mov_b32 s64, 0x4000
buffer_load_dwordx4 v20, s[44:47], s64 offen nt lds
s_add_u32 m0, s83, 2048
s_mov_b32 s64, 0x8000
buffer_load_dwordx4 v20, s[44:47], s64 offen nt lds
s_add_u32 m0, s83, 3072
s_mov_b32 s64, 0xc000
buffer_load_dwordx4 v20, s[44:47], s64 offen nt lds
s_add_u32 m0, s83, 4096
s_mov_b32 s64, 0x10000
buffer_load_dwordx4 v20, s[44:47], s64 offen nt lds
s_add_u32 m0, s83, 5120
s_mov_b32 s64, 0x14000
buffer_load_dwordx4 v20, s[44:47], s64 offen nt lds
s_waitcnt vmcnt(4)
ds_read_b64_tr_b16 a[0:1], v21 offset:0
ds_read_b64_tr_b16 a[2:3], v21 offset:1024
ds_read_b64_tr_b16 a[4:5], v21 offset:8
ds_read_b64_tr_b16 a[6:7], v21 offset:1032
s_waitcnt vmcnt(2)
ds_read_b64_tr_b16 a[8:9], v21 offset:2048
ds_read_b64_tr_b16 a[10:11], v21 offset:3072
ds_read_b64_tr_b16 a[12:13], v21 offset:2056
ds_read_b64_tr_b16 a[14:15], v21 offset:3080
s_waitcnt lgkmcnt(4)
s_add_u32 m0, s83, 0
s_mov_b32 s64, 0x18000
buffer_load_dwordx4 v20, s[44:47], s64 offen nt lds
s_add_u32 m0, s83, 1024
s_mov_b32 s64, 0x1c000
buffer_load_dwordx4 v20, s[44:47], s64 offen nt lds
s_waitcnt vmcnt(2)
ds_read_b64_tr_b16 a[16:17], v21 offset:4096
ds_read_b64_tr_b16 a[18:19], v21 offset:5120
ds_read_b64_tr_b16 a[20:21], v21 offset:4104
ds_read_b64_tr_b16 a[22:23], v21 offset:5128
s_waitcnt lgkmcnt(4)
s_add_u32 m0, s83, 2048
s_mov_b32 s64, 0x20000
buffer_load_dwordx4 v20, s[44:47], s64 offen nt lds
s_add_u32 m0, s83, 3072
s_mov_b32 s64, 0x24000
buffer_load_dwordx4 v20, s[44:47], s64 offen nt lds
s_waitcnt vmcnt(2)
ds_read_b64_tr_b16 a[24:25], v21 offset:0
ds_read_b64_tr_b16 a[26:27], v21 offset:1024
ds_read_b64_tr_b16 a[28:29], v21 offset:8
ds_read_b64_tr_b16 a[30:31], v21 offset:1032
s_waitcnt lgkmcnt(4)
s_add_u32 m0, s83, 4096
s_mov_b32 s64, 0x28000
buffer_load_dwordx4 v20, s[44:47], s64 offen nt lds
s_add_u32 m0, s83, 5120
s_mov_b32 s64, 0x2c000
buffer_load_dwordx4 v20, s[44:47], s64 offen nt lds
s_waitcnt vmcnt(2)
ds_read_b64_tr_b16 a[32:33], v21 offset:2048
ds_read_b64_tr_b16 a[34:35], v21 offset:3072
ds_read_b64_tr_b16 a[36:37], v21 offset:2056
ds_read_b64_tr_b16 a[38:39], v21 offset:3080
s_waitcnt lgkmcnt(4)
s_add_u32 m0, s83, 0
s_mov_b32 s64, 0x30000
buffer_load_dwordx4 v20, s[44:47], s64 offen nt lds
s_add_u32 m0, s83, 1024
s_mov_b32 s64, 0x34000
buffer_load_dwordx4 v20, s[44:47], s64 offen nt lds
s_waitcnt vmcnt(2)
ds_read_b64_tr_b16 a[40:41], v21 offset:4096
ds_read_b64_tr_b16 a[42:43], v21 offset:5120
ds_read_b64_tr_b16 a[44:45], v21 offset:4104
ds_read_b64_tr_b16 a[46:47], v21 offset:5128
s_waitcnt lgkmcnt(4)
s_add_u32 m0, s83, 2048
s_mov_b32 s64, 0x38000
buffer_load_dwordx4 v20, s[44:47], s64 offen nt lds
s_add_u32 m0, s83, 3072
s_mov_b32 s64, 0x3c000
buffer_load_dwordx4 v20, s[44:47], s64 offen nt lds
s_waitcnt vmcnt(2)
ds_read_b64_tr_b16 a[48:49], v21 offset:0
ds_read_b64_tr_b16 a[50:51], v21 offset:1024
ds_read_b64_tr_b16 a[52:53], v21 offset:8
ds_read_b64_tr_b16 a[54:55], v21 offset:1032
s_waitcnt lgkmcnt(4)
s_add_u32 m0, s83, 4096
s_mov_b32 s64, 0x40000
buffer_load_dwordx4 v20, s[44:47], s64 offen nt lds
s_add_u32 m0, s83, 5120
s_mov_b32 s64, 0x44000
buffer_load_dwordx4 v20, s[44:47], s64 offen nt lds
s_waitcnt vmcnt(2)
ds_read_b64_tr_b16 a[56:57], v21 offset:2048
ds_read_b64_tr_b16 a[58:59], v21 offset:3072
ds_read_b64_tr_b16 a[60:61], v21 offset:2056
ds_read_b64_tr_b16 a[62:63], v21 offset:3080
s_waitcnt lgkmcnt(4)
s_add_u32 m0, s83, 0
s_mov_b32 s64, 0x48000
buffer_load_dwordx4 v20, s[44:47], s64 offen nt lds
s_add_u32 m0, s83, 1024
s_mov_b32 s64, 0x4c000
buffer_load_dwordx4 v20, s[44:47], s64 offen nt lds
s_waitcnt vmcnt(2)
ds_read_b64_tr_b16 a[64:65], v21 offset:4096
ds_read_b64_tr_b16 a[66:67], v21 offset:5120
ds_read_b64_tr_b16 a[68:69], v21 offset:4104
ds_read_b64_tr_b16 a[70:71], v21 offset:5128
s_waitcnt lgkmcnt(4)
s_add_u32 m0, s83, 2048
s_mov_b32 s64, 0x50000
buffer_load_dwordx4 v20, s[44:47], s64 offen nt lds
s_add_u32 m0, s83, 3072
s_mov_b32 s64, 0x54000
buffer_load_dwordx4 v20, s[44:47], s64 offen nt lds
s_waitcnt vmcnt(2)
ds_read_b64_tr_b16 a[72:73], v21 offset:0
ds_read_b64_tr_b16 a[74:75], v21 offset:1024
ds_read_b64_tr_b16 a[76:77], v21 offset:8
ds_read_b64_tr_b16 a[78:79], v21 offset:1032
s_waitcnt lgkmcnt(4)
s_add_u32 m0, s83, 4096
s_mov_b32 s64, 0x58000
buffer_load_dwordx4 v20, s[44:47], s64 offen nt lds
s_add_u32 m0, s83, 5120
s_mov_b32 s64, 0x5c000
buffer_load_dwordx4 v20, s[44:47], s64 offen nt lds
s_waitcnt vmcnt(2)
ds_read_b64_tr_b16 a[80:81], v21 offset:2048
ds_read_b64_tr_b16 a[82:83], v21 offset:3072
ds_read_b64_tr_b16 a[84:85], v21 offset:2056
ds_read_b64_tr_b16 a[86:87], v21 offset:3080
s_waitcnt lgkmcnt(4)
s_add_u32 m0, s83, 0
s_mov_b32 s64, 0x60000
buffer_load_dwordx4 v20, s[44:47], s64 offen nt lds
s_add_u32 m0, s83, 1024
s_mov_b32 s64, 0x64000
buffer_load_dwordx4 v20, s[44:47], s64 offen nt lds
s_waitcnt vmcnt(2)
ds_read_b64_tr_b16 a[88:89], v21 offset:4096
ds_read_b64_tr_b16 a[90:91], v21 offset:5120
ds_read_b64_tr_b16 a[92:93], v21 offset:4104
ds_read_b64_tr_b16 a[94:95], v21 offset:5128
s_waitcnt lgkmcnt(4)
s_add_u32 m0, s83, 2048
s_mov_b32 s64, 0x68000
buffer_load_dwordx4 v20, s[44:47], s64 offen nt lds
s_add_u32 m0, s83, 3072
s_mov_b32 s64, 0x6c000
buffer_load_dwordx4 v20, s[44:47], s64 offen nt lds
s_waitcnt vmcnt(2)
ds_read_b64_tr_b16 a[96:97], v21 offset:0
ds_read_b64_tr_b16 a[98:99], v21 offset:1024
ds_read_b64_tr_b16 a[100:101], v21 offset:8
ds_read_b64_tr_b16 a[102:103], v21 offset:1032
s_waitcnt lgkmcnt(4)
s_add_u32 m0, s83, 4096
s_mov_b32 s64, 0x70000
buffer_load_dwordx4 v20, s[44:47], s64 offen nt lds
s_add_u32 m0, s83, 5120
s_mov_b32 s64, 0x74000
buffer_load_dwordx4 v20, s[44:47], s64 offen nt lds
s_waitcnt vmcnt(2)
ds_read_b64_tr_b16 a[104:105], v21 offset:2048
ds_read_b64_tr_b16 a[106:107], v21 offset:3072
ds_read_b64_tr_b16 a[108:109], v21 offset:2056
ds_read_b64_tr_b16 a[110:111], v21 offset:3080
s_waitcnt lgkmcnt(4)
s_add_u32 m0, s83, 0
s_mov_b32 s64, 0x78000
buffer_load_dwordx4 v20, s[44:47], s64 offen nt lds
s_add_u32 m0, s83, 1024
s_mov_b32 s64, 0x7c000
buffer_load_dwordx4 v20, s[44:47], s64 offen nt lds
s_waitcnt vmcnt(2)
ds_read_b64_tr_b16 a[112:113], v21 offset:4096
ds_read_b64_tr_b16 a[114:115], v21 offset:5120
ds_read_b64_tr_b16 a[116:117], v21 offset:4104
ds_read_b64_tr_b16 a[118:119], v21 offset:5128
s_waitcnt lgkmcnt(4)
s_add_u32 m0, s83, 2048
s_mov_b32 s64, 0x80000
buffer_load_dwordx4 v20, s[44:47], s64 offen nt lds
s_add_u32 m0, s83, 3072
s_mov_b32 s64, 0x84000
buffer_load_dwordx4 v20, s[44:47], s64 offen nt lds
s_waitcnt vmcnt(2)
ds_read_b64_tr_b16 a[120:121], v21 offset:0
ds_read_b64_tr_b16 a[122:123], v21 offset:1024
ds_read_b64_tr_b16 a[124:125], v21 offset:8
ds_read_b64_tr_b16 a[126:127], v21 offset:1032
s_waitcnt lgkmcnt(4)
s_add_u32 m0, s83, 4096
s_mov_b32 s64, 0x88000
buffer_load_dwordx4 v20, s[44:47], s64 offen nt lds
s_add_u32 m0, s83, 5120
s_mov_b32 s64, 0x8c000
buffer_load_dwordx4 v20, s[44:47], s64 offen nt lds
s_waitcnt vmcnt(2)
ds_read_b64_tr_b16 a[128:129], v21 offset:2048
ds_read_b64_tr_b16 a[130:131], v21 offset:3072
ds_read_b64_tr_b16 a[132:133], v21 offset:2056
ds_read_b64_tr_b16 a[134:135], v21 offset:3080
s_waitcnt lgkmcnt(4)
s_add_u32 m0, s83, 0
s_mov_b32 s64, 0x90000
buffer_load_dwordx4 v20, s[44:47], s64 offen nt lds
s_add_u32 m0, s83, 1024
s_mov_b32 s64, 0x94000
buffer_load_dwordx4 v20, s[44:47], s64 offen nt lds
s_waitcnt vmcnt(2)
ds_read_b64_tr_b16 a[136:137], v21 offset:4096
ds_read_b64_tr_b16 a[138:139], v21 offset:5120
ds_read_b64_tr_b16 a[140:141], v21 offset:4104
ds_read_b64_tr_b16 a[142:143], v21 offset:5128
s_waitcnt lgkmcnt(4)
s_add_u32 m0, s83, 2048
s_mov_b32 s64, 0x98000
buffer_load_dwordx4 v20, s[44:47], s64 offen nt lds
s_add_u32 m0, s83, 3072
s_mov_b32 s64, 0x9c000
buffer_load_dwordx4 v20, s[44:47], s64 offen nt lds
s_waitcnt vmcnt(2)
ds_read_b64_tr_b16 a[144:145], v21 offset:0
ds_read_b64_tr_b16 a[146:147], v21 offset:1024
ds_read_b64_tr_b16 a[148:149], v21 offset:8
ds_read_b64_tr_b16 a[150:151], v21 offset:1032
s_waitcnt lgkmcnt(4)
s_add_u32 m0, s83, 4096
s_mov_b32 s64, 0xa0000
buffer_load_dwordx4 v20, s[44:47], s64 offen nt lds
s_add_u32 m0, s83, 5120
s_mov_b32 s64, 0xa4000
buffer_load_dwordx4 v20, s[44:47], s64 offen nt lds
s_waitcnt vmcnt(2)
ds_read_b64_tr_b16 a[152:153], v21 offset:2048
ds_read_b64_tr_b16 a[154:155], v21 offset:3072
ds_read_b64_tr_b16 a[156:157], v21 offset:2056
ds_read_b64_tr_b16 a[158:159], v21 offset:3080
s_waitcnt lgkmcnt(4)
s_add_u32 m0, s83, 0
s_mov_b32 s64, 0xa8000
buffer_load_dwordx4 v20, s[44:47], s64 offen nt lds
s_add_u32 m0, s83, 1024
s_mov_b32 s64, 0xac000
buffer_load_dwordx4 v20, s[44:47], s64 offen nt lds
s_waitcnt vmcnt(2)
ds_read_b64_tr_b16 a[160:161], v21 offset:4096
ds_read_b64_tr_b16 a[162:163], v21 offset:5120
ds_read_b64_tr_b16 a[164:165], v21 offset:4104
ds_read_b64_tr_b16 a[166:167], v21 offset:5128
s_waitcnt lgkmcnt(4)
s_add_u32 m0, s83, 2048
s_mov_b32 s64, 0xb0000
buffer_load_dwordx4 v20, s[44:47], s64 offen nt lds
s_add_u32 m0, s83, 3072
s_mov_b32 s64, 0xb4000
buffer_load_dwordx4 v20, s[44:47], s64 offen nt lds
s_waitcnt vmcnt(2)
ds_read_b64_tr_b16 a[168:169], v21 offset:0
ds_read_b64_tr_b16 a[170:171], v21 offset:1024
ds_read_b64_tr_b16 a[172:173], v21 offset:8
ds_read_b64_tr_b16 a[174:175], v21 offset:1032
s_waitcnt lgkmcnt(4)
s_add_u32 m0, s83, 4096
s_mov_b32 s64, 0xb8000
buffer_load_dwordx4 v20, s[44:47], s64 offen nt lds
s_add_u32 m0, s83, 5120
s_mov_b32 s64, 0xbc000
buffer_load_dwordx4 v20, s[44:47], s64 offen nt lds
s_waitcnt vmcnt(2)
ds_read_b64_tr_b16 a[176:177], v21 offset:2048
ds_read_b64_tr_b16 a[178:179], v21 offset:3072
ds_read_b64_tr_b16 a[180:181], v21 offset:2056
ds_read_b64_tr_b16 a[182:183], v21 offset:3080
s_waitcnt lgkmcnt(4)
s_add_u32 m0, s83, 0
s_mov_b32 s64, 0xc0000
buffer_load_dwordx4 v20, s[44:47], s64 offen nt lds
s_add_u32 m0, s83, 1024
s_mov_b32 s64, 0xc4000
buffer_load_dwordx4 v20, s[44:47], s64 offen nt lds
s_waitcnt vmcnt(2)
ds_read_b64_tr_b16 a[184:185], v21 offset:4096
ds_read_b64_tr_b16 a[186:187], v21 offset:5120
ds_read_b64_tr_b16 a[188:189], v21 offset:4104
ds_read_b64_tr_b16 a[190:191], v21 offset:5128
s_waitcnt lgkmcnt(4)
s_add_u32 m0, s83, 2048
s_mov_b32 s64, 0xc8000
buffer_load_dwordx4 v20, s[44:47], s64 offen nt lds
s_add_u32 m0, s83, 3072
s_mov_b32 s64, 0xcc000
buffer_load_dwordx4 v20, s[44:47], s64 offen nt lds
s_waitcnt vmcnt(2)
ds_read_b64_tr_b16 a[192:193], v21 offset:0
ds_read_b64_tr_b16 a[194:195], v21 offset:1024
ds_read_b64_tr_b16 a[196:197], v21 offset:8
ds_read_b64_tr_b16 a[198:199], v21 offset:1032
s_waitcnt lgkmcnt(4)
s_add_u32 m0, s83, 4096
s_mov_b32 s64, 0xd0000
buffer_load_dwordx4 v20, s[44:47], s64 offen nt lds
s_add_u32 m0, s83, 5120
s_mov_b32 s64, 0xd4000
buffer_load_dwordx4 v20, s[44:47], s64 offen nt lds
s_waitcnt vmcnt(2)
ds_read_b64_tr_b16 a[200:201], v21 offset:2048
ds_read_b64_tr_b16 a[202:203], v21 offset:3072
ds_read_b64_tr_b16 a[204:205], v21 offset:2056
ds_read_b64_tr_b16 a[206:207], v21 offset:3080
s_waitcnt lgkmcnt(4)
s_add_u32 m0, s83, 0
s_mov_b32 s64, 0xd8000
buffer_load_dwordx4 v20, s[44:47], s64 offen nt lds
s_add_u32 m0, s83, 1024
s_mov_b32 s64, 0xdc000
buffer_load_dwordx4 v20, s[44:47], s64 offen nt lds
s_waitcnt vmcnt(2)
ds_read_b64_tr_b16 a[208:209], v21 offset:4096
ds_read_b64_tr_b16 a[210:211], v21 offset:5120
ds_read_b64_tr_b16 a[212:213], v21 offset:4104
ds_read_b64_tr_b16 a[214:215], v21 offset:5128
s_waitcnt vmcnt(0)
ds_read_b64_tr_b16 a[216:217], v21 offset:0
ds_read_b64_tr_b16 a[218:219], v21 offset:1024
ds_read_b64_tr_b16 a[220:221], v21 offset:8
ds_read_b64_tr_b16 a[222:223], v21 offset:1032
s_waitcnt lgkmcnt(0)
s_xor_b32 s64, s57, 1
s_lshl_b32 s64, s64, 7
s_lshl_b32 s65, s56, 2
s_add_u32 s64, s64, s65
s_add_u32 s64, s64, 64
v_mov_b32 v30, s64
s_cmp_eq_u32 s88, 0
s_cselect_b32 s86, 1, 0
L_rxw_166:
buffer_load_dword v31, v30, s[36:39], 0 offen sc1
s_waitcnt vmcnt(0)
v_cmp_gt_u32 vcc, s86, v31
s_cbranch_vccz L_rxw_ok_167
s_add_u32 s63, s63, 1
s_cmp_lt_u32 s63, 0x20000
s_cbranch_scc1 L_rxw_166
s_branch L_giveup
L_rxw_ok_167:
s_barrier
s_mov_b32 s59, 0
s_mov_b32 s84, 0xb7fa000
s_mov_b32 s92, 0
s_mov_b32 s93, 0
L_f2_wait:
s_add_u32 s86, s59, 1
buffer_load_dword v48, v4, s[36:39], 0 offen sc1
s_waitcnt vmcnt(0)
s_cmp_eq_u32 s59, 64
s_cbranch_scc1 L_end
s_waitcnt vmcnt(1)
v_cmp_gt_u32 vcc, s86, v48
s_cbranch_vccz L_fp_ok_169
L_fp_168:
buffer_load_dword v48, v4, s[36:39], 0 offen sc1
s_waitcnt vmcnt(0)
v_cmp_gt_u32 vcc, s86, v48
s_cbranch_vccz L_fp_ok_169
s_add_u32 s63, s63, 1
s_cmp_lt_u32 s63, 0x20000
s_cbranch_scc1 L_fp_168
s_branch L_giveup
L_fp_ok_169:
L_f2_go:
s_add_u32 s97, s84, s20
buffer_load_dwordx4 v[64:67], v5, s[36:39], s97 offen offset:0 sc1
buffer_load_dwordx4 v[68:71], v5, s[36:39], s97 offen offset:1024 sc1
buffer_load_dwordx4 v[72:75], v5, s[36:39], s97 offen offset:2048 sc1
buffer_load_dwordx4 v[76:79], v5, s[36:39], s97 offen offset:3072 sc1
s_add_u32 s97, s84, s21
buffer_load_dwordx4 v[80:83], v5, s[36:39], s97 offen offset:0 sc1
buffer_load_dwordx4 v[84:87], v5, s[36:39], s97 offen offset:1024 sc1
buffer_load_dwordx4 v[88:91], v5, s[36:39], s97 offen offset:2048 sc1
buffer_load_dwordx4 v[92:95], v5, s[36:39], s97 offen offset:3072 sc1
s_add_u32 s97, s84, s22
buffer_load_dwordx4 v[96:99], v5, s[36:39], s97 offen offset:0 sc1
buffer_load_dwordx4 v[100:103], v5, s[36:39], s97 offen offset:1024 sc1
buffer_load_dwordx4 v[104:107], v5, s[36:39], s97 offen offset:2048 sc1
buffer_load_dwordx4 v[108:111], v5, s[36:39], s97 offen offset:3072 sc1
L_f2_top:
s_lshl_b32 s64, s59, 16
s_lshl_b32 s65, s59, 9
s_and_b32 s65, s65, 0x2000
s_lshl_b32 s64, s59, 17
s_add_u32 s64, s64, s65
s_add_u32 s64, s64, 0xd7fa000
buffer_load_dwordx4 v[52:55], v10, s[36:39], s64 offen sc1
buffer_load_dword v48, v4, s[36:39], 0 offen sc1
s_add_u32 s86, s59, 2
s_and_b32 s85, s59, 3
s_lshl_b32 s85, s85, 17
s_xor_b32 s91, s85, 0x40000
s_add_u32 s85, s85, 0xb680000
s_add_u32 s91, s91, 0xb680000
s_waitcnt vmcnt(13)
v_mfma_f32_32x32x16_bf16 v[16:31], a[0:3], v[64:67], 0
s_add_u32 s97, s84, s23
buffer_load_dwordx4 v[112:115], v5, s[36:39], s97 offen offset:0 sc1
v_mfma_f32_32x32x16_bf16 v[32:47], a[4:7], v[64:67], 0
s_waitcnt vmcnt(13)
v_mfma_f32_32x32x16_bf16 v[16:31], a[8:11], v[68:71], v[16:31]
buffer_load_dwordx4 v[116:119], v5, s[36:39], s97 offen offset:1024 sc1
v_mfma_f32_32x32x16_bf16 v[32:47], a[12:15], v[68:71], v[32:47]
s_waitcnt vmcnt(13)
v_mfma_f32_32x32x16_bf16 v[16:31], a[16:19], v[72:75], v[16:31]
buffer_load_dwordx4 v[120:123], v5, s[36:39], s97 offen offset:2048 sc1
v_mfma_f32_32x32x16_bf16 v[32:47], a[20:23], v[72:75], v[32:47]
s_waitcnt vmcnt(13)
v_mfma_f32_32x32x16_bf16 v[16:31], a[24:27], v[76:79], v[16:31]
buffer_load_dwordx4 v[124:127], v5, s[36:39], s97 offen offset:3072 sc1
v_mfma_f32_32x32x16_bf16 v[32:47], a[28:31], v[76:79], v[32:47]
s_waitcnt vmcnt(13)
v_mfma_f32_32x32x16_bf16 v[16:31], a[32:35], v[80:83], v[16:31]
s_add_u32 s97, s84, s6
buffer_load_dwordx4 v[128:131], v5, s[36:39], s97 offen offset:0 sc1
v_mfma_f32_32x32x16_bf16 v[32:47], a[36:39], v[80:83], v[32:47]
s_waitcnt vmcnt(13)
v_mfma_f32_32x32x16_bf16 v[16:31], a[40:43], v[84:87], v[16:31]
buffer_load_dwordx4 v[132:135], v5, s[36:39], s97 offen offset:1024 sc1
v_mfma_f32_32x32x16_bf16 v[32:47], a[44:47], v[84:87], v[32:47]
s_waitcnt vmcnt(13)
v_mfma_f32_32x32x16_bf16 v[16:31], a[48:51], v[88:91], v[16:31]
buffer_load_dwordx4 v[136:139], v5, s[36:39], s97 offen offset:2048 sc1
v_mfma_f32_32x32x16_bf16 v[32:47], a[52:55], v[88:91], v[32:47]
s_waitcnt vmcnt(13)
v_mfma_f32_32x32x16_bf16 v[16:31], a[56:59], v[92:95], v[16:31]
buffer_load_dwordx4 v[140:143], v5, s[36:39], s97 offen offset:3072 sc1
v_mfma_f32_32x32x16_bf16 v[32:47], a[60:63], v[92:95], v[32:47]
s_waitcnt vmcnt(13)
v_mfma_f32_32x32x16_bf16 v[16:31], a[64:67], v[96:99], v[16:31]
s_add_u32 s97, s84, s7
buffer_load_dwordx4 v[144:147], v5, s[36:39], s97 offen offset:0 sc1
v_mfma_f32_32x32x16_bf16 v[32:47], a[68:71], v[96:99], v[32:47]
s_waitcnt vmcnt(13)
v_mfma_f32_32x32x16_bf16 v[16:31], a[72:75], v[100:103], v[16:31]
buffer_load_dwordx4 v[148:151], v5, s[36:39], s97 offen offset:1024 sc1
v_mfma_f32_32x32x16_bf16 v[32:47], a[76:79], v[100:103], v[32:47]
s_waitcnt vmcnt(13)
v_mfma_f32_32x32x16_bf16 v[16:31], a[80:83], v[104:107], v[16:31]
buffer_load_dwordx4 v[152:155], v5, s[36:39], s97 offen offset:2048 sc1
v_mfma_f32_32x32x16_bf16 v[32:47], a[84:87], v[104:107], v[32:47]
s_waitcnt vmcnt(13)
v_mfma_f32_32x32x16_bf16 v[16:31], a[88:91], v[108:111], v[16:31]
buffer_load_dwordx4 v[156:159], v5, s[36:39], s97 offen offset:3072 sc1
v_mfma_f32_32x32x16_bf16 v[32:47], a[92:95], v[108:111], v[32:47]
s_waitcnt vmcnt(11)
v_mfma_f32_32x32x16_bf16 v[16:31], a[96:99], v[112:115], v[16:31]
s_add_u32 s97, s84, s3
buffer_load_dwordx4 v[160:163], v5, s[36:39], s97 offen offset:0 sc1
v_mfma_f32_32x32x16_bf16 v[32:47], a[100:103], v[112:115], v[32:47]
s_waitcnt vmcnt(11)
v_mfma_f32_32x32x16_bf16 v[16:31], a[104:107], v[116:119], v[16:31]
buffer_load_dwordx4 v[164:167], v5, s[36:39], s97 offen offset:1024 sc1
v_mfma_f32_32x32x16_bf16 v[32:47], a[108:111], v[116:119], v[32:47]
v_cmp_gt_u32 vcc, s86, v48
s_waitcnt vmcnt(11)
v_mfma_f32_32x32x16_bf16 v[16:31], a[112:115], v[120:123], v[16:31]
buffer_load_dwordx4 v[168:171], v5, s[36:39], s97 offen offset:2048 sc1
v_mfma_f32_32x32x16_bf16 v[32:47], a[116:119], v[120:123], v[32:47]
s_waitcnt vmcnt(11)
v_mfma_f32_32x32x16_bf16 v[16:31], a[120:123], v[124:127], v[16:31]
buffer_load_dwordx4 v[172:175], v5, s[36:39], s97 offen offset:3072 sc1
v_mfma_f32_32x32x16_bf16 v[32:47], a[124:127], v[124:127], v[32:47]
s_add_u32 s64, s59, 1
s_lshl_b32 s84, s64, 19
s_lshl_b32 s64, s64, 11
s_and_b32 s64, s64, 0x2000
s_add_u32 s84, s84, s64
s_add_u32 s84, s84, 0xb7fa000
s_cmp_eq_u64 vcc, 0
s_cselect_b32 s87, 1, 0
s_cselect_b32 s90, s84, 0x7fff0000
s_waitcnt vmcnt(11)
v_mfma_f32_32x32x16_bf16 v[16:31], a[128:131], v[128:131], v[16:31]
s_add_u32 s97, s90, s20
buffer_load_dwordx4 v[64:67], v5, s[36:39], s97 offen offset:0 sc1
v_mfma_f32_32x32x16_bf16 v[32:47], a[132:135], v[128:131], v[32:47]
s_waitcnt vmcnt(11)
v_mfma_f32_32x32x16_bf16 v[16:31], a[136:139], v[132:135], v[16:31]
buffer_load_dwordx4 v[68:71], v5, s[36:39], s97 offen offset:1024 sc1
v_mfma_f32_32x32x16_bf16 v[32:47], a[140:143], v[132:135], v[32:47]
s_waitcnt vmcnt(11)
v_mfma_f32_32x32x16_bf16 v[16:31], a[144:147], v[136:139], v[16:31]
buffer_load_dwordx4 v[72:75], v5, s[36:39], s97 offen offset:2048 sc1
v_mfma_f32_32x32x16_bf16 v[32:47], a[148:151], v[136:139], v[32:47]
s_waitcnt vmcnt(11)
v_mfma_f32_32x32x16_bf16 v[16:31], a[152:155], v[140:143], v[16:31]
buffer_load_dwordx4 v[76:79], v5, s[36:39], s97 offen offset:3072 sc1
v_mfma_f32_32x32x16_bf16 v[32:47], a[156:159], v[140:143], v[32:47]
s_waitcnt vmcnt(11)
v_mfma_f32_32x32x16_bf16 v[16:31], a[160:163], v[144:147], v[16:31]
s_add_u32 s97, s90, s21
buffer_load_dwordx4 v[80:83], v5, s[36:39], s97 offen offset:0 sc1
v_mfma_f32_32x32x16_bf16 v[32:47], a[164:167], v[144:147], v[32:47]
s_waitcnt vmcnt(11)
v_mfma_f32_32x32x16_bf16 v[16:31], a[168:171], v[148:151], v[16:31]
buffer_load_dwordx4 v[84:87], v5, s[36:39], s97 offen offset:1024 sc1
v_mfma_f32_32x32x16_bf16 v[32:47], a[172:175], v[148:151], v[32:47]
buffer_load_dword v51, v4, s[36:39], 0 offen sc1
s_waitcnt vmcnt(11)
v_mfma_f32_32x32x16_bf16 v[16:31], a[176:179], v[152:155], v[16:31]
buffer_load_dwordx4 v[88:91], v5, s[36:39], s97 offen offset:2048 sc1
v_mfma_f32_32x32x16_bf16 v[32:47], a[180:183], v[152:155], v[32:47]
s_waitcnt vmcnt(11)
v_mfma_f32_32x32x16_bf16 v[16:31], a[184:187], v[156:159], v[16:31]
buffer_load_dwordx4 v[92:95], v5, s[36:39], s97 offen offset:3072 sc1
v_mfma_f32_32x32x16_bf16 v[32:47], a[188:191], v[156:159], v[32:47]
s_waitcnt vmcnt(11)
v_mfma_f32_32x32x16_bf16 v[16:31], a[192:195], v[160:163], v[16:31]
s_add_u32 s97, s90, s22
buffer_load_dwordx4 v[96:99], v5, s[36:39], s97 offen offset:0 sc1
v_mfma_f32_32x32x16_bf16 v[32:47], a[196:199], v[160:163], v[32:47]
s_waitcnt vmcnt(11)
v_mfma_f32_32x32x16_bf16 v[16:31], a[200:203], v[164:167], v[16:31]
buffer_load_dwordx4 v[100:103], v5, s[36:39], s97 offen offset:1024 sc1
v_mfma_f32_32x32x16_bf16 v[32:47], a[204:207], v[164:167], v[32:47]
s_waitcnt vmcnt(11)
v_mfma_f32_32x32x16_bf16 v[16:31], a[208:211], v[168:171], v[16:31]
buffer_load_dwordx4 v[104:107], v5, s[36:39], s97 offen offset:2048 sc1
v_mfma_f32_32x32x16_bf16 v[32:47], a[212:215], v[168:171], v[32:47]
s_waitcnt vmcnt(11)
v_mfma_f32_32x32x16_bf16 v[16:31], a[216:219], v[172:175], v[16:31]
buffer_load_dwordx4 v[108:111], v5, s[36:39], s97 offen offset:3072 sc1
v_mfma_f32_32x32x16_bf16 v[32:47], a[220:223], v[172:175], v[32:47]
buffer_load_dword v48, v4, s[36:39], 0 offen sc1
s_nop 8
ds_write_b128 v6, v[16:19] offset:0
ds_write_b128 v6, v[20:23] offset:2048
ds_write_b128 v6, v[24:27] offset:4096
ds_write_b128 v6, v[28:31] offset:6144
ds_write_b128 v6, v[32:35] offset:512
ds_write_b128 v6, v[36:39] offset:2560
ds_write_b128 v6, v[40:43] offset:4608
ds_write_b128 v6, v[44:47] offset:6656
s_waitcnt lgkmcnt(0)
s_barrier
ds_read_b128 v[16:19], v7 offset:0
ds_read_b128 v[20:23], v7 offset:8192
ds_read_b128 v[24:27], v7 offset:16384
ds_read_b128 v[28:31], v7 offset:24576
ds_read_b128 v[32:35], v7 offset:512
ds_read_b128 v[36:39], v7 offset:8704
ds_read_b128 v[40:43], v7 offset:16896
ds_read_b128 v[44:47], v7 offset:25088
s_waitcnt lgkmcnt(4)
v_pk_add_f32 v[16:17], v[16:17], v[20:21]
v_pk_add_f32 v[18:19], v[18:19], v[22:23]
v_pk_add_f32 v[24:25], v[24:25], v[28:29]
v_pk_add_f32 v[26:27], v[26:27], v[30:31]
v_pk_add_f32 v[16:17], v[16:17], v[24:25]
v_pk_add_f32 v[18:19], v[18:19], v[26:27]
s_waitcnt lgkmcnt(0)
v_pk_add_f32 v[32:33], v[32:33], v[36:37]
v_pk_add_f32 v[34:35], v[34:35], v[38:39]
v_pk_add_f32 v[40:41], v[40:41], v[44:45]
v_pk_add_f32 v[42:43], v[42:43], v[46:47]
v_pk_add_f32 v[32:33], v[32:33], v[40:41]
v_pk_add_f32 v[34:35], v[34:35], v[42:43]
v_xor_b32 v6, 0x8000, v6
v_xor_b32 v7, 0x8000, v7
s_cmp_eq_u32 s88, 0
s_cbranch_scc1 L_fin_170
v_min_u32 v16, s54, v16
v_min_u32 v17, s54, v17
v_min_u32 v18, s54, v18
v_min_u32 v19, s54, v19
v_min_u32 v32, s54, v32
v_min_u32 v33, s54, v33
v_min_u32 v34, s54, v34
v_min_u32 v35, s54, v35
v_mov_b32 v56, -1
v_mov_b32 v57, -1
v_mov_b32 v58, -1
v_mov_b32 v59, -1
s_cmp_lg_u32 s58, 0
s_cbranch_scc1 L_sl_172
buffer_store_dwordx4 v[16:19], v8, s[36:39], s85 offen offset:0
buffer_store_dwordx4 v[32:35], v8, s[36:39], s85 offen offset:512
buffer_store_dwordx4 v[56:59], v8, s[36:39], s91 offen offset:0
buffer_store_dwordx4 v[56:59], v8, s[36:39], s91 offen offset:512
s_branch L_sd_173
L_sl_172:
buffer_store_dwordx4 v[16:19], v8, s[36:39], s85 offen offset:0 sc1
buffer_store_dwordx4 v[32:35], v8, s[36:39], s85 offen offset:512 sc1
buffer_store_dwordx4 v[56:59], v8, s[36:39], s91 offen offset:0 sc1
buffer_store_dwordx4 v[56:59], v8, s[36:39], s91 offen offset:512 sc1
L_sd_173:
s_add_u32 s92, s92, 1
s_cmp_lg_u32 s87, 0
s_cbranch_scc1 L_np_174
s_waitcnt vmcnt(4)
v_cmp_gt_u32 vcc, s86, v48
s_cbranch_vccnz L_np_174
s_add_u32 s97, s84, s20
buffer_load_dwordx4 v[64:67], v5, s[36:39], s97 offen offset:0 sc1
buffer_load_dwordx4 v[68:71], v5, s[36:39], s97 offen offset:1024 sc1
buffer_load_dwordx4 v[72:75], v5, s[36:39], s97 offen offset:2048 sc1
buffer_load_dwordx4 v[76:79], v5, s[36:39], s97 offen offset:3072 sc1
s_add_u32 s97, s84, s21
buffer_load_dwordx4 v[80:83], v5, s[36:39], s97 offen offset:0 sc1
buffer_load_dwordx4 v[84:87], v5, s[36:39], s97 offen offset:1024 sc1
buffer_load_dwordx4 v[88:91], v5, s[36:39], s97 offen offset:2048 sc1
buffer_load_dwordx4 v[92:95], v5, s[36:39], s97 offen offset:3072 sc1
s_add_u32 s97, s84, s22
buffer_load_dwordx4 v[96:99], v5, s[36:39], s97 offen offset:0 sc1
buffer_load_dwordx4 v[100:103], v5, s[36:39], s97 offen offset:1024 sc1
buffer_load_dwordx4 v[104:107], v5, s[36:39], s97 offen offset:2048 sc1
buffer_load_dwordx4 v[108:111], v5, s[36:39], s97 offen offset:3072 sc1
s_mov_b32 s87, 1
L_np_174:
s_branch L_join_171
L_fin_170:
s_mov_b32 s95, s85
v_lshlrev_b32 v192, 16, v52
v_and_b32 v193, 0xffff0000, v52
v_pk_add_f32 v[192:193], v[192:193], v[16:17]
v_lshlrev_b32 v194, 16, v53
v_and_b32 v195, 0xffff0000, v53
v_pk_add_f32 v[194:195], v[194:195], v[18:19]
v_lshlrev_b32 v196, 16, v54
v_and_b32 v197, 0xffff0000, v54
v_pk_add_f32 v[196:197], v[196:197], v[32:33]
v_lshlrev_b32 v198, 16, v55
v_and_b32 v199, 0xffff0000, v55
v_pk_add_f32 v[198:199], v[198:199], v[34:35]
buffer_load_dwordx4 v[56:59], v8, s[36:39], s95 offen offset:0 sc1
buffer_load_dwordx4 v[60:63], v8, s[36:39], s95 offen offset:512 sc1
s_waitcnt vmcnt(0)
v_max3_u32 v50, v56, v57, v58
v_max3_u32 v50, v50, v59, v60
v_max3_u32 v50, v50, v61, v62
v_max_u32 v50, v50, v63
v_cmp_eq_u32 vcc, -1, v50
s_cbranch_vccz L_got_175
L_px_176:
buffer_load_dwordx4 v[56:59], v8, s[36:39], s95 offen offset:0 sc1
buffer_load_dwordx4 v[60:63], v8, s[36:39], s95 offen offset:512 sc1
s_waitcnt vmcnt(0)
v_max3_u32 v50, v56, v57, v58
v_max3_u32 v50, v50, v59, v60
v_max3_u32 v50, v50, v61, v62
v_max_u32 v50, v50, v63
v_cmp_eq_u32 vcc, -1, v50
s_cbranch_vccz L_px_ok_177
s_add_u32 s63, s63, 1
s_cmp_lt_u32 s63, 0x20000
s_cbranch_scc1 L_px_176
s_branch L_giveup
L_px_ok_177:
L_got_175:
s_lshl_b32 s64, s92, 16
v_pk_add_f32 v[192:193], v[192:193], v[56:57]
v_cvt_pk_bf16_f32 v56, v192, v193
v_pk_add_f32 v[194:195], v[194:195], v[58:59]
v_cvt_pk_bf16_f32 v57, v194, v195
v_pk_add_f32 v[196:197], v[196:197], v[60:61]
v_cvt_pk_bf16_f32 v58, v196, v197
v_pk_add_f32 v[198:199], v[198:199], v[62:63]
v_cvt_pk_bf16_f32 v59, v198, v199
buffer_store_dwordx4 v[56:59], v11, s[48:51], s64 offen
s_add_u32 s92, s92, 1
L_join_171:
s_add_u32 s59, s59, 1
s_cmp_lg_u32 s87, 0
s_cbranch_scc1 L_f2_top
s_cmp_eq_u32 s59, 64
s_cbranch_scc1 L_f2_last
s_waitcnt vmcnt(1)
v_cmp_gt_u32 vcc, s86, v48
s_cbranch_vccz L_f2_go
s_branch L_f2_wait
L_f2_last:
s_endpgm
L_role_qkv:
s_sub_u32 s80, s57, 64
s_lshr_b32 s80, s80, 5
s_lshl_b32 s80, s80, 4
s_and_b32 s64, s57, 15
s_add_u32 s80, s80, s64
s_and_b32 s66, s56, 1
s_lshr_b32 s67, s56, 1
s_mov_b32 s44, s12
s_and_b32 s45, s13, 0xffff
s_mov_b32 s46, 0x800000
s_mov_b32 s47, 0x20000
s_mov_b32 s48, s14
s_and_b32 s49, s15, 0xffff
s_mov_b32 s50, 0x800000
s_mov_b32 s51, 0x20000
s_mov_b32 s4, s16
s_and_b32 s5, s17, 0xffff
s_mov_b32 s6, 0x800000
s_mov_b32 s7, 0x20000
v_lshrrev_b32 v20, 3, v0
s_lshl_b32 s64, s56, 3
v_add_u32 v20, s64, v20
v_lshlrev_b32 v20, 13, v20
v_bfe_u32 v21, v0, 4, 1
v_lshlrev_b32 v21, 2, v21
v_and_b32 v22, 7, v0
v_xor_b32 v21, v21, v22
v_lshl_add_u32 v20, v21, 4, v20
s_lshl_b32 s64, s80, 7
v_add_u32 v20, s64, v20
v_xor_b32 v21, 256, v20
v_xor_b32 v22, 512, v20
s_lshl_b32 s83, s56, 10
s_add_u32 s83, s83, 0
v_lshrrev_b32 v24, 4, v0
v_bfe_u32 v25, v0, 2, 2
v_lshl_add_u32 v24, v24, 3, v25
v_lshlrev_b32 v24, 7, v24
v_and_b32 v23, 3, v0
v_lshl_add_u32 v24, v23, 4, v24
v_bfe_u32 v25, v0, 3, 1
v_xor_b32 v26, s66, v25
v_lshl_add_u32 v32, v26, 6, v24
s_lshl_b32 s64, s67, 12
s_add_u32 s64, s64, 0
v_add_u32 v32, s64, v32
v_add_u32 v33, 0x10000, v32
v_add_u32 v34, 0x20000, v32
v_xor_b32 v26, s67, v25
v_lshl_add_u32 v36, v26, 6, v24
s_lshl_b32 s64, s66, 3
s_add_u32 s64, s64, 8192
v_add_u32 v36, s64, v36
v_add_u32 v37, 0x10000, v36
v_add_u32 v38, 0x20000, v36
s_lshl_b32 s64, s57, 7
s_lshl_b32 s65, s56, 2
s_add_u32 s64, s64, s65
v_mov_b32 v3, 0x7fff0000
v_mov_b32 v255, s64
v_cmp_eq_u32 vcc, 0, v0
s_nop 1
v_cndmask_b32 v3, v3, v255, vcc
v_lshlrev_b32 v2, 4, v0
s_lshl_b32 s81, s56, 13
v_add_u32 v5, s81, v2
v_add_u32 v23, 220, v23
v_lshlrev_b32 v23, 7, v23
s_lshl_b32 s64, s56, 2
s_add_u32 s64, s64, 64
v_add_u32 v4, s64, v23
s_and_b32 s64, s80, 1
s_lshl_b32 s65, s64, 1
s_add_u32 s65, s65, s66
s_lshl_b32 s65, s65, 10
s_lshr_b32 s82, s80, 1
s_xor_b32 s84, s82, s67
s_mul_i32 s84, s84, 49152
s_add_u32 s65, s65, s84
s_cmp_lt_u32 s56, 2
s_cselect_b32 s84, 32768, 0
s_add_u32 s65, s65, s84
v_add_u32 v6, s65, v2
s_lshl_b32 s65, s64, 2
s_add_u32 s65, s65, s56
s_lshl_b32 s65, s65, 10
s_add_u32 s65, s65, 16384
s_xor_b32 s84, s82, 2
s_mul_i32 s84, s84, 49152
s_add_u32 s65, s65, s84
v_add_u32 v7, s65, v2
s_mov_b32 s82, 0xbfc000
s_add_u32 m0, s83, 0
s_mov_b32 s64, 0x0
buffer_load_dwordx4 v20, s[44:47], s64 offen nt lds
s_add_u32 m0, s83, 4096
s_mov_b32 s64, 0x0
buffer_load_dwordx4 v21, s[48:51], s64 offen nt lds
s_add_u32 m0, s83, 8192
s_mov_b32 s64, 0x0
buffer_load_dwordx4 v22, s[4:7], s64 offen nt lds
s_add_u32 m0, s83, 12288
s_mov_b32 s64, 0x40000
buffer_load_dwordx4 v20, s[44:47], s64 offen nt lds
s_add_u32 m0, s83, 16384
s_mov_b32 s64, 0x40000
buffer_load_dwordx4 v21, s[48:51], s64 offen nt lds
s_add_u32 m0, s83, 20480
s_mov_b32 s64, 0x40000
buffer_load_dwordx4 v22, s[4:7], s64 offen nt lds
s_add_u32 m0, s83, 24576
s_mov_b32 s64, 0x80000
buffer_load_dwordx4 v20, s[44:47], s64 offen nt lds
s_add_u32 m0, s83, 28672
s_mov_b32 s64, 0x80000
buffer_load_dwordx4 v21, s[48:51], s64 offen nt lds
s_add_u32 m0, s83, 32768
s_mov_b32 s64, 0x80000
buffer_load_dwordx4 v22, s[4:7], s64 offen nt lds
s_add_u32 m0, s83, 36864
s_mov_b32 s64, 0xc0000
buffer_load_dwordx4 v20, s[44:47], s64 offen nt lds
s_add_u32 m0, s83, 40960
s_mov_b32 s64, 0xc0000
buffer_load_dwordx4 v21, s[48:51], s64 offen nt lds
s_add_u32 m0, s83, 45056
s_mov_b32 s64, 0xc0000
buffer_load_dwordx4 v22, s[4:7], s64 offen nt lds
s_add_u32 m0, s83, 49152
s_mov_b32 s64, 0x100000
buffer_load_dwordx4 v20, s[44:47], s64 offen nt lds
s_add_u32 m0, s83, 53248
s_mov_b32 s64, 0x100000
buffer_load_dwordx4 v21, s[48:51], s64 offen nt lds
s_add_u32 m0, s83, 57344
s_mov_b32 s64, 0x100000
buffer_load_dwordx4 v22, s[4:7], s64 offen nt lds
s_add_u32 m0, s83, 61440
s_mov_b32 s64, 0x140000
buffer_load_dwordx4 v20, s[44:47], s64 offen nt lds
s_add_u32 m0, s83, 65536
s_mov_b32 s64, 0x140000
buffer_load_dwordx4 v21, s[48:51], s64 offen nt lds
s_add_u32 m0, s83, 69632
s_mov_b32 s64, 0x140000
buffer_load_dwordx4 v22, s[4:7], s64 offen nt lds
s_add_u32 m0, s83, 73728
s_mov_b32 s64, 0x180000
buffer_load_dwordx4 v20, s[44:47], s64 offen nt lds
s_add_u32 m0, s83, 77824
s_mov_b32 s64, 0x180000
buffer_load_dwordx4 v21, s[48:51], s64 offen nt lds
s_add_u32 m0, s83, 81920
s_mov_b32 s64, 0x180000
buffer_load_dwordx4 v22, s[4:7], s64 offen nt lds
s_add_u32 m0, s83, 86016
s_mov_b32 s64, 0x1c0000
buffer_load_dwordx4 v20, s[44:47], s64 offen nt lds
s_add_u32 m0, s83, 90112
s_mov_b32 s64, 0x1c0000
buffer_load_dwordx4 v21, s[48:51], s64 offen nt lds
s_add_u32 m0, s83, 94208
s_mov_b32 s64, 0x1c0000
buffer_load_dwordx4 v22, s[4:7], s64 offen nt lds
s_add_u32 m0, s83, 98304
s_mov_b32 s64, 0x200000
buffer_load_dwordx4 v20, s[44:47], s64 offen nt lds
s_add_u32 m0, s83, 102400
s_mov_b32 s64, 0x200000
buffer_load_dwordx4 v21, s[48:51], s64 offen nt lds
s_add_u32 m0, s83, 106496
s_mov_b32 s64, 0x200000
buffer_load_dwordx4 v22, s[4:7], s64 offen nt lds
s_add_u32 m0, s83, 110592
s_mov_b32 s64, 0x240000
buffer_load_dwordx4 v20, s[44:47], s64 offen nt lds
s_add_u32 m0, s83, 114688
s_mov_b32 s64, 0x240000
buffer_load_dwordx4 v21, s[48:51], s64 offen nt lds
s_add_u32 m0, s83, 118784
s_mov_b32 s64, 0x240000
buffer_load_dwordx4 v22, s[4:7], s64 offen nt lds
s_add_u32 m0, s83, 122880
s_mov_b32 s64, 0x280000
buffer_load_dwordx4 v20, s[44:47], s64 offen nt lds
s_add_u32 m0, s83, 126976
s_mov_b32 s64, 0x280000
buffer_load_dwordx4 v21, s[48:51], s64 offen nt lds
s_add_u32 m0, s83, 131072
s_mov_b32 s64, 0x280000
buffer_load_dwordx4 v22, s[4:7], s64 offen nt lds
s_add_u32 m0, s83, 135168
s_mov_b32 s64, 0x2c0000
buffer_load_dwordx4 v20, s[44:47], s64 offen nt lds
s_add_u32 m0, s83, 139264
s_mov_b32 s64, 0x2c0000
buffer_load_dwordx4 v21, s[48:51], s64 offen nt lds
s_add_u32 m0, s83, 143360
s_mov_b32 s64, 0x2c0000
buffer_load_dwordx4 v22, s[4:7], s64 offen nt lds
s_add_u32 m0, s83, 147456
s_mov_b32 s64, 0x300000
buffer_load_dwordx4 v20, s[44:47], s64 offen nt lds
s_add_u32 m0, s83, 151552
s_mov_b32 s64, 0x300000
buffer_load_dwordx4 v21, s[48:51], s64 offen nt lds
s_add_u32 m0, s83, 155648
s_mov_b32 s64, 0x300000
buffer_load_dwordx4 v22, s[4:7], s64 offen nt lds
s_waitcnt vmcnt(36)
s_barrier
ds_read_b64_tr_b16 a[0:1], v32 offset:0
ds_read_b64_tr_b16 a[2:3], v32 offset:512
ds_read_b64_tr_b16 a[4:5], v32 offset:8
ds_read_b64_tr_b16 a[6:7], v32 offset:520
ds_read_b64_tr_b16 a[8:9], v36 offset:0
ds_read_b64_tr_b16 a[10:11], v36 offset:512
s_waitcnt vmcnt(33)
s_waitcnt lgkmcnt(0)
s_barrier
s_add_u32 m0, s83, 0
s_mov_b32 s64, 0x340000
buffer_load_dwordx4 v20, s[44:47], s64 offen nt lds
s_add_u32 m0, s83, 4096
s_mov_b32 s64, 0x340000
buffer_load_dwordx4 v21, s[48:51], s64 offen nt lds
s_add_u32 m0, s83, 8192
s_mov_b32 s64, 0x340000
buffer_load_dwordx4 v22, s[4:7], s64 offen nt lds
ds_read_b64_tr_b16 a[12:13], v32 offset:12288
ds_read_b64_tr_b16 a[14:15], v32 offset:12800
ds_read_b64_tr_b16 a[16:17], v32 offset:12296
ds_read_b64_tr_b16 a[18:19], v32 offset:12808
ds_read_b64_tr_b16 a[20:21], v36 offset:12288
ds_read_b64_tr_b16 a[22:23], v36 offset:12800
s_waitcnt vmcnt(33)
s_waitcnt lgkmcnt(0)
s_barrier
s_add_u32 m0, s83, 12288
s_mov_b32 s64, 0x380000
buffer_load_dwordx4 v20, s[44:47], s64 offen nt lds
s_add_u32 m0, s83, 16384
s_mov_b32 s64, 0x380000
buffer_load_dwordx4 v21, s[48:51], s64 offen nt lds
s_add_u32 m0, s83, 20480
s_mov_b32 s64, 0x380000
buffer_load_dwordx4 v22, s[4:7], s64 offen nt lds
ds_read_b64_tr_b16 a[24:25], v32 offset:24576
ds_read_b64_tr_b16 a[26:27], v32 offset:25088
ds_read_b64_tr_b16 a[28:29], v32 offset:24584
ds_read_b64_tr_b16 a[30:31], v32 offset:25096
ds_read_b64_tr_b16 a[32:33], v36 offset:24576
ds_read_b64_tr_b16 a[34:35], v36 offset:25088
s_waitcnt vmcnt(33)
s_waitcnt lgkmcnt(0)
s_barrier
s_add_u32 m0, s83, 24576
s_mov_b32 s64, 0x3c0000
buffer_load_dwordx4 v20, s[44:47], s64 offen nt lds
s_add_u32 m0, s83, 28672
s_mov_b32 s64, 0x3c0000
buffer_load_dwordx4 v21, s[48:51], s64 offen nt lds
s_add_u32 m0, s83, 32768
s_mov_b32 s64, 0x3c0000
buffer_load_dwordx4 v22, s[4:7], s64 offen nt lds
ds_read_b64_tr_b16 a[36:37], v32 offset:36864
ds_read_b64_tr_b16 a[38:39], v32 offset:37376
ds_read_b64_tr_b16 a[40:41], v32 offset:36872
ds_read_b64_tr_b16 a[42:43], v32 offset:37384
ds_read_b64_tr_b16 a[44:45], v36 offset:36864
ds_read_b64_tr_b16 a[46:47], v36 offset:37376
s_waitcnt vmcnt(33)
s_waitcnt lgkmcnt(0)
s_barrier
s_add_u32 m0, s83, 36864
s_mov_b32 s64, 0x400000
buffer_load_dwordx4 v20, s[44:47], s64 offen nt lds
s_add_u32 m0, s83, 40960
s_mov_b32 s64, 0x400000
buffer_load_dwordx4 v21, s[48:51], s64 offen nt lds
s_add_u32 m0, s83, 45056
s_mov_b32 s64, 0x400000
buffer_load_dwordx4 v22, s[4:7], s64 offen nt lds
ds_read_b64_tr_b16 a[48:49], v32 offset:49152
ds_read_b64_tr_b16 a[50:51], v32 offset:49664
ds_read_b64_tr_b16 a[52:53], v32 offset:49160
ds_read_b64_tr_b16 a[54:55], v32 offset:49672
ds_read_b64_tr_b16 a[56:57], v36 offset:49152
ds_read_b64_tr_b16 a[58:59], v36 offset:49664
s_waitcnt vmcnt(33)
s_waitcnt lgkmcnt(0)
s_barrier
s_add_u32 m0, s83, 49152
s_mov_b32 s64, 0x440000
buffer_load_dwordx4 v20, s[44:47], s64 offen nt lds
s_add_u32 m0, s83, 53248
s_mov_b32 s64, 0x440000
buffer_load_dwordx4 v21, s[48:51], s64 offen nt lds
s_add_u32 m0, s83, 57344
s_mov_b32 s64, 0x440000
buffer_load_dwordx4 v22, s[4:7], s64 offen nt lds
ds_read_b64_tr_b16 a[60:61], v32 offset:61440
ds_read_b64_tr_b16 a[62:63], v32 offset:61952
ds_read_b64_tr_b16 a[64:65], v32 offset:61448
ds_read_b64_tr_b16 a[66:67], v32 offset:61960
ds_read_b64_tr_b16 a[68:69], v36 offset:61440
ds_read_b64_tr_b16 a[70:71], v36 offset:61952
s_waitcnt vmcnt(33)
s_waitcnt lgkmcnt(0)
s_barrier
s_add_u32 m0, s83, 61440
s_mov_b32 s64, 0x480000
buffer_load_dwordx4 v20, s[44:47], s64 offen nt lds
s_add_u32 m0, s83, 65536
s_mov_b32 s64, 0x480000
buffer_load_dwordx4 v21, s[48:51], s64 offen nt lds
s_add_u32 m0, s83, 69632
s_mov_b32 s64, 0x480000
buffer_load_dwordx4 v22, s[4:7], s64 offen nt lds
ds_read_b64_tr_b16 a[72:73], v33 offset:8192
ds_read_b64_tr_b16 a[74:75], v33 offset:8704
ds_read_b64_tr_b16 a[76:77], v33 offset:8200
ds_read_b64_tr_b16 a[78:79], v33 offset:8712
ds_read_b64_tr_b16 a[80:81], v37 offset:8192
ds_read_b64_tr_b16 a[82:83], v37 offset:8704
s_waitcnt vmcnt(33)
s_waitcnt lgkmcnt(0)
s_barrier
s_add_u32 m0, s83, 73728
s_mov_b32 s64, 0x4c0000
buffer_load_dwordx4 v20, s[44:47], s64 offen nt lds
s_add_u32 m0, s83, 77824
s_mov_b32 s64, 0x4c0000
buffer_load_dwordx4 v21, s[48:51], s64 offen nt lds
s_add_u32 m0, s83, 81920
s_mov_b32 s64, 0x4c0000
buffer_load_dwordx4 v22, s[4:7], s64 offen nt lds
ds_read_b64_tr_b16 a[84:85], v33 offset:20480
ds_read_b64_tr_b16 a[86:87], v33 offset:20992
ds_read_b64_tr_b16 a[88:89], v33 offset:20488
ds_read_b64_tr_b16 a[90:91], v33 offset:21000
ds_read_b64_tr_b16 a[92:93], v37 offset:20480
ds_read_b64_tr_b16 a[94:95], v37 offset:20992
s_waitcnt vmcnt(33)
s_waitcnt lgkmcnt(0)
s_barrier
s_add_u32 m0, s83, 86016
s_mov_b32 s64, 0x500000
buffer_load_dwordx4 v20, s[44:47], s64 offen nt lds
s_add_u32 m0, s83, 90112
s_mov_b32 s64, 0x500000
buffer_load_dwordx4 v21, s[48:51], s64 offen nt lds
s_add_u32 m0, s83, 94208
s_mov_b32 s64, 0x500000
buffer_load_dwordx4 v22, s[4:7], s64 offen nt lds
ds_read_b64_tr_b16 a[96:97], v33 offset:32768
ds_read_b64_tr_b16 a[98:99], v33 offset:33280
ds_read_b64_tr_b16 a[100:101], v33 offset:32776
ds_read_b64_tr_b16 a[102:103], v33 offset:33288
ds_read_b64_tr_b16 a[104:105], v37 offset:32768
ds_read_b64_tr_b16 a[106:107], v37 offset:33280
s_waitcnt vmcnt(33)
s_waitcnt lgkmcnt(0)
s_barrier
s_add_u32 m0, s83, 98304
s_mov_b32 s64, 0x540000
buffer_load_dwordx4 v20, s[44:47], s64 offen nt lds
s_add_u32 m0, s83, 102400
s_mov_b32 s64, 0x540000
buffer_load_dwordx4 v21, s[48:51], s64 offen nt lds
s_add_u32 m0, s83, 106496
s_mov_b32 s64, 0x540000
buffer_load_dwordx4 v22, s[4:7], s64 offen nt lds
ds_read_b64_tr_b16 a[108:109], v33 offset:45056
ds_read_b64_tr_b16 a[110:111], v33 offset:45568
ds_read_b64_tr_b16 a[112:113], v33 offset:45064
ds_read_b64_tr_b16 a[114:115], v33 offset:45576
ds_read_b64_tr_b16 a[116:117], v37 offset:45056
ds_read_b64_tr_b16 a[118:119], v37 offset:45568
s_waitcnt vmcnt(33)
s_waitcnt lgkmcnt(0)
s_barrier
s_add_u32 m0, s83, 110592
s_mov_b32 s64, 0x580000
buffer_load_dwordx4 v20, s[44:47], s64 offen nt lds
s_add_u32 m0, s83, 114688
s_mov_b32 s64, 0x580000
buffer_load_dwordx4 v21, s[48:51], s64 offen nt lds
s_add_u32 m0, s83, 118784
s_mov_b32 s64, 0x580000
buffer_load_dwordx4 v22, s[4:7], s64 offen nt lds
ds_read_b64_tr_b16 a[120:121], v33 offset:57344
ds_read_b64_tr_b16 a[122:123], v33 offset:57856
ds_read_b64_tr_b16 a[124:125], v33 offset:57352
ds_read_b64_tr_b16 a[126:127], v33 offset:57864
ds_read_b64_tr_b16 a[128:129], v37 offset:57344
ds_read_b64_tr_b16 a[130:131], v37 offset:57856
s_waitcnt vmcnt(33)
s_waitcnt lgkmcnt(0)
s_barrier
s_add_u32 m0, s83, 122880
s_mov_b32 s64, 0x5c0000
buffer_load_dwordx4 v20, s[44:47], s64 offen nt lds
s_add_u32 m0, s83, 126976
s_mov_b32 s64, 0x5c0000
buffer_load_dwordx4 v21, s[48:51], s64 offen nt lds
s_add_u32 m0, s83, 131072
s_mov_b32 s64, 0x5c0000
buffer_load_dwordx4 v22, s[4:7], s64 offen nt lds
ds_read_b64_tr_b16 a[132:133], v34 offset:4096
ds_read_b64_tr_b16 a[134:135], v34 offset:4608
ds_read_b64_tr_b16 a[136:137], v34 offset:4104
ds_read_b64_tr_b16 a[138:139], v34 offset:4616
ds_read_b64_tr_b16 a[140:141], v38 offset:4096
ds_read_b64_tr_b16 a[142:143], v38 offset:4608
s_waitcnt vmcnt(33)
s_waitcnt lgkmcnt(0)
s_barrier
s_add_u32 m0, s83, 135168
s_mov_b32 s64, 0x600000
buffer_load_dwordx4 v20, s[44:47], s64 offen nt lds
s_add_u32 m0, s83, 139264
s_mov_b32 s64, 0x600000
buffer_load_dwordx4 v21, s[48:51], s64 offen nt lds
s_add_u32 m0, s83, 143360
s_mov_b32 s64, 0x600000
buffer_load_dwordx4 v22, s[4:7], s64 offen nt lds
ds_read_b64_tr_b16 a[144:145], v34 offset:16384
ds_read_b64_tr_b16 a[146:147], v34 offset:16896
ds_read_b64_tr_b16 a[148:149], v34 offset:16392
ds_read_b64_tr_b16 a[150:151], v34 offset:16904
ds_read_b64_tr_b16 a[152:153], v38 offset:16384
ds_read_b64_tr_b16 a[154:155], v38 offset:16896
s_waitcnt vmcnt(33)
s_waitcnt lgkmcnt(0)
s_barrier
s_add_u32 m0, s83, 147456
s_mov_b32 s64, 0x640000
buffer_load_dwordx4 v20, s[44:47], s64 offen nt lds
s_add_u32 m0, s83, 151552
s_mov_b32 s64, 0x640000
buffer_load_dwordx4 v21, s[48:51], s64 offen nt lds
s_add_u32 m0, s83, 155648
s_mov_b32 s64, 0x640000
buffer_load_dwordx4 v22, s[4:7], s64 offen nt lds
ds_read_b64_tr_b16 a[156:157], v32 offset:0
ds_read_b64_tr_b16 a[158:159], v32 offset:512
ds_read_b64_tr_b16 a[160:161], v32 offset:8
ds_read_b64_tr_b16 a[162:163], v32 offset:520
ds_read_b64_tr_b16 a[164:165], v36 offset:0
ds_read_b64_tr_b16 a[166:167], v36 offset:512
s_waitcnt vmcnt(33)
s_waitcnt lgkmcnt(0)
s_barrier
s_add_u32 m0, s83, 0
s_mov_b32 s64, 0x680000
buffer_load_dwordx4 v20, s[44:47], s64 offen nt lds
s_add_u32 m0, s83, 4096
s_mov_b32 s64, 0x680000
buffer_load_dwordx4 v21, s[48:51], s64 offen nt lds
s_add_u32 m0, s83, 8192
s_mov_b32 s64, 0x680000
buffer_load_dwordx4 v22, s[4:7], s64 offen nt lds
ds_read_b64_tr_b16 a[168:169], v32 offset:12288
ds_read_b64_tr_b16 a[170:171], v32 offset:12800
ds_read_b64_tr_b16 a[172:173], v32 offset:12296
ds_read_b64_tr_b16 a[174:175], v32 offset:12808
ds_read_b64_tr_b16 a[176:177], v36 offset:12288
ds_read_b64_tr_b16 a[178:179], v36 offset:12800
s_waitcnt vmcnt(33)
s_waitcnt lgkmcnt(0)
s_barrier
s_add_u32 m0, s83, 12288
s_mov_b32 s64, 0x6c0000
buffer_load_dwordx4 v20, s[44:47], s64 offen nt lds
s_add_u32 m0, s83, 16384
s_mov_b32 s64, 0x6c0000
buffer_load_dwordx4 v21, s[48:51], s64 offen nt lds
s_add_u32 m0, s83, 20480
s_mov_b32 s64, 0x6c0000
buffer_load_dwordx4 v22, s[4:7], s64 offen nt lds
ds_read_b64_tr_b16 a[180:181], v32 offset:24576
ds_read_b64_tr_b16 a[182:183], v32 offset:25088
ds_read_b64_tr_b16 a[184:185], v32 offset:24584
ds_read_b64_tr_b16 a[186:187], v32 offset:25096
ds_read_b64_tr_b16 a[188:189], v36 offset:24576
ds_read_b64_tr_b16 a[190:191], v36 offset:25088
s_waitcnt vmcnt(33)
s_waitcnt lgkmcnt(0)
s_barrier
s_add_u32 m0, s83, 24576
s_mov_b32 s64, 0x700000
buffer_load_dwordx4 v20, s[44:47], s64 offen nt lds
s_add_u32 m0, s83, 28672
s_mov_b32 s64, 0x700000
buffer_load_dwordx4 v21, s[48:51], s64 offen nt lds
s_add_u32 m0, s83, 32768
s_mov_b32 s64, 0x700000
buffer_load_dwordx4 v22, s[4:7], s64 offen nt lds
ds_read_b64_tr_b16 a[192:193], v32 offset:36864
ds_read_b64_tr_b16 a[194:195], v32 offset:37376
ds_read_b64_tr_b16 a[196:197], v32 offset:36872
ds_read_b64_tr_b16 a[198:199], v32 offset:37384
ds_read_b64_tr_b16 a[200:201], v36 offset:36864
ds_read_b64_tr_b16 a[202:203], v36 offset:37376
s_waitcnt vmcnt(33)
s_waitcnt lgkmcnt(0)
s_barrier
s_add_u32 m0, s83, 36864
s_mov_b32 s64, 0x740000
buffer_load_dwordx4 v20, s[44:47], s64 offen nt lds
s_add_u32 m0, s83, 40960
s_mov_b32 s64, 0x740000
buffer_load_dwordx4 v21, s[48:51], s64 offen nt lds
s_add_u32 m0, s83, 45056
s_mov_b32 s64, 0x740000
buffer_load_dwordx4 v22, s[4:7], s64 offen nt lds
ds_read_b64_tr_b16 a[204:205], v32 offset:49152
ds_read_b64_tr_b16 a[206:207], v32 offset:49664
ds_read_b64_tr_b16 a[208:209], v32 offset:49160
ds_read_b64_tr_b16 a[210:211], v32 offset:49672
ds_read_b64_tr_b16 a[212:213], v36 offset:49152
ds_read_b64_tr_b16 a[214:215], v36 offset:49664
s_waitcnt vmcnt(33)
s_waitcnt lgkmcnt(0)
s_barrier
s_add_u32 m0, s83, 49152
s_mov_b32 s64, 0x780000
buffer_load_dwordx4 v20, s[44:47], s64 offen nt lds
s_add_u32 m0, s83, 53248
s_mov_b32 s64, 0x780000
buffer_load_dwordx4 v21, s[48:51], s64 offen nt lds
s_add_u32 m0, s83, 57344
s_mov_b32 s64, 0x780000
buffer_load_dwordx4 v22, s[4:7], s64 offen nt lds
ds_read_b64_tr_b16 a[216:217], v32 offset:61440
ds_read_b64_tr_b16 a[218:219], v32 offset:61952
ds_read_b64_tr_b16 a[220:221], v32 offset:61448
ds_read_b64_tr_b16 a[222:223], v32 offset:61960
ds_read_b64_tr_b16 a[224:225], v36 offset:61440
ds_read_b64_tr_b16 a[226:227], v36 offset:61952
s_waitcnt vmcnt(33)
s_waitcnt lgkmcnt(0)
s_barrier
s_add_u32 m0, s83, 61440
s_mov_b32 s64, 0x7c0000
buffer_load_dwordx4 v20, s[44:47], s64 offen nt lds
s_add_u32 m0, s83, 65536
s_mov_b32 s64, 0x7c0000
buffer_load_dwordx4 v21, s[48:51], s64 offen nt lds
s_add_u32 m0, s83, 69632
s_mov_b32 s64, 0x7c0000
buffer_load_dwordx4 v22, s[4:7], s64 offen nt lds
ds_read_b64_tr_b16 a[228:229], v33 offset:8192
ds_read_b64_tr_b16 a[230:231], v33 offset:8704
ds_read_b64_tr_b16 a[232:233], v33 offset:8200
ds_read_b64_tr_b16 a[234:235], v33 offset:8712
ds_read_b64_tr_b16 a[236:237], v37 offset:8192
ds_read_b64_tr_b16 a[238:239], v37 offset:8704
s_waitcnt vmcnt(33)
s_waitcnt lgkmcnt(0)
s_barrier
ds_read_b64_tr_b16 a[240:241], v33 offset:20480
ds_read_b64_tr_b16 a[242:243], v33 offset:20992
ds_read_b64_tr_b16 a[244:245], v33 offset:20488
ds_read_b64_tr_b16 a[246:247], v33 offset:21000
ds_read_b64_tr_b16 a[248:249], v37 offset:20480
ds_read_b64_tr_b16 a[250:251], v37 offset:20992
s_waitcnt vmcnt(30)
s_waitcnt lgkmcnt(0)
s_barrier
ds_read_b64_tr_b16 a[252:253], v33 offset:32768
ds_read_b64_tr_b16 a[254:255], v33 offset:33280
ds_read_b64_tr_b16 v[128:129], v33 offset:32776
ds_read_b64_tr_b16 v[130:131], v33 offset:33288
ds_read_b64_tr_b16 v[132:133], v37 offset:32768
ds_read_b64_tr_b16 v[134:135], v37 offset:33280
s_waitcnt vmcnt(27)
s_waitcnt lgkmcnt(0)
s_barrier
ds_read_b64_tr_b16 v[136:137], v33 offset:45056
ds_read_b64_tr_b16 v[138:139], v33 offset:45568
ds_read_b64_tr_b16 v[140:141], v33 offset:45064
ds_read_b64_tr_b16 v[142:143], v33 offset:45576
ds_read_b64_tr_b16 v[144:145], v37 offset:45056
ds_read_b64_tr_b16 v[146:147], v37 offset:45568
s_waitcnt vmcnt(24)
s_waitcnt lgkmcnt(0)
s_barrier
ds_read_b64_tr_b16 v[148:149], v33 offset:57344
ds_read_b64_tr_b16 v[150:151], v33 offset:57856
ds_read_b64_tr_b16 v[152:153], v33 offset:57352
ds_read_b64_tr_b16 v[154:155], v33 offset:57864
ds_read_b64_tr_b16 v[156:157], v37 offset:57344
ds_read_b64_tr_b16 v[158:159], v37 offset:57856
s_waitcnt vmcnt(21)
s_waitcnt lgkmcnt(0)
s_barrier
ds_read_b64_tr_b16 v[160:161], v34 offset:4096
ds_read_b64_tr_b16 v[162:163], v34 offset:4608
ds_read_b64_tr_b16 v[164:165], v34 offset:4104
ds_read_b64_tr_b16 v[166:167], v34 offset:4616
ds_read_b64_tr_b16 v[168:169], v38 offset:4096
ds_read_b64_tr_b16 v[170:171], v38 offset:4608
s_waitcnt vmcnt(18)
s_waitcnt lgkmcnt(0)
s_barrier
ds_read_b64_tr_b16 v[172:173], v34 offset:16384
ds_read_b64_tr_b16 v[174:175], v34 offset:16896
ds_read_b64_tr_b16 v[176:177], v34 offset:16392
ds_read_b64_tr_b16 v[178:179], v34 offset:16904
ds_read_b64_tr_b16 v[180:181], v38 offset:16384
ds_read_b64_tr_b16 v[182:183], v38 offset:16896
s_waitcnt vmcnt(15)
s_waitcnt lgkmcnt(0)
s_barrier
ds_read_b64_tr_b16 v[184:185], v32 offset:0
ds_read_b64_tr_b16 v[186:187], v32 offset:512
ds_read_b64_tr_b16 v[188:189], v32 offset:8
ds_read_b64_tr_b16 v[190:191], v32 offset:520
ds_read_b64_tr_b16 v[192:193], v36 offset:0
ds_read_b64_tr_b16 v[194:195], v36 offset:512
s_waitcnt vmcnt(12)
s_waitcnt lgkmcnt(0)
s_barrier
ds_read_b64_tr_b16 v[196:197], v32 offset:12288
ds_read_b64_tr_b16 v[198:199], v32 offset:12800
ds_read_b64_tr_b16 v[200:201], v32 offset:12296
ds_read_b64_tr_b16 v[202:203], v32 offset:12808
ds_read_b64_tr_b16 v[204:205], v36 offset:12288
ds_read_b64_tr_b16 v[206:207], v36 offset:12800
s_waitcnt vmcnt(9)
s_waitcnt lgkmcnt(0)
s_barrier
ds_read_b64_tr_b16 v[208:209], v32 offset:24576
ds_read_b64_tr_b16 v[210:211], v32 offset:25088
ds_read_b64_tr_b16 v[212:213], v32 offset:24584
ds_read_b64_tr_b16 v[214:215], v32 offset:25096
ds_read_b64_tr_b16 v[216:217], v36 offset:24576
ds_read_b64_tr_b16 v[218:219], v36 offset:25088
s_waitcnt vmcnt(6)
s_waitcnt lgkmcnt(0)
s_barrier
ds_read_b64_tr_b16 v[220:221], v32 offset:36864
ds_read_b64_tr_b16 v[222:223], v32 offset:37376
ds_read_b64_tr_b16 v[224:225], v32 offset:36872
ds_read_b64_tr_b16 v[226:227], v32 offset:37384
ds_read_b64_tr_b16 v[228:229], v36 offset:36864
ds_read_b64_tr_b16 v[230:231], v36 offset:37376
s_waitcnt vmcnt(3)
s_waitcnt lgkmcnt(0)
s_barrier
ds_read_b64_tr_b16 v[232:233], v32 offset:49152
ds_read_b64_tr_b16 v[234:235], v32 offset:49664
ds_read_b64_tr_b16 v[236:237], v32 offset:49160
ds_read_b64_tr_b16 v[238:239], v32 offset:49672
ds_read_b64_tr_b16 v[240:241], v36 offset:49152
ds_read_b64_tr_b16 v[242:243], v36 offset:49664
s_waitcnt vmcnt(0)
s_waitcnt lgkmcnt(0)
s_barrier
ds_read_b64_tr_b16 v[244:245], v32 offset:61440
ds_read_b64_tr_b16 v[246:247], v32 offset:61952
ds_read_b64_tr_b16 v[248:249], v32 offset:61448
ds_read_b64_tr_b16 v[250:251], v32 offset:61960
ds_read_b64_tr_b16 v[252:253], v36 offset:61440
ds_read_b64_tr_b16 v[254:255], v36 offset:61952
s_waitcnt lgkmcnt(0)
s_barrier
s_cmp_lg_u32 s62, 0
s_cbranch_scc1 L_cd_178
v_mbcnt_lo_u32_b32 v17, -1, 0
v_mbcnt_hi_u32_b32 v17, -1, v17
v_lshlrev_b32 v17, 2, v17
L_ct_179:
buffer_load_dword v18, v17, s[40:43], 0 offen sc1
s_mov_b32 s64, 0x10001000
s_mov_b32 s65, 0x10001000
s_waitcnt vmcnt(0)
v_cmp_ne_u32 vcc, 64, v18
s_nop 0
s_and_b64 s[64:65], s[64:65], vcc
s_cbranch_scc0 L_co_180
s_sleep 12
s_add_u32 s63, s63, 1
s_cmp_lt_u32 s63, 0x20000
s_cbranch_scc1 L_ct_179
s_branch L_giveup
L_co_180:
v_cmp_ne_u32 vcc, 32, v18
s_mov_b32 s64, 0x110011
s_mov_b32 s65, 0x110011
s_and_b64 s[64:65], s[64:65], vcc
s_cbranch_scc1 L_recensus
L_sd_181:
v_readlane_b32 s64, v18, 2
s_nop 0
s_cmp_lg_u32 s64, 0
s_cbranch_scc1 L_sk_182
s_sleep 4
buffer_load_dword v18, v17, s[40:43], 0 offen sc1
s_waitcnt vmcnt(0)
s_add_u32 s63, s63, 1
s_cmp_lt_u32 s63, 0x20000
s_cbranch_scc1 L_sd_181
s_branch L_giveup
L_sk_182:
s_cmp_eq_u32 s64, 2
s_cselect_b32 s64, 0x200000, 0
s_add_u32 s64, s64, 0x6000
s_add_u32 s36, s34, s64
s_addc_u32 s37, s35, 0
s_and_b32 s37, s37, 0xffff
L_cd_178:
s_mov_b32 s59, 0
s_mov_b32 s84, 0x400000
s_mov_b32 s85, s81
s_mov_b32 s86, 1
L_fx0_183:
buffer_load_dword v96, v4, s[36:39], 0 offen sc1
s_waitcnt vmcnt(0)
v_cmp_gt_u32 vcc, s86, v96
s_cbranch_vccz L_fx0_ok_184
s_add_u32 s63, s63, 1
s_cmp_lt_u32 s63, 0x20000
s_cbranch_scc1 L_fx0_183
s_branch L_giveup
L_fx0_ok_184:
s_add_u32 s87, s84, 32768
s_add_u32 s88, s85, 32768
s_add_u32 s64, s85, 0
s_add_u32 s65, s84, 0
s_mov_b32 m0, s64
s_nop 0
buffer_load_dwordx4 v5, s[36:39], s65 offen offset:0 sc1 lds
buffer_load_dwordx4 v5, s[36:39], s65 offen offset:1024 sc1 lds
buffer_load_dwordx4 v5, s[36:39], s65 offen offset:2048 sc1 lds
buffer_load_dwordx4 v5, s[36:39], s65 offen offset:3072 sc1 lds
s_add_u32 s64, s85, 4096
s_add_u32 s65, s84, 4096
s_mov_b32 m0, s64
s_nop 0
buffer_load_dwordx4 v5, s[36:39], s65 offen offset:0 sc1 lds
buffer_load_dwordx4 v5, s[36:39], s65 offen offset:1024 sc1 lds
buffer_load_dwordx4 v5, s[36:39], s65 offen offset:2048 sc1 lds
buffer_load_dwordx4 v5, s[36:39], s65 offen offset:3072 sc1 lds
s_add_u32 s64, s88, 0
s_add_u32 s65, s87, 0
s_mov_b32 m0, s64
s_nop 0
buffer_load_dwordx4 v5, s[36:39], s65 offen offset:0 sc1 lds
buffer_load_dwordx4 v5, s[36:39], s65 offen offset:1024 sc1 lds
buffer_load_dwordx4 v5, s[36:39], s65 offen offset:2048 sc1 lds
buffer_load_dwordx4 v5, s[36:39], s65 offen offset:3072 sc1 lds
s_add_u32 s64, s88, 4096
s_add_u32 s65, s87, 4096
s_mov_b32 m0, s64
s_nop 0
buffer_load_dwordx4 v5, s[36:39], s65 offen offset:0 sc1 lds
buffer_load_dwordx4 v5, s[36:39], s65 offen offset:1024 sc1 lds
buffer_load_dwordx4 v5, s[36:39], s65 offen offset:2048 sc1 lds
buffer_load_dwordx4 v5, s[36:39], s65 offen offset:3072 sc1 lds
s_add_u32 s83, s82, 4096
v_mov_b32 v8, v2
v_xor_b32 v4, 0x1000, v4
buffer_load_dword v108, v4, s[36:39], 0 offen sc1
s_waitcnt vmcnt(0)
L_qkv_top:
s_waitcnt vmcnt(3)
s_barrier
ds_read_b128 v[48:51], v8 offset:0
ds_read_b128 v[52:55], v8 offset:32768
ds_read_b128 v[56:59], v8 offset:1024
ds_read_b128 v[60:63], v8 offset:33792
ds_read_b128 v[64:67], v8 offset:2048
ds_read_b128 v[68:71], v8 offset:34816
s_add_u32 s84, s84, 0x10000
s_xor_b32 s85, s85, 0x10000
s_add_u32 s87, s84, 32768
s_add_u32 s88, s85, 32768
s_add_u32 s86, s59, 3
s_lshr_b32 s86, s86, 1
s_min_u32 s86, s86, 32
s_waitcnt vmcnt(3)
v_cmp_gt_u32 vcc, s86, v108
s_cbranch_vccz L_fx_ok_186
L_fx_185:
buffer_load_dword v108, v4, s[36:39], 0 offen sc1
s_waitcnt vmcnt(0)
v_cmp_gt_u32 vcc, s86, v108
s_cbranch_vccz L_fx_ok_186
s_add_u32 s63, s63, 1
s_cmp_lt_u32 s63, 0x20000
s_cbranch_scc1 L_fx_185
s_branch L_giveup
L_fx_ok_186:
v_xor_b32 v4, 0x1000, v4
s_waitcnt lgkmcnt(4)
v_mfma_f32_16x16x32_bf16 v[16:19], a[0:3], v[48:51], 0
ds_read_b128 v[72:75], v8 offset:3072
ds_read_b128 v[76:79], v8 offset:35840
v_mfma_f32_16x16x32_bf16 v[20:23], a[0:3], v[52:55], 0
v_mfma_f32_16x16x32_bf16 v[24:27], a[4:7], v[48:51], 0
v_mfma_f32_16x16x32_bf16 v[28:31], a[4:7], v[52:55], 0
s_add_u32 s64, s85, 0
s_add_u32 s65, s84, 0
s_mov_b32 m0, s64
s_nop 0
buffer_load_dwordx4 v5, s[36:39], s65 offen offset:0 sc1 lds
v_mfma_f32_16x16x32_bf16 v[32:35], v[48:51], a[8:11], 0
v_mfma_f32_16x16x32_bf16 v[36:39], v[52:55], a[8:11], 0
s_waitcnt lgkmcnt(4)
v_mfma_f32_16x16x32_bf16 v[16:19], a[12:15], v[56:59], v[16:19]
ds_read_b128 v[48:51], v8 offset:4096
ds_read_b128 v[52:55], v8 offset:36864
v_mfma_f32_16x16x32_bf16 v[20:23], a[12:15], v[60:63], v[20:23]
v_mfma_f32_16x16x32_bf16 v[24:27], a[16:19], v[56:59], v[24:27]
v_mfma_f32_16x16x32_bf16 v[28:31], a[16:19], v[60:63], v[28:31]
buffer_load_dwordx4 v5, s[36:39], s65 offen offset:1024 sc1 lds
v_mfma_f32_16x16x32_bf16 v[32:35], v[56:59], a[20:23], v[32:35]
v_mfma_f32_16x16x32_bf16 v[36:39], v[60:63], a[20:23], v[36:39]
s_waitcnt lgkmcnt(4)
v_mfma_f32_16x16x32_bf16 v[16:19], a[24:27], v[64:67], v[16:19]
ds_read_b128 v[56:59], v8 offset:5120
ds_read_b128 v[60:63], v8 offset:37888
v_mfma_f32_16x16x32_bf16 v[20:23], a[24:27], v[68:71], v[20:23]
v_mfma_f32_16x16x32_bf16 v[24:27], a[28:31], v[64:67], v[24:27]
v_mfma_f32_16x16x32_bf16 v[28:31], a[28:31], v[68:71], v[28:31]
buffer_load_dwordx4 v5, s[36:39], s65 offen offset:2048 sc1 lds
v_mfma_f32_16x16x32_bf16 v[32:35], v[64:67], a[32:35], v[32:35]
v_mfma_f32_16x16x32_bf16 v[36:39], v[68:71], a[32:35], v[36:39]
s_waitcnt lgkmcnt(4)
v_mfma_f32_16x16x32_bf16 v[16:19], a[36:39], v[72:75], v[16:19]
ds_read_b128 v[64:67], v8 offset:6144
ds_read_b128 v[68:71], v8 offset:38912
v_mfma_f32_16x16x32_bf16 v[20:23], a[36:39], v[76:79], v[20:23]
v_mfma_f32_16x16x32_bf16 v[24:27], a[40:43], v[72:75], v[24:27]
v_mfma_f32_16x16x32_bf16 v[28:31], a[40:43], v[76:79], v[28:31]
buffer_load_dwordx4 v5, s[36:39], s65 offen offset:3072 sc1 lds
v_mfma_f32_16x16x32_bf16 v[32:35], v[72:75], a[44:47], v[32:35]
v_mfma_f32_16x16x32_bf16 v[36:39], v[76:79], a[44:47], v[36:39]
s_waitcnt lgkmcnt(4)
v_mfma_f32_16x16x32_bf16 v[16:19], a[48:51], v[48:51], v[16:19]
ds_read_b128 v[72:75], v8 offset:7168
ds_read_b128 v[76:79], v8 offset:39936
v_mfma_f32_16x16x32_bf16 v[20:23], a[48:51], v[52:55], v[20:23]
v_mfma_f32_16x16x32_bf16 v[24:27], a[52:55], v[48:51], v[24:27]
v_mfma_f32_16x16x32_bf16 v[28:31], a[52:55], v[52:55], v[28:31]
s_add_u32 s64, s85, 4096
s_add_u32 s65, s84, 4096
s_mov_b32 m0, s64
s_nop 0
buffer_load_dwordx4 v5, s[36:39], s65 offen offset:0 sc1 lds
v_mfma_f32_16x16x32_bf16 v[32:35], v[48:51], a[56:59], v[32:35]
v_mfma_f32_16x16x32_bf16 v[36:39], v[52:55], a[56:59], v[36:39]
s_waitcnt lgkmcnt(4)
v_mfma_f32_16x16x32_bf16 v[16:19], a[60:63], v[56:59], v[16:19]
ds_read_b128 v[48:51], v8 offset:8192
ds_read_b128 v[52:55], v8 offset:40960
v_mfma_f32_16x16x32_bf16 v[20:23], a[60:63], v[60:63], v[20:23]
v_mfma_f32_16x16x32_bf16 v[24:27], a[64:67], v[56:59], v[24:27]
v_mfma_f32_16x16x32_bf16 v[28:31], a[64:67], v[60:63], v[28:31]
buffer_load_dwordx4 v5, s[36:39], s65 offen offset:1024 sc1 lds
v_mfma_f32_16x16x32_bf16 v[32:35], v[56:59], a[68:71], v[32:35]
v_mfma_f32_16x16x32_bf16 v[36:39], v[60:63], a[68:71], v[36:39]
s_waitcnt lgkmcnt(4)
v_mfma_f32_16x16x32_bf16 v[16:19], a[72:75], v[64:67], v[16:19]
ds_read_b128 v[56:59], v8 offset:9216
ds_read_b128 v[60:63], v8 offset:41984
v_mfma_f32_16x16x32_bf16 v[20:23], a[72:75], v[68:71], v[20:23]
v_mfma_f32_16x16x32_bf16 v[24:27], a[76:79], v[64:67], v[24:27]
v_mfma_f32_16x16x32_bf16 v[28:31], a[76:79], v[68:71], v[28:31]
buffer_load_dwordx4 v5, s[36:39], s65 offen offset:2048 sc1 lds
v_mfma_f32_16x16x32_bf16 v[32:35], v[64:67], a[80:83], v[32:35]
v_mfma_f32_16x16x32_bf16 v[36:39], v[68:71], a[80:83], v[36:39]
s_waitcnt lgkmcnt(4)
v_mfma_f32_16x16x32_bf16 v[16:19], a[84:87], v[72:75], v[16:19]
ds_read_b128 v[64:67], v8 offset:10240
ds_read_b128 v[68:71], v8 offset:43008
v_mfma_f32_16x16x32_bf16 v[20:23], a[84:87], v[76:79], v[20:23]
v_mfma_f32_16x16x32_bf16 v[24:27], a[88:91], v[72:75], v[24:27]
v_mfma_f32_16x16x32_bf16 v[28:31], a[88:91], v[76:79], v[28:31]
buffer_load_dwordx4 v5, s[36:39], s65 offen offset:3072 sc1 lds
v_mfma_f32_16x16x32_bf16 v[32:35], v[72:75], a[92:95], v[32:35]
v_mfma_f32_16x16x32_bf16 v[36:39], v[76:79], a[92:95], v[36:39]
s_waitcnt lgkmcnt(4)
v_mfma_f32_16x16x32_bf16 v[16:19], a[96:99], v[48:51], v[16:19]
ds_read_b128 v[72:75], v8 offset:11264
ds_read_b128 v[76:79], v8 offset:44032
v_mfma_f32_16x16x32_bf16 v[20:23], a[96:99], v[52:55], v[20:23]
v_mfma_f32_16x16x32_bf16 v[24:27], a[100:103], v[48:51], v[24:27]
v_mfma_f32_16x16x32_bf16 v[28:31], a[100:103], v[52:55], v[28:31]
s_add_u32 s64, s88, 0
s_add_u32 s65, s87, 0
s_mov_b32 m0, s64
s_nop 0
buffer_load_dwordx4 v5, s[36:39], s65 offen offset:0 sc1 lds
v_mfma_f32_16x16x32_bf16 v[32:35], v[48:51], a[104:107], v[32:35]
v_mfma_f32_16x16x32_bf16 v[36:39], v[52:55], a[104:107], v[36:39]
s_waitcnt lgkmcnt(4)
v_mfma_f32_16x16x32_bf16 v[16:19], a[108:111], v[56:59], v[16:19]
ds_read_b128 v[48:51], v8 offset:12288
ds_read_b128 v[52:55], v8 offset:45056
v_mfma_f32_16x16x32_bf16 v[20:23], a[108:111], v[60:63], v[20:23]
v_mfma_f32_16x16x32_bf16 v[24:27], a[112:115], v[56:59], v[24:27]
v_mfma_f32_16x16x32_bf16 v[28:31], a[112:115], v[60:63], v[28:31]
buffer_load_dwordx4 v5, s[36:39], s65 offen offset:1024 sc1 lds
v_mfma_f32_16x16x32_bf16 v[32:35], v[56:59], a[116:119], v[32:35]
v_mfma_f32_16x16x32_bf16 v[36:39], v[60:63], a[116:119], v[36:39]
s_waitcnt lgkmcnt(4)
v_mfma_f32_16x16x32_bf16 v[16:19], a[120:123], v[64:67], v[16:19]
ds_read_b128 v[56:59], v8 offset:13312
ds_read_b128 v[60:63], v8 offset:46080
v_mfma_f32_16x16x32_bf16 v[20:23], a[120:123], v[68:71], v[20:23]
v_mfma_f32_16x16x32_bf16 v[24:27], a[124:127], v[64:67], v[24:27]
v_mfma_f32_16x16x32_bf16 v[28:31], a[124:127], v[68:71], v[28:31]
buffer_load_dwordx4 v5, s[36:39], s65 offen offset:2048 sc1 lds
v_mfma_f32_16x16x32_bf16 v[32:35], v[64:67], a[128:131], v[32:35]
v_mfma_f32_16x16x32_bf16 v[36:39], v[68:71], a[128:131], v[36:39]
s_waitcnt lgkmcnt(4)
v_mfma_f32_16x16x32_bf16 v[16:19], a[132:135], v[72:75], v[16:19]
ds_read_b128 v[64:67], v8 offset:14336
ds_read_b128 v[68:71], v8 offset:47104
v_mfma_f32_16x16x32_bf16 v[20:23], a[132:135], v[76:79], v[20:23]
v_mfma_f32_16x16x32_bf16 v[24:27], a[136:139], v[72:75], v[24:27]
v_mfma_f32_16x16x32_bf16 v[28:31], a[136:139], v[76:79], v[28:31]
buffer_load_dwordx4 v5, s[36:39], s65 offen offset:3072 sc1 lds
v_mfma_f32_16x16x32_bf16 v[32:35], v[72:75], a[140:143], v[32:35]
v_mfma_f32_16x16x32_bf16 v[36:39], v[76:79], a[140:143], v[36:39]
s_waitcnt lgkmcnt(4)
v_mfma_f32_16x16x32_bf16 v[16:19], a[144:147], v[48:51], v[16:19]
ds_read_b128 v[72:75], v8 offset:15360
ds_read_b128 v[76:79], v8 offset:48128
v_mfma_f32_16x16x32_bf16 v[20:23], a[144:147], v[52:55], v[20:23]
v_mfma_f32_16x16x32_bf16 v[24:27], a[148:151], v[48:51], v[24:27]
v_mfma_f32_16x16x32_bf16 v[28:31], a[148:151], v[52:55], v[28:31]
s_add_u32 s64, s88, 4096
s_add_u32 s65, s87, 4096
s_mov_b32 m0, s64
s_nop 0
buffer_load_dwordx4 v5, s[36:39], s65 offen offset:0 sc1 lds
v_mfma_f32_16x16x32_bf16 v[32:35], v[48:51], a[152:155], v[32:35]
v_mfma_f32_16x16x32_bf16 v[36:39], v[52:55], a[152:155], v[36:39]
s_waitcnt lgkmcnt(4)
v_mfma_f32_16x16x32_bf16 v[16:19], a[156:159], v[56:59], v[16:19]
ds_read_b128 v[48:51], v8 offset:16384
ds_read_b128 v[52:55], v8 offset:49152
v_mfma_f32_16x16x32_bf16 v[20:23], a[156:159], v[60:63], v[20:23]
v_mfma_f32_16x16x32_bf16 v[24:27], a[160:163], v[56:59], v[24:27]
v_mfma_f32_16x16x32_bf16 v[28:31], a[160:163], v[60:63], v[28:31]
buffer_load_dwordx4 v5, s[36:39], s65 offen offset:1024 sc1 lds
v_mfma_f32_16x16x32_bf16 v[32:35], v[56:59], a[164:167], v[32:35]
v_mfma_f32_16x16x32_bf16 v[36:39], v[60:63], a[164:167], v[36:39]
s_waitcnt lgkmcnt(4)
v_mfma_f32_16x16x32_bf16 v[16:19], a[168:171], v[64:67], v[16:19]
ds_read_b128 v[56:59], v8 offset:17408
ds_read_b128 v[60:63], v8 offset:50176
v_mfma_f32_16x16x32_bf16 v[20:23], a[168:171], v[68:71], v[20:23]
v_mfma_f32_16x16x32_bf16 v[24:27], a[172:175], v[64:67], v[24:27]
v_mfma_f32_16x16x32_bf16 v[28:31], a[172:175], v[68:71], v[28:31]
buffer_load_dwordx4 v5, s[36:39], s65 offen offset:2048 sc1 lds
v_mfma_f32_16x16x32_bf16 v[32:35], v[64:67], a[176:179], v[32:35]
v_mfma_f32_16x16x32_bf16 v[36:39], v[68:71], a[176:179], v[36:39]
s_waitcnt lgkmcnt(4)
v_mfma_f32_16x16x32_bf16 v[16:19], a[180:183], v[72:75], v[16:19]
ds_read_b128 v[64:67], v8 offset:18432
ds_read_b128 v[68:71], v8 offset:51200
v_mfma_f32_16x16x32_bf16 v[20:23], a[180:183], v[76:79], v[20:23]
v_mfma_f32_16x16x32_bf16 v[24:27], a[184:187], v[72:75], v[24:27]
v_mfma_f32_16x16x32_bf16 v[28:31], a[184:187], v[76:79], v[28:31]
buffer_load_dwordx4 v5, s[36:39], s65 offen offset:3072 sc1 lds
v_mfma_f32_16x16x32_bf16 v[32:35], v[72:75], a[188:191], v[32:35]
v_mfma_f32_16x16x32_bf16 v[36:39], v[76:79], a[188:191], v[36:39]
s_waitcnt lgkmcnt(4)
v_mfma_f32_16x16x32_bf16 v[16:19], a[192:195], v[48:51], v[16:19]
ds_read_b128 v[72:75], v8 offset:19456
ds_read_b128 v[76:79], v8 offset:52224
v_mfma_f32_16x16x32_bf16 v[20:23], a[192:195], v[52:55], v[20:23]
v_mfma_f32_16x16x32_bf16 v[24:27], a[196:199], v[48:51], v[24:27]
v_mfma_f32_16x16x32_bf16 v[28:31], a[196:199], v[52:55], v[28:31]
v_mfma_f32_16x16x32_bf16 v[32:35], v[48:51], a[200:203], v[32:35]
v_mfma_f32_16x16x32_bf16 v[36:39], v[52:55], a[200:203], v[36:39]
s_waitcnt lgkmcnt(4)
v_mfma_f32_16x16x32_bf16 v[16:19], a[204:207], v[56:59], v[16:19]
ds_read_b128 v[48:51], v8 offset:20480
ds_read_b128 v[52:55], v8 offset:53248
v_mfma_f32_16x16x32_bf16 v[20:23], a[204:207], v[60:63], v[20:23]
v_mfma_f32_16x16x32_bf16 v[24:27], a[208:211], v[56:59], v[24:27]
v_mfma_f32_16x16x32_bf16 v[28:31], a[208:211], v[60:63], v[28:31]
v_mfma_f32_16x16x32_bf16 v[32:35], v[56:59], a[212:215], v[32:35]
v_mfma_f32_16x16x32_bf16 v[36:39], v[60:63], a[212:215], v[36:39]
s_waitcnt lgkmcnt(4)
v_mfma_f32_16x16x32_bf16 v[16:19], a[216:219], v[64:67], v[16:19]
ds_read_b128 v[56:59], v8 offset:21504
ds_read_b128 v[60:63], v8 offset:54272
v_mfma_f32_16x16x32_bf16 v[20:23], a[216:219], v[68:71], v[20:23]
v_mfma_f32_16x16x32_bf16 v[24:27], a[220:223], v[64:67], v[24:27]
v_mfma_f32_16x16x32_bf16 v[28:31], a[220:223], v[68:71], v[28:31]
s_waitcnt vmcnt(16)
v_mov_b32 v109, s59
buffer_store_dword v109, v3, s[36:39], 0 offen sc1
v_mfma_f32_16x16x32_bf16 v[32:35], v[64:67], a[224:227], v[32:35]
v_mfma_f32_16x16x32_bf16 v[36:39], v[68:71], a[224:227], v[36:39]
s_waitcnt lgkmcnt(4)
v_mfma_f32_16x16x32_bf16 v[16:19], a[228:231], v[72:75], v[16:19]
ds_read_b128 v[64:67], v8 offset:22528
ds_read_b128 v[68:71], v8 offset:55296
v_mfma_f32_16x16x32_bf16 v[20:23], a[228:231], v[76:79], v[20:23]
v_mfma_f32_16x16x32_bf16 v[24:27], a[232:235], v[72:75], v[24:27]
v_mfma_f32_16x16x32_bf16 v[28:31], a[232:235], v[76:79], v[28:31]
v_mfma_f32_16x16x32_bf16 v[32:35], v[72:75], a[236:239], v[32:35]
v_mfma_f32_16x16x32_bf16 v[36:39], v[76:79], a[236:239], v[36:39]
s_waitcnt lgkmcnt(4)
v_mfma_f32_16x16x32_bf16 v[16:19], a[240:243], v[48:51], v[16:19]
ds_read_b128 v[72:75], v8 offset:23552
ds_read_b128 v[76:79], v8 offset:56320
v_mfma_f32_16x16x32_bf16 v[20:23], a[240:243], v[52:55], v[20:23]
v_mfma_f32_16x16x32_bf16 v[24:27], a[244:247], v[48:51], v[24:27]
v_mfma_f32_16x16x32_bf16 v[28:31], a[244:247], v[52:55], v[28:31]
v_mfma_f32_16x16x32_bf16 v[32:35], v[48:51], a[248:251], v[32:35]
v_mfma_f32_16x16x32_bf16 v[36:39], v[52:55], a[248:251], v[36:39]
s_waitcnt lgkmcnt(4)
v_mfma_f32_16x16x32_bf16 v[16:19], a[252:255], v[56:59], v[16:19]
ds_read_b128 v[48:51], v8 offset:24576
ds_read_b128 v[52:55], v8 offset:57344
v_mfma_f32_16x16x32_bf16 v[20:23], a[252:255], v[60:63], v[20:23]
v_mfma_f32_16x16x32_bf16 v[24:27], v[128:131], v[56:59], v[24:27]
v_mfma_f32_16x16x32_bf16 v[28:31], v[128:131], v[60:63], v[28:31]
v_mfma_f32_16x16x32_bf16 v[32:35], v[56:59], v[132:135], v[32:35]
v_mfma_f32_16x16x32_bf16 v[36:39], v[60:63], v[132:135], v[36:39]
s_waitcnt lgkmcnt(4)
v_mfma_f32_16x16x32_bf16 v[16:19], v[136:139], v[64:67], v[16:19]
ds_read_b128 v[56:59], v8 offset:25600
ds_read_b128 v[60:63], v8 offset:58368
v_mfma_f32_16x16x32_bf16 v[20:23], v[136:139], v[68:71], v[20:23]
v_mfma_f32_16x16x32_bf16 v[24:27], v[140:143], v[64:67], v[24:27]
v_mfma_f32_16x16x32_bf16 v[28:31], v[140:143], v[68:71], v[28:31]
v_mfma_f32_16x16x32_bf16 v[32:35], v[64:67], v[144:147], v[32:35]
v_mfma_f32_16x16x32_bf16 v[36:39], v[68:71], v[144:147], v[36:39]
s_waitcnt lgkmcnt(4)
v_mfma_f32_16x16x32_bf16 v[16:19], v[148:151], v[72:75], v[16:19]
ds_read_b128 v[64:67], v8 offset:26624
ds_read_b128 v[68:71], v8 offset:59392
v_mfma_f32_16x16x32_bf16 v[20:23], v[148:151], v[76:79], v[20:23]
v_mfma_f32_16x16x32_bf16 v[24:27], v[152:155], v[72:75], v[24:27]
v_mfma_f32_16x16x32_bf16 v[28:31], v[152:155], v[76:79], v[28:31]
v_mfma_f32_16x16x32_bf16 v[32:35], v[72:75], v[156:159], v[32:35]
v_mfma_f32_16x16x32_bf16 v[36:39], v[76:79], v[156:159], v[36:39]
s_waitcnt lgkmcnt(4)
v_mfma_f32_16x16x32_bf16 v[16:19], v[160:163], v[48:51], v[16:19]
ds_read_b128 v[72:75], v8 offset:27648
ds_read_b128 v[76:79], v8 offset:60416
v_mfma_f32_16x16x32_bf16 v[20:23], v[160:163], v[52:55], v[20:23]
v_mfma_f32_16x16x32_bf16 v[24:27], v[164:167], v[48:51], v[24:27]
v_mfma_f32_16x16x32_bf16 v[28:31], v[164:167], v[52:55], v[28:31]
v_mfma_f32_16x16x32_bf16 v[32:35], v[48:51], v[168:171], v[32:35]
v_mfma_f32_16x16x32_bf16 v[36:39], v[52:55], v[168:171], v[36:39]
s_waitcnt lgkmcnt(4)
v_mfma_f32_16x16x32_bf16 v[16:19], v[172:175], v[56:59], v[16:19]
ds_read_b128 v[48:51], v8 offset:28672
ds_read_b128 v[52:55], v8 offset:61440
v_mfma_f32_16x16x32_bf16 v[20:23], v[172:175], v[60:63], v[20:23]
v_mfma_f32_16x16x32_bf16 v[24:27], v[176:179], v[56:59], v[24:27]
v_mfma_f32_16x16x32_bf16 v[28:31], v[176:179], v[60:63], v[28:31]
v_mfma_f32_16x16x32_bf16 v[32:35], v[56:59], v[180:183], v[32:35]
v_mfma_f32_16x16x32_bf16 v[36:39], v[60:63], v[180:183], v[36:39]
s_waitcnt lgkmcnt(4)
v_mfma_f32_16x16x32_bf16 v[16:19], v[184:187], v[64:67], v[16:19]
ds_read_b128 v[56:59], v8 offset:29696
ds_read_b128 v[60:63], v8 offset:62464
v_mfma_f32_16x16x32_bf16 v[20:23], v[184:187], v[68:71], v[20:23]
v_mfma_f32_16x16x32_bf16 v[24:27], v[188:191], v[64:67], v[24:27]
v_mfma_f32_16x16x32_bf16 v[28:31], v[188:191], v[68:71], v[28:31]
v_mfma_f32_16x16x32_bf16 v[32:35], v[64:67], v[192:195], v[32:35]
v_mfma_f32_16x16x32_bf16 v[36:39], v[68:71], v[192:195], v[36:39]
s_waitcnt lgkmcnt(4)
v_mfma_f32_16x16x32_bf16 v[16:19], v[196:199], v[72:75], v[16:19]
ds_read_b128 v[64:67], v8 offset:30720
ds_read_b128 v[68:71], v8 offset:63488
v_mfma_f32_16x16x32_bf16 v[20:23], v[196:199], v[76:79], v[20:23]
v_mfma_f32_16x16x32_bf16 v[24:27], v[200:203], v[72:75], v[24:27]
v_mfma_f32_16x16x32_bf16 v[28:31], v[200:203], v[76:79], v[28:31]
v_mfma_f32_16x16x32_bf16 v[32:35], v[72:75], v[204:207], v[32:35]
v_mfma_f32_16x16x32_bf16 v[36:39], v[76:79], v[204:207], v[36:39]
s_waitcnt lgkmcnt(4)
v_mfma_f32_16x16x32_bf16 v[16:19], v[208:211], v[48:51], v[16:19]
ds_read_b128 v[72:75], v8 offset:31744
ds_read_b128 v[76:79], v8 offset:64512
v_mfma_f32_16x16x32_bf16 v[20:23], v[208:211], v[52:55], v[20:23]
v_mfma_f32_16x16x32_bf16 v[24:27], v[212:215], v[48:51], v[24:27]
v_mfma_f32_16x16x32_bf16 v[28:31], v[212:215], v[52:55], v[28:31]
v_mfma_f32_16x16x32_bf16 v[32:35], v[48:51], v[216:219], v[32:35]
v_mfma_f32_16x16x32_bf16 v[36:39], v[52:55], v[216:219], v[36:39]
s_waitcnt lgkmcnt(4)
v_mfma_f32_16x16x32_bf16 v[16:19], v[220:223], v[56:59], v[16:19]
v_mfma_f32_16x16x32_bf16 v[20:23], v[220:223], v[60:63], v[20:23]
v_mfma_f32_16x16x32_bf16 v[24:27], v[224:227], v[56:59], v[24:27]
v_mfma_f32_16x16x32_bf16 v[28:31], v[224:227], v[60:63], v[28:31]
v_mfma_f32_16x16x32_bf16 v[32:35], v[56:59], v[228:231], v[32:35]
v_mfma_f32_16x16x32_bf16 v[36:39], v[60:63], v[228:231], v[36:39]
s_waitcnt lgkmcnt(2)
v_mfma_f32_16x16x32_bf16 v[16:19], v[232:235], v[64:67], v[16:19]
v_mfma_f32_16x16x32_bf16 v[20:23], v[232:235], v[68:71], v[20:23]
v_mfma_f32_16x16x32_bf16 v[24:27], v[236:239], v[64:67], v[24:27]
v_mfma_f32_16x16x32_bf16 v[28:31], v[236:239], v[68:71], v[28:31]
buffer_load_dword v108, v4, s[36:39], 0 offen sc1
v_mfma_f32_16x16x32_bf16 v[32:35], v[64:67], v[240:243], v[32:35]
v_mfma_f32_16x16x32_bf16 v[36:39], v[68:71], v[240:243], v[36:39]
s_waitcnt lgkmcnt(0)
v_mfma_f32_16x16x32_bf16 v[16:19], v[244:247], v[72:75], v[16:19]
v_mfma_f32_16x16x32_bf16 v[20:23], v[244:247], v[76:79], v[20:23]
v_mfma_f32_16x16x32_bf16 v[24:27], v[248:251], v[72:75], v[24:27]
v_mfma_f32_16x16x32_bf16 v[28:31], v[248:251], v[76:79], v[28:31]
v_mfma_f32_16x16x32_bf16 v[32:35], v[72:75], v[252:255], v[32:35]
v_mfma_f32_16x16x32_bf16 v[36:39], v[76:79], v[252:255], v[36:39]
s_nop 2
v_cvt_pk_bf16_f32 v96, v16, v17
v_cvt_pk_bf16_f32 v97, v18, v19
v_cvt_pk_bf16_f32 v98, v24, v25
v_cvt_pk_bf16_f32 v99, v26, v27
buffer_store_dwordx4 v[96:99], v6, s[36:39], s82 offen sc1
v_cvt_pk_bf16_f32 v100, v20, v21
v_cvt_pk_bf16_f32 v101, v22, v23
v_cvt_pk_bf16_f32 v102, v28, v29
v_cvt_pk_bf16_f32 v103, v30, v31
buffer_store_dwordx4 v[100:103], v6, s[36:39], s83 offen sc1
v_cvt_pk_bf16_f32 v104, v32, v33
v_cvt_pk_bf16_f32 v105, v34, v35
v_cvt_pk_bf16_f32 v106, v36, v37
v_cvt_pk_bf16_f32 v107, v38, v39
buffer_store_dwordx4 v[104:107], v7, s[36:39], s82 offen sc1
v_xor_b32 v8, 0x10000, v8
s_add_u32 s82, s82, 0x200000
s_xor_b32 s82, s82, 0x2000
s_add_u32 s83, s82, 4096
s_add_u32 s59, s59, 1
s_cmp_gt_u32 s59, 2
s_cbranch_scc1 L_qkv_next
s_waitcnt vmcnt(0)
v_mov_b32 v109, s59
buffer_store_dword v109, v3, s[36:39], 0 offen sc1
L_qkv_next:
s_cmp_lt_u32 s59, 64
s_cbranch_scc1 L_qkv_top
s_waitcnt vmcnt(0)
v_mov_b32 v109, s59
buffer_store_dword v109, v3, s[36:39], 0 offen sc1
s_endpgm
L_role_f1:
s_bfe_u32 s80, s57, 0x10005
s_mul_i32 s80, s80, 28
s_and_b32 s64, s57, 31
s_add_u32 s80, s80, s64
s_mov_b32 s44, s24
s_and_b32 s45, s25, 0xffff
s_mov_b32 s46, 0x700000
s_mov_b32 s47, 0x20000
s_mov_b32 s48, s26
s_and_b32 s49, s27, 0xffff
s_mov_b32 s50, 0x700000
s_mov_b32 s51, 0x20000
s_lshl_b32 s82, s80, 2
s_add_u32 s82, s82, s56
v_lshrrev_b32 v20, 3, v0
s_lshl_b32 s64, s56, 4
v_add_u32 v20, s64, v20
v_mul_u32_u24 v20, 7168, v20
s_lshl_b32 s64, s80, 7
v_add_u32 v20, s64, v20
v_bfe_u32 v21, v0, 4, 1
v_lshlrev_b32 v21, 1, v21
v_and_b32 v22, 7, v0
v_xor_b32 v21, v21, v22
v_xor_b32 v22, 4, v21
v_lshl_add_u32 v22, v22, 4, v20
v_lshl_add_u32 v20, v21, 4, v20
s_lshl_b32 s83, s56, 11
v_lshrrev_b32 v21, 5, v0
v_bfe_u32 v23, v0, 2, 2
v_lshl_add_u32 v21, v21, 3, v23
v_lshlrev_b32 v21, 7, v21
v_bfe_u32 v24, v0, 4, 1
v_lshl_add_u32 v21, v24, 13, v21
v_and_b32 v25, 1, v0
v_lshl_add_u32 v21, v25, 3, v21
v_bfe_u32 v25, v0, 1, 1
s_lshl_b32 s64, s56, 1
v_add_u32 v25, s64, v25
v_and_b32 v23, 2, v23
v_lshl_add_u32 v23, v24, 2, v23
v_xor_b32 v25, v25, v23
v_lshl_add_u32 v21, v25, 4, v21
v_lshlrev_b32 v2, 4, v0
s_xor_b32 s64, s56, 0
s_lshl_b32 s65, s64, 11
v_add_u32 v48, s65, v21
v_add_u32 v49, 0x10000, v48
v_add_u32 v50, 0x20000, v48
s_lshl_b32 s65, s64, 10
v_add_u32 v8, s65, v2
s_xor_b32 s64, s56, 1
s_lshl_b32 s65, s64, 11
v_add_u32 v52, s65, v21
v_add_u32 v53, 0x10000, v52
v_add_u32 v54, 0x20000, v52
s_lshl_b32 s65, s64, 10
v_add_u32 v9, s65, v2
s_xor_b32 s64, s56, 2
s_lshl_b32 s65, s64, 11
v_add_u32 v56, s65, v21
v_add_u32 v57, 0x10000, v56
v_add_u32 v58, 0x20000, v56
s_lshl_b32 s65, s64, 10
v_add_u32 v10, s65, v2
s_xor_b32 s64, s56, 3
s_lshl_b32 s65, s64, 11
v_add_u32 v60, s65, v21
v_add_u32 v61, 0x10000, v60
v_add_u32 v62, 0x20000, v60
s_lshl_b32 s65, s64, 10
v_add_u32 v11, s65, v2
s_lshl_b32 s64, s57, 7
s_lshl_b32 s65, s56, 2
s_add_u32 s64, s64, s65
v_mov_b32 v3, 0x7fff0000
v_mov_b32 v255, s64
v_cmp_eq_u32 vcc, 0, v0
s_nop 1
v_cndmask_b32 v3, v3, v255, vcc
s_lshl_b32 s81, s56, 14
s_lshl_b32 s64, s56, 15
v_add_u32 v5, s64, v2
v_bfe_u32 v24, v0, 1, 3
s_lshr_b32 s64, s56, 1
s_lshl_b32 s64, s64, 5
s_and_b32 s65, s56, 1
s_lshl_b32 s65, s65, 3
s_add_u32 s64, s64, s65
s_add_u32 s64, s64, 64
v_add_u32 v24, s64, v24
v_lshlrev_b32 v24, 7, v24
v_and_b32 v23, 3, v0
v_lshl_add_u32 v4, v23, 2, v24
v_and_b32 v23, 31, v0
v_lshlrev_b32 v23, 2, v23
v_add_u32 v7, 131072, v23
v_and_b32 v23, 15, v0
v_lshlrev_b32 v23, 4, v23
s_lshl_b32 s64, s56, 8
s_add_u32 s64, s64, 131072
v_add_u32 v6, s64, v23
s_lshl_b32 s89, s56, 12
s_add_u32 s89, s89, 0xb400000
s_lshr_b32 s64, s82, 3
s_lshl_b32 s64, s64, 14
s_and_b32 s82, s82, 7
s_lshl_b32 s82, s82, 10
s_add_u32 s82, s82, s64
s_add_u32 s97, s82, 0xb7fa000
s_cmp_lg_u32 s62, 0
s_cbranch_scc1 L_cd_187
v_mbcnt_lo_u32_b32 v17, -1, 0
v_mbcnt_hi_u32_b32 v17, -1, v17
v_lshlrev_b32 v17, 2, v17
L_ct_188:
buffer_load_dword v18, v17, s[40:43], 0 offen sc1
s_mov_b32 s64, 0x10001000
s_mov_b32 s65, 0x10001000
s_waitcnt vmcnt(0)
v_cmp_ne_u32 vcc, 64, v18
s_nop 0
s_and_b64 s[64:65], s[64:65], vcc
s_cbranch_scc0 L_co_189
s_sleep 12
s_add_u32 s63, s63, 1
s_cmp_lt_u32 s63, 0x20000
s_cbranch_scc1 L_ct_188
s_branch L_giveup
L_co_189:
v_cmp_ne_u32 vcc, 32, v18
s_mov_b32 s64, 0x110011
s_mov_b32 s65, 0x110011
s_and_b64 s[64:65], s[64:65], vcc
s_cbranch_scc1 L_recensus
L_sd_190:
v_readlane_b32 s64, v18, 2
s_nop 0
s_cmp_lg_u32 s64, 0
s_cbranch_scc1 L_sk_191
s_sleep 4
buffer_load_dword v18, v17, s[40:43], 0 offen sc1
s_waitcnt vmcnt(0)
s_add_u32 s63, s63, 1
s_cmp_lt_u32 s63, 0x20000
s_cbranch_scc1 L_sd_190
s_branch L_giveup
L_sk_191:
s_cmp_eq_u32 s64, 2
s_cselect_b32 s64, 0x200000, 0
s_add_u32 s64, s64, 0x6000
s_add_u32 s36, s34, s64
s_addc_u32 s37, s35, 0
s_and_b32 s37, s37, 0xffff
L_cd_187:
v_mov_b32 v30, 0
s_mov_b32 s86, 1
L_late_192:
buffer_load_dword v31, v30, s[36:39], 0 offen sc1
s_waitcnt vmcnt(0)
v_cmp_gt_u32 vcc, s86, v31
s_cbranch_vccz L_late_ok_193
s_sleep 24
s_add_u32 s63, s63, 1
s_cmp_lt_u32 s63, 0x20000
s_cbranch_scc1 L_late_192
s_branch L_giveup
L_late_ok_193:
s_add_u32 m0, s83, 0
s_mov_b32 s64, 0x0
buffer_load_dwordx4 v20, s[44:47], s64 offen nt lds
s_add_u32 m0, s83, 1024
s_mov_b32 s64, 0xe000
buffer_load_dwordx4 v20, s[44:47], s64 offen nt lds
s_add_u32 m0, s83, 8192
s_mov_b32 s64, 0x0
buffer_load_dwordx4 v22, s[48:51], s64 offen nt lds
s_add_u32 m0, s83, 9216
s_mov_b32 s64, 0xe000
buffer_load_dwordx4 v22, s[48:51], s64 offen nt lds
s_add_u32 m0, s83, 16384
s_mov_b32 s64, 0x70000
buffer_load_dwordx4 v20, s[44:47], s64 offen nt lds
s_add_u32 m0, s83, 17408
s_mov_b32 s64, 0x7e000
buffer_load_dwordx4 v20, s[44:47], s64 offen nt lds
s_add_u32 m0, s83, 24576
s_mov_b32 s64, 0x70000
buffer_load_dwordx4 v22, s[48:51], s64 offen nt lds
s_add_u32 m0, s83, 25600
s_mov_b32 s64, 0x7e000
buffer_load_dwordx4 v22, s[48:51], s64 offen nt lds
s_add_u32 m0, s83, 32768
s_mov_b32 s64, 0xe0000
buffer_load_dwordx4 v20, s[44:47], s64 offen nt lds
s_add_u32 m0, s83, 33792
s_mov_b32 s64, 0xee000
buffer_load_dwordx4 v20, s[44:47], s64 offen nt lds
s_add_u32 m0, s83, 40960
s_mov_b32 s64, 0xe0000
buffer_load_dwordx4 v22, s[48:51], s64 offen nt lds
s_add_u32 m0, s83, 41984
s_mov_b32 s64, 0xee000
buffer_load_dwordx4 v22, s[48:51], s64 offen nt lds
s_waitcnt vmcnt(8)
s_barrier
ds_read_b64_tr_b16 a[0:1], v48 offset:0
ds_read_b64_tr_b16 a[2:3], v48 offset:512
ds_read_b64_tr_b16 a[4:5], v52 offset:0
ds_read_b64_tr_b16 a[6:7], v52 offset:512
ds_read_b64_tr_b16 a[8:9], v56 offset:0
ds_read_b64_tr_b16 a[10:11], v56 offset:512
ds_read_b64_tr_b16 a[12:13], v60 offset:0
ds_read_b64_tr_b16 a[14:15], v60 offset:512
s_waitcnt vmcnt(4)
s_waitcnt lgkmcnt(0)
s_barrier
s_add_u32 m0, s83, 0
s_mov_b32 s64, 0x150000
buffer_load_dwordx4 v20, s[44:47], s64 offen nt lds
s_add_u32 m0, s83, 1024
s_mov_b32 s64, 0x15e000
buffer_load_dwordx4 v20, s[44:47], s64 offen nt lds
s_add_u32 m0, s83, 8192
s_mov_b32 s64, 0x150000
buffer_load_dwordx4 v22, s[48:51], s64 offen nt lds
s_add_u32 m0, s83, 9216
s_mov_b32 s64, 0x15e000
buffer_load_dwordx4 v22, s[48:51], s64 offen nt lds
ds_read_b64_tr_b16 a[64:65], v48 offset:16384
ds_read_b64_tr_b16 a[66:67], v48 offset:16896
ds_read_b64_tr_b16 a[68:69], v52 offset:16384
ds_read_b64_tr_b16 a[70:71], v52 offset:16896
ds_read_b64_tr_b16 a[72:73], v56 offset:16384
ds_read_b64_tr_b16 a[74:75], v56 offset:16896
ds_read_b64_tr_b16 a[76:77], v60 offset:16384
ds_read_b64_tr_b16 a[78:79], v60 offset:16896
s_waitcnt vmcnt(4)
s_waitcnt lgkmcnt(0)
s_barrier
s_add_u32 m0, s83, 16384
s_mov_b32 s64, 0x1c0000
buffer_load_dwordx4 v20, s[44:47], s64 offen nt lds
s_add_u32 m0, s83, 17408
s_mov_b32 s64, 0x1ce000
buffer_load_dwordx4 v20, s[44:47], s64 offen nt lds
s_add_u32 m0, s83, 24576
s_mov_b32 s64, 0x1c0000
buffer_load_dwordx4 v22, s[48:51], s64 offen nt lds
s_add_u32 m0, s83, 25600
s_mov_b32 s64, 0x1ce000
buffer_load_dwordx4 v22, s[48:51], s64 offen nt lds
ds_read_b64_tr_b16 a[128:129], v48 offset:32768
ds_read_b64_tr_b16 a[130:131], v48 offset:33280
ds_read_b64_tr_b16 a[132:133], v52 offset:32768
ds_read_b64_tr_b16 a[134:135], v52 offset:33280
ds_read_b64_tr_b16 a[136:137], v56 offset:32768
ds_read_b64_tr_b16 a[138:139], v56 offset:33280
ds_read_b64_tr_b16 a[140:141], v60 offset:32768
ds_read_b64_tr_b16 a[142:143], v60 offset:33280
s_waitcnt vmcnt(4)
s_waitcnt lgkmcnt(0)
s_barrier
s_add_u32 m0, s83, 32768
s_mov_b32 s64, 0x230000
buffer_load_dwordx4 v20, s[44:47], s64 offen nt lds
s_add_u32 m0, s83, 33792
s_mov_b32 s64, 0x23e000
buffer_load_dwordx4 v20, s[44:47], s64 offen nt lds
s_add_u32 m0, s83, 40960
s_mov_b32 s64, 0x230000
buffer_load_dwordx4 v22, s[48:51], s64 offen nt lds
s_add_u32 m0, s83, 41984
s_mov_b32 s64, 0x23e000
buffer_load_dwordx4 v22, s[48:51], s64 offen nt lds
ds_read_b64_tr_b16 a[192:193], v48 offset:0
ds_read_b64_tr_b16 a[194:195], v48 offset:512
ds_read_b64_tr_b16 a[196:197], v52 offset:0
ds_read_b64_tr_b16 a[198:199], v52 offset:512
ds_read_b64_tr_b16 a[200:201], v56 offset:0
ds_read_b64_tr_b16 a[202:203], v56 offset:512
ds_read_b64_tr_b16 a[204:205], v60 offset:0
ds_read_b64_tr_b16 a[206:207], v60 offset:512
s_waitcnt vmcnt(4)
s_waitcnt lgkmcnt(0)
s_barrier
s_add_u32 m0, s83, 0
s_mov_b32 s64, 0x2a0000
buffer_load_dwordx4 v20, s[44:47], s64 offen nt lds
s_add_u32 m0, s83, 1024
s_mov_b32 s64, 0x2ae000
buffer_load_dwordx4 v20, s[44:47], s64 offen nt lds
s_add_u32 m0, s83, 8192
s_mov_b32 s64, 0x2a0000
buffer_load_dwordx4 v22, s[48:51], s64 offen nt lds
s_add_u32 m0, s83, 9216
s_mov_b32 s64, 0x2ae000
buffer_load_dwordx4 v22, s[48:51], s64 offen nt lds
ds_read_b64_tr_b16 a[16:17], v48 offset:16384
ds_read_b64_tr_b16 a[18:19], v48 offset:16896
ds_read_b64_tr_b16 a[20:21], v52 offset:16384
ds_read_b64_tr_b16 a[22:23], v52 offset:16896
ds_read_b64_tr_b16 a[24:25], v56 offset:16384
ds_read_b64_tr_b16 a[26:27], v56 offset:16896
ds_read_b64_tr_b16 a[28:29], v60 offset:16384
ds_read_b64_tr_b16 a[30:31], v60 offset:16896
s_waitcnt vmcnt(4)
s_waitcnt lgkmcnt(0)
s_barrier
s_add_u32 m0, s83, 16384
s_mov_b32 s64, 0x310000
buffer_load_dwordx4 v20, s[44:47], s64 offen nt lds
s_add_u32 m0, s83, 17408
s_mov_b32 s64, 0x31e000
buffer_load_dwordx4 v20, s[44:47], s64 offen nt lds
s_add_u32 m0, s83, 24576
s_mov_b32 s64, 0x310000
buffer_load_dwordx4 v22, s[48:51], s64 offen nt lds
s_add_u32 m0, s83, 25600
s_mov_b32 s64, 0x31e000
buffer_load_dwordx4 v22, s[48:51], s64 offen nt lds
ds_read_b64_tr_b16 a[80:81], v48 offset:32768
ds_read_b64_tr_b16 a[82:83], v48 offset:33280
ds_read_b64_tr_b16 a[84:85], v52 offset:32768
ds_read_b64_tr_b16 a[86:87], v52 offset:33280
ds_read_b64_tr_b16 a[88:89], v56 offset:32768
ds_read_b64_tr_b16 a[90:91], v56 offset:33280
ds_read_b64_tr_b16 a[92:93], v60 offset:32768
ds_read_b64_tr_b16 a[94:95], v60 offset:33280
s_waitcnt vmcnt(4)
s_waitcnt lgkmcnt(0)
s_barrier
s_add_u32 m0, s83, 32768
s_mov_b32 s64, 0x380000
buffer_load_dwordx4 v20, s[44:47], s64 offen nt lds
s_add_u32 m0, s83, 33792
s_mov_b32 s64, 0x38e000
buffer_load_dwordx4 v20, s[44:47], s64 offen nt lds
s_add_u32 m0, s83, 40960
s_mov_b32 s64, 0x380000
buffer_load_dwordx4 v22, s[48:51], s64 offen nt lds
s_add_u32 m0, s83, 41984
s_mov_b32 s64, 0x38e000
buffer_load_dwordx4 v22, s[48:51], s64 offen nt lds
ds_read_b64_tr_b16 a[144:145], v48 offset:0
ds_read_b64_tr_b16 a[146:147], v48 offset:512
ds_read_b64_tr_b16 a[148:149], v52 offset:0
ds_read_b64_tr_b16 a[150:151], v52 offset:512
ds_read_b64_tr_b16 a[152:153], v56 offset:0
ds_read_b64_tr_b16 a[154:155], v56 offset:512
ds_read_b64_tr_b16 a[156:157], v60 offset:0
ds_read_b64_tr_b16 a[158:159], v60 offset:512
s_waitcnt vmcnt(4)
s_waitcnt lgkmcnt(0)
s_barrier
s_add_u32 m0, s83, 0
s_mov_b32 s64, 0x3f0000
buffer_load_dwordx4 v20, s[44:47], s64 offen nt lds
s_add_u32 m0, s83, 1024
s_mov_b32 s64, 0x3fe000
buffer_load_dwordx4 v20, s[44:47], s64 offen nt lds
s_add_u32 m0, s83, 8192
s_mov_b32 s64, 0x3f0000
buffer_load_dwordx4 v22, s[48:51], s64 offen nt lds
s_add_u32 m0, s83, 9216
s_mov_b32 s64, 0x3fe000
buffer_load_dwordx4 v22, s[48:51], s64 offen nt lds
ds_read_b64_tr_b16 a[208:209], v48 offset:16384
ds_read_b64_tr_b16 a[210:211], v48 offset:16896
ds_read_b64_tr_b16 a[212:213], v52 offset:16384
ds_read_b64_tr_b16 a[214:215], v52 offset:16896
ds_read_b64_tr_b16 a[216:217], v56 offset:16384
ds_read_b64_tr_b16 a[218:219], v56 offset:16896
ds_read_b64_tr_b16 a[220:221], v60 offset:16384
ds_read_b64_tr_b16 a[222:223], v60 offset:16896
s_waitcnt vmcnt(4)
s_waitcnt lgkmcnt(0)
s_barrier
s_add_u32 m0, s83, 16384
s_mov_b32 s64, 0x460000
buffer_load_dwordx4 v20, s[44:47], s64 offen nt lds
s_add_u32 m0, s83, 17408
s_mov_b32 s64, 0x46e000
buffer_load_dwordx4 v20, s[44:47], s64 offen nt lds
s_add_u32 m0, s83, 24576
s_mov_b32 s64, 0x460000
buffer_load_dwordx4 v22, s[48:51], s64 offen nt lds
s_add_u32 m0, s83, 25600
s_mov_b32 s64, 0x46e000
buffer_load_dwordx4 v22, s[48:51], s64 offen nt lds
ds_read_b64_tr_b16 a[32:33], v48 offset:32768
ds_read_b64_tr_b16 a[34:35], v48 offset:33280
ds_read_b64_tr_b16 a[36:37], v52 offset:32768
ds_read_b64_tr_b16 a[38:39], v52 offset:33280
ds_read_b64_tr_b16 a[40:41], v56 offset:32768
ds_read_b64_tr_b16 a[42:43], v56 offset:33280
ds_read_b64_tr_b16 a[44:45], v60 offset:32768
ds_read_b64_tr_b16 a[46:47], v60 offset:33280
s_waitcnt vmcnt(4)
s_waitcnt lgkmcnt(0)
s_barrier
s_add_u32 m0, s83, 32768
s_mov_b32 s64, 0x4d0000
buffer_load_dwordx4 v20, s[44:47], s64 offen nt lds
s_add_u32 m0, s83, 33792
s_mov_b32 s64, 0x4de000
buffer_load_dwordx4 v20, s[44:47], s64 offen nt lds
s_add_u32 m0, s83, 40960
s_mov_b32 s64, 0x4d0000
buffer_load_dwordx4 v22, s[48:51], s64 offen nt lds
s_add_u32 m0, s83, 41984
s_mov_b32 s64, 0x4de000
buffer_load_dwordx4 v22, s[48:51], s64 offen nt lds
ds_read_b64_tr_b16 a[96:97], v48 offset:0
ds_read_b64_tr_b16 a[98:99], v48 offset:512
ds_read_b64_tr_b16 a[100:101], v52 offset:0
ds_read_b64_tr_b16 a[102:103], v52 offset:512
ds_read_b64_tr_b16 a[104:105], v56 offset:0
ds_read_b64_tr_b16 a[106:107], v56 offset:512
ds_read_b64_tr_b16 a[108:109], v60 offset:0
ds_read_b64_tr_b16 a[110:111], v60 offset:512
s_waitcnt vmcnt(4)
s_waitcnt lgkmcnt(0)
s_barrier
s_add_u32 m0, s83, 0
s_mov_b32 s64, 0x540000
buffer_load_dwordx4 v20, s[44:47], s64 offen nt lds
s_add_u32 m0, s83, 1024
s_mov_b32 s64, 0x54e000
buffer_load_dwordx4 v20, s[44:47], s64 offen nt lds
s_add_u32 m0, s83, 8192
s_mov_b32 s64, 0x540000
buffer_load_dwordx4 v22, s[48:51], s64 offen nt lds
s_add_u32 m0, s83, 9216
s_mov_b32 s64, 0x54e000
buffer_load_dwordx4 v22, s[48:51], s64 offen nt lds
ds_read_b64_tr_b16 a[160:161], v48 offset:16384
ds_read_b64_tr_b16 a[162:163], v48 offset:16896
ds_read_b64_tr_b16 a[164:165], v52 offset:16384
ds_read_b64_tr_b16 a[166:167], v52 offset:16896
ds_read_b64_tr_b16 a[168:169], v56 offset:16384
ds_read_b64_tr_b16 a[170:171], v56 offset:16896
ds_read_b64_tr_b16 a[172:173], v60 offset:16384
ds_read_b64_tr_b16 a[174:175], v60 offset:16896
s_waitcnt vmcnt(4)
s_waitcnt lgkmcnt(0)
s_barrier
s_add_u32 m0, s83, 16384
s_mov_b32 s64, 0x5b0000
buffer_load_dwordx4 v20, s[44:47], s64 offen nt lds
s_add_u32 m0, s83, 17408
s_mov_b32 s64, 0x5be000
buffer_load_dwordx4 v20, s[44:47], s64 offen nt lds
s_add_u32 m0, s83, 24576
s_mov_b32 s64, 0x5b0000
buffer_load_dwordx4 v22, s[48:51], s64 offen nt lds
s_add_u32 m0, s83, 25600
s_mov_b32 s64, 0x5be000
buffer_load_dwordx4 v22, s[48:51], s64 offen nt lds
ds_read_b64_tr_b16 a[224:225], v48 offset:32768
ds_read_b64_tr_b16 a[226:227], v48 offset:33280
ds_read_b64_tr_b16 a[228:229], v52 offset:32768
ds_read_b64_tr_b16 a[230:231], v52 offset:33280
ds_read_b64_tr_b16 a[232:233], v56 offset:32768
ds_read_b64_tr_b16 a[234:235], v56 offset:33280
ds_read_b64_tr_b16 a[236:237], v60 offset:32768
ds_read_b64_tr_b16 a[238:239], v60 offset:33280
s_waitcnt vmcnt(4)
s_waitcnt lgkmcnt(0)
s_barrier
s_add_u32 m0, s83, 32768
s_mov_b32 s64, 0x620000
buffer_load_dwordx4 v20, s[44:47], s64 offen nt lds
s_add_u32 m0, s83, 33792
s_mov_b32 s64, 0x62e000
buffer_load_dwordx4 v20, s[44:47], s64 offen nt lds
s_add_u32 m0, s83, 40960
s_mov_b32 s64, 0x620000
buffer_load_dwordx4 v22, s[48:51], s64 offen nt lds
s_add_u32 m0, s83, 41984
s_mov_b32 s64, 0x62e000
buffer_load_dwordx4 v22, s[48:51], s64 offen nt lds
ds_read_b64_tr_b16 a[48:49], v48 offset:0
ds_read_b64_tr_b16 a[50:51], v48 offset:512
ds_read_b64_tr_b16 a[52:53], v52 offset:0
ds_read_b64_tr_b16 a[54:55], v52 offset:512
ds_read_b64_tr_b16 a[56:57], v56 offset:0
ds_read_b64_tr_b16 a[58:59], v56 offset:512
ds_read_b64_tr_b16 a[60:61], v60 offset:0
ds_read_b64_tr_b16 a[62:63], v60 offset:512
s_waitcnt vmcnt(4)
s_waitcnt lgkmcnt(0)
s_barrier
s_add_u32 m0, s83, 0
s_mov_b32 s64, 0x690000
buffer_load_dwordx4 v20, s[44:47], s64 offen nt lds
s_add_u32 m0, s83, 1024
s_mov_b32 s64, 0x69e000
buffer_load_dwordx4 v20, s[44:47], s64 offen nt lds
s_add_u32 m0, s83, 8192
s_mov_b32 s64, 0x690000
buffer_load_dwordx4 v22, s[48:51], s64 offen nt lds
s_add_u32 m0, s83, 9216
s_mov_b32 s64, 0x69e000
buffer_load_dwordx4 v22, s[48:51], s64 offen nt lds
ds_read_b64_tr_b16 a[112:113], v48 offset:16384
ds_read_b64_tr_b16 a[114:115], v48 offset:16896
ds_read_b64_tr_b16 a[116:117], v52 offset:16384
ds_read_b64_tr_b16 a[118:119], v52 offset:16896
ds_read_b64_tr_b16 a[120:121], v56 offset:16384
ds_read_b64_tr_b16 a[122:123], v56 offset:16896
ds_read_b64_tr_b16 a[124:125], v60 offset:16384
ds_read_b64_tr_b16 a[126:127], v60 offset:16896
s_waitcnt vmcnt(4)
s_waitcnt lgkmcnt(0)
s_barrier
ds_read_b64_tr_b16 a[176:177], v48 offset:32768
ds_read_b64_tr_b16 a[178:179], v48 offset:33280
ds_read_b64_tr_b16 a[180:181], v52 offset:32768
ds_read_b64_tr_b16 a[182:183], v52 offset:33280
ds_read_b64_tr_b16 a[184:185], v56 offset:32768
ds_read_b64_tr_b16 a[186:187], v56 offset:33280
ds_read_b64_tr_b16 a[188:189], v60 offset:32768
ds_read_b64_tr_b16 a[190:191], v60 offset:33280
s_waitcnt vmcnt(0)
s_waitcnt lgkmcnt(0)
s_barrier
ds_read_b64_tr_b16 a[240:241], v48 offset:0
ds_read_b64_tr_b16 a[242:243], v48 offset:512
ds_read_b64_tr_b16 a[244:245], v52 offset:0
ds_read_b64_tr_b16 a[246:247], v52 offset:512
ds_read_b64_tr_b16 a[248:249], v56 offset:0
ds_read_b64_tr_b16 a[250:251], v56 offset:512
ds_read_b64_tr_b16 a[252:253], v60 offset:0
ds_read_b64_tr_b16 a[254:255], v60 offset:512
s_waitcnt lgkmcnt(0)
s_mov_b32 s94, 0x3f803f80
v_mov_b32 v48, s94
v_mov_b32 v49, s94
v_mov_b32 v50, s94
v_mov_b32 v51, s94
s_nop 1
v_mfma_f32_32x32x16_bf16 v[32:47], a[0:3], v[48:51], 0
v_mfma_f32_32x32x16_bf16 v[32:47], a[4:7], v[48:51], v[32:47]
v_mfma_f32_32x32x16_bf16 v[32:47], a[8:11], v[48:51], v[32:47]
v_mfma_f32_32x32x16_bf16 v[32:47], a[12:15], v[48:51], v[32:47]
v_mfma_f32_32x32x16_bf16 v[32:47], a[16:19], v[48:51], v[32:47]
v_mfma_f32_32x32x16_bf16 v[32:47], a[20:23], v[48:51], v[32:47]
v_mfma_f32_32x32x16_bf16 v[32:47], a[24:27], v[48:51], v[32:47]
v_mfma_f32_32x32x16_bf16 v[32:47], a[28:31], v[48:51], v[32:47]
v_mfma_f32_32x32x16_bf16 v[32:47], a[32:35], v[48:51], v[32:47]
v_mfma_f32_32x32x16_bf16 v[32:47], a[36:39], v[48:51], v[32:47]
v_mfma_f32_32x32x16_bf16 v[32:47], a[40:43], v[48:51], v[32:47]
v_mfma_f32_32x32x16_bf16 v[32:47], a[44:47], v[48:51], v[32:47]
v_mfma_f32_32x32x16_bf16 v[32:47], a[48:51], v[48:51], v[32:47]
v_mfma_f32_32x32x16_bf16 v[32:47], a[52:55], v[48:51], v[32:47]
v_mfma_f32_32x32x16_bf16 v[32:47], a[56:59], v[48:51], v[32:47]
v_mfma_f32_32x32x16_bf16 v[32:47], a[60:63], v[48:51], v[32:47]
v_mfma_f32_32x32x16_bf16 v[32:47], a[64:67], v[48:51], v[32:47]
v_mfma_f32_32x32x16_bf16 v[32:47], a[68:71], v[48:51], v[32:47]
v_mfma_f32_32x32x16_bf16 v[32:47], a[72:75], v[48:51], v[32:47]
v_mfma_f32_32x32x16_bf16 v[32:47], a[76:79], v[48:51], v[32:47]
v_mfma_f32_32x32x16_bf16 v[32:47], a[80:83], v[48:51], v[32:47]
v_mfma_f32_32x32x16_bf16 v[32:47], a[84:87], v[48:51], v[32:47]
v_mfma_f32_32x32x16_bf16 v[32:47], a[88:91], v[48:51], v[32:47]
v_mfma_f32_32x32x16_bf16 v[32:47], a[92:95], v[48:51], v[32:47]
v_mfma_f32_32x32x16_bf16 v[32:47], a[96:99], v[48:51], v[32:47]
v_mfma_f32_32x32x16_bf16 v[32:47], a[100:103], v[48:51], v[32:47]
v_mfma_f32_32x32x16_bf16 v[32:47], a[104:107], v[48:51], v[32:47]
v_mfma_f32_32x32x16_bf16 v[32:47], a[108:111], v[48:51], v[32:47]
v_mfma_f32_32x32x16_bf16 v[32:47], a[112:115], v[48:51], v[32:47]
v_mfma_f32_32x32x16_bf16 v[32:47], a[116:119], v[48:51], v[32:47]
v_mfma_f32_32x32x16_bf16 v[32:47], a[120:123], v[48:51], v[32:47]
v_mfma_f32_32x32x16_bf16 v[32:47], a[124:127], v[48:51], v[32:47]
v_mfma_f32_32x32x16_bf16 v[32:47], a[128:131], v[48:51], v[32:47]
v_mfma_f32_32x32x16_bf16 v[32:47], a[132:135], v[48:51], v[32:47]
v_mfma_f32_32x32x16_bf16 v[32:47], a[136:139], v[48:51], v[32:47]
v_mfma_f32_32x32x16_bf16 v[32:47], a[140:143], v[48:51], v[32:47]
v_mfma_f32_32x32x16_bf16 v[32:47], a[144:147], v[48:51], v[32:47]
v_mfma_f32_32x32x16_bf16 v[32:47], a[148:151], v[48:51], v[32:47]
v_mfma_f32_32x32x16_bf16 v[32:47], a[152:155], v[48:51], v[32:47]
v_mfma_f32_32x32x16_bf16 v[32:47], a[156:159], v[48:51], v[32:47]
v_mfma_f32_32x32x16_bf16 v[32:47], a[160:163], v[48:51], v[32:47]
v_mfma_f32_32x32x16_bf16 v[32:47], a[164:167], v[48:51], v[32:47]
v_mfma_f32_32x32x16_bf16 v[32:47], a[168:171], v[48:51], v[32:47]
v_mfma_f32_32x32x16_bf16 v[32:47], a[172:175], v[48:51], v[32:47]
v_mfma_f32_32x32x16_bf16 v[32:47], a[176:179], v[48:51], v[32:47]
v_mfma_f32_32x32x16_bf16 v[32:47], a[180:183], v[48:51], v[32:47]
v_mfma_f32_32x32x16_bf16 v[32:47], a[184:187], v[48:51], v[32:47]
v_mfma_f32_32x32x16_bf16 v[32:47], a[188:191], v[48:51], v[32:47]
v_mfma_f32_32x32x16_bf16 v[32:47], a[192:195], v[48:51], v[32:47]
v_mfma_f32_32x32x16_bf16 v[32:47], a[196:199], v[48:51], v[32:47]
v_mfma_f32_32x32x16_bf16 v[32:47], a[200:203], v[48:51], v[32:47]
v_mfma_f32_32x32x16_bf16 v[32:47], a[204:207], v[48:51], v[32:47]
v_mfma_f32_32x32x16_bf16 v[32:47], a[208:211], v[48:51], v[32:47]
v_mfma_f32_32x32x16_bf16 v[32:47], a[212:215], v[48:51], v[32:47]
v_mfma_f32_32x32x16_bf16 v[32:47], a[216:219], v[48:51], v[32:47]
v_mfma_f32_32x32x16_bf16 v[32:47], a[220:223], v[48:51], v[32:47]
v_mfma_f32_32x32x16_bf16 v[32:47], a[224:227], v[48:51], v[32:47]
v_mfma_f32_32x32x16_bf16 v[32:47], a[228:231], v[48:51], v[32:47]
v_mfma_f32_32x32x16_bf16 v[32:47], a[232:235], v[48:51], v[32:47]
v_mfma_f32_32x32x16_bf16 v[32:47], a[236:239], v[48:51], v[32:47]
v_mfma_f32_32x32x16_bf16 v[32:47], a[240:243], v[48:51], v[32:47]
v_mfma_f32_32x32x16_bf16 v[32:47], a[244:247], v[48:51], v[32:47]
v_mfma_f32_32x32x16_bf16 v[32:47], a[248:251], v[48:51], v[32:47]
v_mfma_f32_32x32x16_bf16 v[32:47], a[252:255], v[48:51], v[32:47]
s_barrier
s_mov_b32 s59, 0
s_mov_b32 s84, 0xd7fa000
s_mov_b32 s85, s81
s_mov_b32 s92, 0xc0135761
s_mov_b32 s93, 0xbdd2d3e8
s_mov_b32 s95, 0x3a800000
s_mov_b32 s87, 0
s_mov_b32 s96, 0
L_f1_wait:
s_add_u32 s86, s59, 1
buffer_load_dword v112, v4, s[36:39], 0 offen sc1
s_waitcnt vmcnt(0)
v_mov_b32 v113, s59
buffer_store_dword v113, v3, s[36:39], 0 offen sc1
s_mov_b32 s96, s59
s_cmp_eq_u32 s59, 64
s_cbranch_scc1 L_end
s_waitcnt vmcnt(1)
v_cmp_gt_u32 vcc, s86, v112
s_cbranch_vccz L_fh_ok_195
L_fh_194:
buffer_load_dword v112, v4, s[36:39], 0 offen sc1
s_waitcnt vmcnt(0)
v_cmp_gt_u32 vcc, s86, v112
s_cbranch_vccz L_fh_ok_195
s_add_u32 s63, s63, 1
s_cmp_lt_u32 s63, 0x20000
s_cbranch_scc1 L_fh_194
s_branch L_giveup
L_fh_ok_195:
L_f1_go:
s_add_u32 s64, s85, 0
s_add_u32 s65, s84, 0
s_mov_b32 m0, s64
s_nop 0
buffer_load_dwordx4 v5, s[36:39], s65 offen offset:0 sc1 lds
buffer_load_dwordx4 v5, s[36:39], s65 offen offset:1024 sc1 lds
buffer_load_dwordx4 v5, s[36:39], s65 offen offset:2048 sc1 lds
buffer_load_dwordx4 v5, s[36:39], s65 offen offset:3072 sc1 lds
s_add_u32 s64, s85, 4096
s_add_u32 s65, s84, 4096
s_mov_b32 m0, s64
s_nop 0
buffer_load_dwordx4 v5, s[36:39], s65 offen offset:0 sc1 lds
buffer_load_dwordx4 v5, s[36:39], s65 offen offset:1024 sc1 lds
buffer_load_dwordx4 v5, s[36:39], s65 offen offset:2048 sc1 lds
buffer_load_dwordx4 v5, s[36:39], s65 offen offset:3072 sc1 lds
s_add_u32 s64, s85, 8192
s_add_u32 s65, s84, 16384
s_mov_b32 m0, s64
s_nop 0
buffer_load_dwordx4 v5, s[36:39], s65 offen offset:0 sc1 lds
buffer_load_dwordx4 v5, s[36:39], s65 offen offset:1024 sc1 lds
buffer_load_dwordx4 v5, s[36:39], s65 offen offset:2048 sc1 lds
buffer_load_dwordx4 v5, s[36:39], s65 offen offset:3072 sc1 lds
s_add_u32 s64, s85, 12288
s_add_u32 s65, s84, 20480
s_mov_b32 m0, s64
s_nop 0
buffer_load_dwordx4 v5, s[36:39], s65 offen offset:0 sc1 lds
buffer_load_dwordx4 v5, s[36:39], s65 offen offset:1024 sc1 lds
buffer_load_dwordx4 v5, s[36:39], s65 offen offset:2048 sc1 lds
buffer_load_dwordx4 v5, s[36:39], s65 offen offset:3072 sc1 lds
L_f1_top:
s_add_u32 s86, s59, 2
buffer_load_dwordx4 v[128:131], v2, s[36:39], s89 offen offset:0 sc1
buffer_load_dwordx4 v[132:135], v2, s[36:39], s89 offen offset:1024 sc1
buffer_load_dwordx4 v[136:139], v2, s[36:39], s89 offen offset:2048 sc1
buffer_load_dwordx4 v[140:143], v2, s[36:39], s89 offen offset:3072 sc1
buffer_load_dword v112, v4, s[36:39], 0 offen sc1
s_add_u32 s89, s89, 0x4000
s_add_u32 s64, s59, 1
s_lshl_b32 s65, s64, 9
s_and_b32 s65, s65, 0x2000
s_lshl_b32 s84, s64, 17
s_add_u32 s84, s84, s65
s_add_u32 s84, s84, 0xd7fa000
s_xor_b32 s85, s85, 0x10000
s_waitcnt vmcnt(17)
s_barrier
ds_read_b128 v[48:51], v8 offset:0
ds_read_b128 v[52:55], v9 offset:0
ds_read_b128 v[56:59], v10 offset:0
ds_read_b128 v[60:63], v11 offset:0
ds_read_b128 v[64:67], v8 offset:16384
ds_read_b128 v[68:71], v9 offset:16384
s_waitcnt lgkmcnt(5)
v_mfma_f32_32x32x16_bf16 v[16:31], a[0:3], v[48:51], 0
s_waitcnt lgkmcnt(4)
v_mfma_f32_32x32x16_bf16 v[16:31], a[4:7], v[52:55], v[16:31]
s_cmp_eq_u32 s96, s59
s_cselect_b32 s64, 1, s87
s_cmp_lg_u32 s64, 0
s_cbranch_scc1 L_told_196
v_mov_b32 v113, s59
buffer_store_dword v113, v3, s[36:39], 0 offen sc1
s_mov_b32 s96, s59
L_told_196:
s_waitcnt lgkmcnt(3)
v_mfma_f32_32x32x16_bf16 v[16:31], a[8:11], v[56:59], v[16:31]
ds_read_b128 v[48:51], v10 offset:16384
s_waitcnt lgkmcnt(3)
v_mfma_f32_32x32x16_bf16 v[16:31], a[12:15], v[60:63], v[16:31]
ds_read_b128 v[52:55], v11 offset:16384
s_waitcnt lgkmcnt(3)
v_mfma_f32_32x32x16_bf16 v[16:31], a[16:19], v[64:67], v[16:31]
ds_read_b128 v[56:59], v8 offset:32768
s_waitcnt lgkmcnt(3)
v_mfma_f32_32x32x16_bf16 v[16:31], a[20:23], v[68:71], v[16:31]
ds_read_b128 v[60:63], v9 offset:32768
s_waitcnt lgkmcnt(3)
v_mfma_f32_32x32x16_bf16 v[16:31], a[24:27], v[48:51], v[16:31]
ds_read_b128 v[64:67], v10 offset:32768
s_waitcnt lgkmcnt(3)
v_mfma_f32_32x32x16_bf16 v[16:31], a[28:31], v[52:55], v[16:31]
ds_read_b128 v[68:71], v11 offset:32768
s_waitcnt lgkmcnt(3)
v_mfma_f32_32x32x16_bf16 v[16:31], a[32:35], v[56:59], v[16:31]
ds_read_b128 v[48:51], v8 offset:49152
s_waitcnt lgkmcnt(3)
v_mfma_f32_32x32x16_bf16 v[16:31], a[36:39], v[60:63], v[16:31]
ds_read_b128 v[52:55], v9 offset:49152
s_waitcnt lgkmcnt(3)
v_mfma_f32_32x32x16_bf16 v[16:31], a[40:43], v[64:67], v[16:31]
ds_read_b128 v[56:59], v10 offset:49152
s_waitcnt lgkmcnt(3)
v_mfma_f32_32x32x16_bf16 v[16:31], a[44:47], v[68:71], v[16:31]
ds_read_b128 v[60:63], v11 offset:49152
s_waitcnt lgkmcnt(3)
v_mfma_f32_32x32x16_bf16 v[16:31], a[48:51], v[48:51], v[16:31]
s_waitcnt lgkmcnt(2)
v_mfma_f32_32x32x16_bf16 v[16:31], a[52:55], v[52:55], v[16:31]
s_waitcnt vmcnt(13)
s_barrier
ds_read_b128 v[64:67], v8 offset:4096
ds_read_b128 v[68:71], v9 offset:4096
s_waitcnt lgkmcnt(3)
v_mfma_f32_32x32x16_bf16 v[16:31], a[56:59], v[56:59], v[16:31]
ds_read_b128 v[48:51], v10 offset:4096
s_waitcnt lgkmcnt(3)
v_mfma_f32_32x32x16_bf16 v[16:31], a[60:63], v[60:63], v[16:31]
ds_read_b128 v[52:55], v11 offset:4096
s_waitcnt lgkmcnt(3)
v_mfma_f32_32x32x16_bf16 v[16:31], a[64:67], v[64:67], v[16:31]
s_cmp_eq_u32 s96, s59
s_cbranch_scc1 L_told_197
s_waitcnt vmcnt(5)
v_mov_b32 v113, s59
buffer_store_dword v113, v3, s[36:39], 0 offen sc1
s_mov_b32 s96, s59
L_told_197:
ds_read_b128 v[56:59], v8 offset:20480
s_waitcnt lgkmcnt(3)
v_mfma_f32_32x32x16_bf16 v[16:31], a[68:71], v[68:71], v[16:31]
ds_read_b128 v[60:63], v9 offset:20480
s_waitcnt lgkmcnt(3)
v_mfma_f32_32x32x16_bf16 v[16:31], a[72:75], v[48:51], v[16:31]
ds_read_b128 v[64:67], v10 offset:20480
s_waitcnt lgkmcnt(3)
v_mfma_f32_32x32x16_bf16 v[16:31], a[76:79], v[52:55], v[16:31]
ds_read_b128 v[68:71], v11 offset:20480
s_waitcnt lgkmcnt(3)
v_mfma_f32_32x32x16_bf16 v[16:31], a[80:83], v[56:59], v[16:31]
ds_read_b128 v[48:51], v8 offset:36864
s_waitcnt lgkmcnt(3)
v_mfma_f32_32x32x16_bf16 v[16:31], a[84:87], v[60:63], v[16:31]
ds_read_b128 v[52:55], v9 offset:36864
s_waitcnt lgkmcnt(3)
v_mfma_f32_32x32x16_bf16 v[16:31], a[88:91], v[64:67], v[16:31]
ds_read_b128 v[56:59], v10 offset:36864
s_waitcnt lgkmcnt(3)
v_mfma_f32_32x32x16_bf16 v[16:31], a[92:95], v[68:71], v[16:31]
ds_read_b128 v[60:63], v11 offset:36864
s_waitcnt lgkmcnt(3)
v_mfma_f32_32x32x16_bf16 v[16:31], a[96:99], v[48:51], v[16:31]
ds_read_b128 v[64:67], v8 offset:53248
s_waitcnt lgkmcnt(3)
v_mfma_f32_32x32x16_bf16 v[16:31], a[100:103], v[52:55], v[16:31]
ds_read_b128 v[68:71], v9 offset:53248
s_waitcnt lgkmcnt(3)
v_mfma_f32_32x32x16_bf16 v[16:31], a[104:107], v[56:59], v[16:31]
ds_read_b128 v[48:51], v10 offset:53248
s_waitcnt lgkmcnt(3)
v_mfma_f32_32x32x16_bf16 v[16:31], a[108:111], v[60:63], v[16:31]
ds_read_b128 v[52:55], v11 offset:53248
s_waitcnt lgkmcnt(3)
v_mfma_f32_32x32x16_bf16 v[16:31], a[112:115], v[64:67], v[16:31]
s_waitcnt lgkmcnt(2)
v_mfma_f32_32x32x16_bf16 v[16:31], a[116:119], v[68:71], v[16:31]
s_waitcnt vmcnt(9)
s_barrier
ds_read_b128 v[56:59], v8 offset:8192
ds_read_b128 v[60:63], v9 offset:8192
s_waitcnt lgkmcnt(3)
v_mfma_f32_32x32x16_bf16 v[16:31], a[120:123], v[48:51], v[16:31]
ds_read_b128 v[64:67], v10 offset:8192
s_waitcnt lgkmcnt(3)
v_mfma_f32_32x32x16_bf16 v[16:31], a[124:127], v[52:55], v[16:31]
ds_read_b128 v[68:71], v11 offset:8192
s_waitcnt lgkmcnt(3)
v_mfma_f32_32x32x16_bf16 v[16:31], a[128:131], v[56:59], v[16:31]
ds_read_b128 v[48:51], v8 offset:24576
s_waitcnt lgkmcnt(3)
v_mfma_f32_32x32x16_bf16 v[16:31], a[132:135], v[60:63], v[16:31]
ds_read_b128 v[52:55], v9 offset:24576
s_waitcnt lgkmcnt(3)
v_mfma_f32_32x32x16_bf16 v[16:31], a[136:139], v[64:67], v[16:31]
ds_read_b128 v[56:59], v10 offset:24576
s_waitcnt lgkmcnt(3)
v_mfma_f32_32x32x16_bf16 v[16:31], a[140:143], v[68:71], v[16:31]
ds_read_b128 v[60:63], v11 offset:24576
s_waitcnt lgkmcnt(3)
v_mfma_f32_32x32x16_bf16 v[16:31], a[144:147], v[48:51], v[16:31]
ds_read_b128 v[64:67], v8 offset:40960
s_waitcnt lgkmcnt(3)
v_mfma_f32_32x32x16_bf16 v[16:31], a[148:151], v[52:55], v[16:31]
ds_read_b128 v[68:71], v9 offset:40960
s_waitcnt lgkmcnt(3)
v_mfma_f32_32x32x16_bf16 v[16:31], a[152:155], v[56:59], v[16:31]
ds_read_b128 v[48:51], v10 offset:40960
s_waitcnt lgkmcnt(3)
v_mfma_f32_32x32x16_bf16 v[16:31], a[156:159], v[60:63], v[16:31]
ds_read_b128 v[52:55], v11 offset:40960
s_waitcnt lgkmcnt(3)
v_mfma_f32_32x32x16_bf16 v[16:31], a[160:163], v[64:67], v[16:31]
ds_read_b128 v[56:59], v8 offset:57344
s_waitcnt lgkmcnt(3)
v_mfma_f32_32x32x16_bf16 v[16:31], a[164:167], v[68:71], v[16:31]
ds_read_b128 v[60:63], v9 offset:57344
s_waitcnt lgkmcnt(3)
v_mfma_f32_32x32x16_bf16 v[16:31], a[168:171], v[48:51], v[16:31]
ds_read_b128 v[64:67], v10 offset:57344
s_waitcnt lgkmcnt(3)
v_mfma_f32_32x32x16_bf16 v[16:31], a[172:175], v[52:55], v[16:31]
ds_read_b128 v[68:71], v11 offset:57344
s_waitcnt lgkmcnt(3)
v_mfma_f32_32x32x16_bf16 v[16:31], a[176:179], v[56:59], v[16:31]
s_waitcnt lgkmcnt(2)
v_mfma_f32_32x32x16_bf16 v[16:31], a[180:183], v[60:63], v[16:31]
s_waitcnt vmcnt(5)
s_barrier
ds_read_b128 v[48:51], v8 offset:12288
ds_read_b128 v[52:55], v9 offset:12288
s_waitcnt lgkmcnt(3)
v_mfma_f32_32x32x16_bf16 v[16:31], a[184:187], v[64:67], v[16:31]
s_waitcnt vmcnt(0)
v_cmp_gt_u32 vcc, s86, v112
ds_read_b128 v[56:59], v10 offset:12288
s_waitcnt lgkmcnt(3)
v_mfma_f32_32x32x16_bf16 v[16:31], a[188:191], v[68:71], v[16:31]
s_mov_b32 s87, 0
s_cbranch_vccnz L_f1_plain
s_mov_b32 s87, 1
ds_read_b128 v[60:63], v11 offset:12288
s_waitcnt lgkmcnt(3)
v_mfma_f32_32x32x16_bf16 v[16:31], a[192:195], v[48:51], v[16:31]
s_add_u32 s64, s85, 0
s_add_u32 s65, s84, 0
s_mov_b32 m0, s64
s_nop 0
buffer_load_dwordx4 v5, s[36:39], s65 offen offset:0 sc1 lds
v_pk_add_f32 v[128:129], v[128:129], v[132:133]
v_pk_add_f32 v[130:131], v[130:131], v[134:135]
v_pk_add_f32 v[136:137], v[136:137], v[140:141]
ds_read_b128 v[64:67], v8 offset:28672
s_waitcnt lgkmcnt(3)
v_mfma_f32_32x32x16_bf16 v[16:31], a[196:199], v[52:55], v[16:31]
buffer_load_dwordx4 v5, s[36:39], s65 offen offset:1024 sc1 lds
v_pk_add_f32 v[138:139], v[138:139], v[142:143]
v_pk_add_f32 v[128:129], v[128:129], v[136:137]
v_pk_add_f32 v[130:131], v[130:131], v[138:139]
ds_read_b128 v[68:71], v9 offset:28672
s_waitcnt lgkmcnt(3)
v_mfma_f32_32x32x16_bf16 v[16:31], a[200:203], v[56:59], v[16:31]
buffer_load_dwordx4 v5, s[36:39], s65 offen offset:2048 sc1 lds
v_mov_b32 v132, v128
v_mov_b32 v133, v129
v_mov_b32 v134, v130
ds_read_b128 v[48:51], v10 offset:28672
s_waitcnt lgkmcnt(3)
v_mfma_f32_32x32x16_bf16 v[16:31], a[204:207], v[60:63], v[16:31]
buffer_load_dwordx4 v5, s[36:39], s65 offen offset:3072 sc1 lds
v_mov_b32 v135, v131
v_permlane16_swap_b32 v128, v132
v_permlane16_swap_b32 v129, v133
ds_read_b128 v[52:55], v11 offset:28672
s_waitcnt lgkmcnt(3)
v_mfma_f32_32x32x16_bf16 v[16:31], a[208:211], v[64:67], v[16:31]
s_add_u32 s64, s85, 4096
s_add_u32 s65, s84, 4096
s_mov_b32 m0, s64
s_nop 0
buffer_load_dwordx4 v5, s[36:39], s65 offen offset:0 sc1 lds
v_permlane16_swap_b32 v130, v134
v_permlane16_swap_b32 v131, v135
v_pk_add_f32 v[128:129], v[128:129], v[132:133]
ds_read_b128 v[56:59], v8 offset:45056
s_waitcnt lgkmcnt(3)
v_mfma_f32_32x32x16_bf16 v[16:31], a[212:215], v[68:71], v[16:31]
buffer_load_dwordx4 v5, s[36:39], s65 offen offset:1024 sc1 lds
v_pk_add_f32 v[130:131], v[130:131], v[134:135]
v_mov_b32 v132, v128
v_mov_b32 v133, v129
ds_read_b128 v[60:63], v9 offset:45056
s_waitcnt lgkmcnt(3)
v_mfma_f32_32x32x16_bf16 v[16:31], a[216:219], v[48:51], v[16:31]
buffer_load_dwordx4 v5, s[36:39], s65 offen offset:2048 sc1 lds
v_mov_b32 v134, v130
v_mov_b32 v135, v131
v_permlane32_swap_b32 v128, v132
ds_read_b128 v[64:67], v10 offset:45056
s_waitcnt lgkmcnt(3)
v_mfma_f32_32x32x16_bf16 v[16:31], a[220:223], v[52:55], v[16:31]
buffer_load_dwordx4 v5, s[36:39], s65 offen offset:3072 sc1 lds
v_permlane32_swap_b32 v129, v133
v_permlane32_swap_b32 v130, v134
v_permlane32_swap_b32 v131, v135
ds_read_b128 v[68:71], v11 offset:45056
s_waitcnt lgkmcnt(3)
v_mfma_f32_32x32x16_bf16 v[16:31], a[224:227], v[56:59], v[16:31]
s_add_u32 s64, s85, 8192
s_add_u32 s65, s84, 16384
s_mov_b32 m0, s64
s_nop 0
buffer_load_dwordx4 v5, s[36:39], s65 offen offset:0 sc1 lds
v_pk_add_f32 v[128:129], v[128:129], v[132:133]
v_pk_add_f32 v[130:131], v[130:131], v[134:135]
ds_write_b128 v6, v[128:131]
ds_read_b128 v[48:51], v8 offset:61440
s_waitcnt lgkmcnt(4)
v_mfma_f32_32x32x16_bf16 v[16:31], a[228:231], v[60:63], v[16:31]
buffer_load_dwordx4 v5, s[36:39], s65 offen offset:1024 sc1 lds
v_add_u32 v12, 128, v7
ds_read_b128 v[52:55], v9 offset:61440
s_waitcnt lgkmcnt(4)
v_mfma_f32_32x32x16_bf16 v[16:31], a[232:235], v[64:67], v[16:31]
buffer_load_dwordx4 v5, s[36:39], s65 offen offset:2048 sc1 lds
ds_read_b128 v[56:59], v10 offset:61440
s_waitcnt lgkmcnt(4)
v_mfma_f32_32x32x16_bf16 v[16:31], a[236:239], v[68:71], v[16:31]
buffer_load_dwordx4 v5, s[36:39], s65 offen offset:3072 sc1 lds
ds_read_b128 v[60:63], v11 offset:61440
s_waitcnt lgkmcnt(3)
v_mfma_f32_32x32x16_bf16 v[16:31], a[240:243], v[48:51], v[16:31]
s_add_u32 s64, s85, 12288
s_add_u32 s65, s84, 20480
s_mov_b32 m0, s64
s_nop 0
buffer_load_dwordx4 v5, s[36:39], s65 offen offset:0 sc1 lds
buffer_load_dword v112, v4, s[36:39], 0 offen sc1
s_waitcnt lgkmcnt(2)
v_mfma_f32_32x32x16_bf16 v[16:31], a[244:247], v[52:55], v[16:31]
buffer_load_dwordx4 v5, s[36:39], s65 offen offset:1024 sc1 lds
s_waitcnt lgkmcnt(1)
v_mfma_f32_32x32x16_bf16 v[16:31], a[248:251], v[56:59], v[16:31]
buffer_load_dwordx4 v5, s[36:39], s65 offen offset:2048 sc1 lds
s_barrier
ds_read2st64_b32 v[96:97], v7 offset0:0 offset1:1
ds_read2st64_b32 v[100:101], v12 offset0:0 offset1:1
ds_read2st64_b32 v[98:99], v7 offset0:2 offset1:3
ds_read2st64_b32 v[102:103], v12 offset0:2 offset1:3
s_waitcnt lgkmcnt(4)
v_mfma_f32_32x32x16_bf16 v[16:31], a[252:255], v[60:63], v[16:31]
buffer_load_dwordx4 v5, s[36:39], s65 offen offset:3072 sc1 lds
s_branch L_f1_join
L_f1_plain:
ds_read_b128 v[60:63], v11 offset:12288
s_waitcnt lgkmcnt(3)
v_mfma_f32_32x32x16_bf16 v[16:31], a[192:195], v[48:51], v[16:31]
v_pk_add_f32 v[128:129], v[128:129], v[132:133]
v_pk_add_f32 v[130:131], v[130:131], v[134:135]
v_pk_add_f32 v[136:137], v[136:137], v[140:141]
ds_read_b128 v[64:67], v8 offset:28672
s_waitcnt lgkmcnt(3)
v_mfma_f32_32x32x16_bf16 v[16:31], a[196:199], v[52:55], v[16:31]
v_pk_add_f32 v[138:139], v[138:139], v[142:143]
v_pk_add_f32 v[128:129], v[128:129], v[136:137]
v_pk_add_f32 v[130:131], v[130:131], v[138:139]
ds_read_b128 v[68:71], v9 offset:28672
s_waitcnt lgkmcnt(3)
v_mfma_f32_32x32x16_bf16 v[16:31], a[200:203], v[56:59], v[16:31]
v_mov_b32 v132, v128
v_mov_b32 v133, v129
v_mov_b32 v134, v130
ds_read_b128 v[48:51], v10 offset:28672
s_waitcnt lgkmcnt(3)
v_mfma_f32_32x32x16_bf16 v[16:31], a[204:207], v[60:63], v[16:31]
v_mov_b32 v135, v131
v_permlane16_swap_b32 v128, v132
v_permlane16_swap_b32 v129, v133
ds_read_b128 v[52:55], v11 offset:28672
s_waitcnt lgkmcnt(3)
v_mfma_f32_32x32x16_bf16 v[16:31], a[208:211], v[64:67], v[16:31]
v_permlane16_swap_b32 v130, v134
v_permlane16_swap_b32 v131, v135
v_pk_add_f32 v[128:129], v[128:129], v[132:133]
ds_read_b128 v[56:59], v8 offset:45056
s_waitcnt lgkmcnt(3)
v_mfma_f32_32x32x16_bf16 v[16:31], a[212:215], v[68:71], v[16:31]
v_pk_add_f32 v[130:131], v[130:131], v[134:135]
v_mov_b32 v132, v128
v_mov_b32 v133, v129
ds_read_b128 v[60:63], v9 offset:45056
s_waitcnt lgkmcnt(3)
v_mfma_f32_32x32x16_bf16 v[16:31], a[216:219], v[48:51], v[16:31]
v_mov_b32 v134, v130
v_mov_b32 v135, v131
v_permlane32_swap_b32 v128, v132
ds_read_b128 v[64:67], v10 offset:45056
s_waitcnt lgkmcnt(3)
v_mfma_f32_32x32x16_bf16 v[16:31], a[220:223], v[52:55], v[16:31]
v_permlane32_swap_b32 v129, v133
v_permlane32_swap_b32 v130, v134
v_permlane32_swap_b32 v131, v135
ds_read_b128 v[68:71], v11 offset:45056
s_waitcnt lgkmcnt(3)
v_mfma_f32_32x32x16_bf16 v[16:31], a[224:227], v[56:59], v[16:31]
v_pk_add_f32 v[128:129], v[128:129], v[132:133]
v_pk_add_f32 v[130:131], v[130:131], v[134:135]
ds_write_b128 v6, v[128:131]
ds_read_b128 v[48:51], v8 offset:61440
s_waitcnt lgkmcnt(4)
v_mfma_f32_32x32x16_bf16 v[16:31], a[228:231], v[60:63], v[16:31]
v_add_u32 v12, 128, v7
ds_read_b128 v[52:55], v9 offset:61440
s_waitcnt lgkmcnt(4)
v_mfma_f32_32x32x16_bf16 v[16:31], a[232:235], v[64:67], v[16:31]
ds_read_b128 v[56:59], v10 offset:61440
s_waitcnt lgkmcnt(4)
v_mfma_f32_32x32x16_bf16 v[16:31], a[236:239], v[68:71], v[16:31]
ds_read_b128 v[60:63], v11 offset:61440
s_waitcnt lgkmcnt(3)
v_mfma_f32_32x32x16_bf16 v[16:31], a[240:243], v[48:51], v[16:31]
buffer_load_dword v112, v4, s[36:39], 0 offen sc1
s_waitcnt lgkmcnt(2)
v_mfma_f32_32x32x16_bf16 v[16:31], a[244:247], v[52:55], v[16:31]
s_waitcnt lgkmcnt(1)
v_mfma_f32_32x32x16_bf16 v[16:31], a[248:251], v[56:59], v[16:31]
s_barrier
ds_read2st64_b32 v[96:97], v7 offset0:0 offset1:1
ds_read2st64_b32 v[100:101], v12 offset0:0 offset1:1
ds_read2st64_b32 v[98:99], v7 offset0:2 offset1:3
ds_read2st64_b32 v[102:103], v12 offset0:2 offset1:3
s_waitcnt lgkmcnt(4)
v_mfma_f32_32x32x16_bf16 v[16:31], a[252:255], v[60:63], v[16:31]
L_f1_join:
v_xor_b32 v8, 0x10000, v8
v_xor_b32 v9, 0x10000, v9
v_xor_b32 v10, 0x10000, v10
v_xor_b32 v11, 0x10000, v11
v_xor_b32 v6, 1024, v6
v_xor_b32 v7, 1024, v7
v_mov_b32 v104, s92
s_waitcnt lgkmcnt(0)
v_pk_add_f32 v[96:97], v[96:97], v[98:99]
v_pk_add_f32 v[100:101], v[100:101], v[102:103]
v_add_f32 v96, v96, v97
v_add_f32 v97, v100, v101
v_mul_f32 v120, s95, v96
v_mul_f32 v97, s95, v97
v_fma_f32 v97, -v120, v120, v97
v_max_f32 v97, 0, v97
v_add_f32 v97, 0x3727c5ac, v97
v_rsq_f32 v122, v97
v_pk_fma_f32 v[16:17], v[32:33], v[120:121], v[16:17] op_sel_hi:[1,0,1] neg_lo:[0,1,0] neg_hi:[0,1,0]
v_pk_fma_f32 v[18:19], v[34:35], v[120:121], v[18:19] op_sel_hi:[1,0,1] neg_lo:[0,1,0] neg_hi:[0,1,0]
v_pk_fma_f32 v[20:21], v[36:37], v[120:121], v[20:21] op_sel_hi:[1,0,1] neg_lo:[0,1,0] neg_hi:[0,1,0]
v_pk_fma_f32 v[22:23], v[38:39], v[120:121], v[22:23] op_sel_hi:[1,0,1] neg_lo:[0,1,0] neg_hi:[0,1,0]
v_pk_fma_f32 v[24:25], v[40:41], v[120:121], v[24:25] op_sel_hi:[1,0,1] neg_lo:[0,1,0] neg_hi:[0,1,0]
v_pk_fma_f32 v[26:27], v[42:43], v[120:121], v[26:27] op_sel_hi:[1,0,1] neg_lo:[0,1,0] neg_hi:[0,1,0]
v_pk_fma_f32 v[28:29], v[44:45], v[120:121], v[28:29] op_sel_hi:[1,0,1] neg_lo:[0,1,0] neg_hi:[0,1,0]
v_pk_fma_f32 v[30:31], v[46:47], v[120:121], v[30:31] op_sel_hi:[1,0,1] neg_lo:[0,1,0] neg_hi:[0,1,0]
v_pk_mul_f32 v[16:17], v[16:17], v[122:123] op_sel_hi:[1,0]
v_pk_mul_f32 v[18:19], v[18:19], v[122:123] op_sel_hi:[1,0]
v_pk_mul_f32 v[20:21], v[20:21], v[122:123] op_sel_hi:[1,0]
v_pk_mul_f32 v[22:23], v[22:23], v[122:123] op_sel_hi:[1,0]
v_pk_mul_f32 v[24:25], v[24:25], v[122:123] op_sel_hi:[1,0]
v_pk_mul_f32 v[26:27], v[26:27], v[122:123] op_sel_hi:[1,0]
v_pk_mul_f32 v[28:29], v[28:29], v[122:123] op_sel_hi:[1,0]
v_pk_mul_f32 v[30:31], v[30:31], v[122:123] op_sel_hi:[1,0]
v_pk_mul_f32 v[96:97], v[16:17], v[16:17]
v_pk_mul_f32 v[98:99], v[18:19], v[18:19]
v_pk_mul_f32 v[100:101], v[20:21], v[20:21]
v_pk_mul_f32 v[102:103], v[22:23], v[22:23]
v_fma_f32 v96, v96, s93, v104
v_fma_f32 v97, v97, s93, v104
v_fma_f32 v98, v98, s93, v104
v_fma_f32 v99, v99, s93, v104
v_fma_f32 v100, v100, s93, v104
v_fma_f32 v101, v101, s93, v104
v_fma_f32 v102, v102, s93, v104
v_fma_f32 v103, v103, s93, v104
v_pk_mul_f32 v[96:97], v[96:97], v[16:17]
v_pk_mul_f32 v[98:99], v[98:99], v[18:19]
v_pk_mul_f32 v[100:101], v[100:101], v[20:21]
v_pk_mul_f32 v[102:103], v[102:103], v[22:23]
v_exp_f32 v96, v96
v_exp_f32 v97, v97
v_exp_f32 v98, v98
v_exp_f32 v99, v99
v_exp_f32 v100, v100
v_exp_f32 v101, v101
v_exp_f32 v102, v102
v_exp_f32 v103, v103
v_add_f32 v96, 1.0, v96
v_add_f32 v97, 1.0, v97
v_add_f32 v98, 1.0, v98
v_add_f32 v99, 1.0, v99
v_add_f32 v100, 1.0, v100
v_add_f32 v101, 1.0, v101
v_add_f32 v102, 1.0, v102
v_add_f32 v103, 1.0, v103
v_rcp_f32 v96, v96
v_rcp_f32 v97, v97
v_rcp_f32 v98, v98
v_rcp_f32 v99, v99
v_rcp_f32 v100, v100
v_rcp_f32 v101, v101
v_rcp_f32 v102, v102
v_rcp_f32 v103, v103
v_pk_mul_f32 v[96:97], v[96:97], v[16:17]
v_pk_mul_f32 v[98:99], v[98:99], v[18:19]
v_pk_mul_f32 v[100:101], v[100:101], v[20:21]
v_pk_mul_f32 v[102:103], v[102:103], v[22:23]
v_pk_mul_f32 v[96:97], v[96:97], v[24:25]
v_pk_mul_f32 v[98:99], v[98:99], v[26:27]
v_pk_mul_f32 v[100:101], v[100:101], v[28:29]
v_pk_mul_f32 v[102:103], v[102:103], v[30:31]
v_cvt_pk_bf16_f32 v108, v96, v97
v_cvt_pk_bf16_f32 v109, v98, v99
v_cvt_pk_bf16_f32 v110, v100, v101
v_cvt_pk_bf16_f32 v111, v102, v103
s_lshl_b32 s82, s59, 19
s_lshl_b32 s64, s59, 11
s_and_b32 s64, s64, 0x2000
s_add_u32 s82, s82, s64
s_add_u32 s82, s82, s97
buffer_store_dwordx4 v[108:111], v2, s[36:39], s82 offen sc1
s_add_u32 s59, s59, 1
s_cmp_lg_u32 s87, 0
s_cbranch_scc1 L_f1_top
s_cmp_eq_u32 s59, 64
s_cbranch_scc1 L_f1_last
s_waitcnt vmcnt(1)
v_cmp_gt_u32 vcc, s86, v112
s_cbranch_vccz L_f1_go
s_branch L_f1_wait
L_f1_last:
s_waitcnt vmcnt(0)
v_mov_b32 v113, s59
buffer_store_dword v113, v3, s[36:39], 0 offen sc1
s_endpgm
L_role_aux:
s_bfe_u32 s80, s57, 0x10005
s_lshl_b32 s80, s80, 2
s_and_b32 s81, s57, 3
s_add_u32 s80, s80, s81
s_mov_b32 s44, s8
s_and_b32 s45, s9, 0xffff
s_mov_b32 s46, 0x400000
s_mov_b32 s47, 0x20000
s_lshl_b32 s64, s57, 7
s_lshl_b32 s65, s56, 2
s_add_u32 s64, s64, s65
v_mov_b32 v2, 0x7fff0000
v_mov_b32 v255, s64
v_cmp_eq_u32 vcc, 0, v0
s_nop 1
v_cndmask_b32 v2, v2, v255, vcc
v_and_b32 v20, 7, v0
v_lshrrev_b32 v21, 3, v0
s_lshl_b32 s64, s56, 5
v_add_u32 v22, s64, v21
v_lshlrev_b32 v23, 11, v20
v_lshl_add_u32 v3, v22, 4, v23
v_lshlrev_b32 v23, 4, v20
v_lshl_add_u32 v4, v22, 8, v23
v_lshlrev_b32 v9, 5, v20
s_lshl_b32 s64, s56, 3
v_add_u32 v8, s64, v9
s_mov_b32 s90, 0xffff0000
s_mov_b32 s91, 0x3b800000
s_mov_b32 s92, 0x3a800000
s_mov_b32 s93, 0x3727c5ac
s_mov_b32 s94, 0x43800000
s_lshl_b32 s84, s80, 14
s_mov_b32 s59, 0
buffer_load_dwordx4 v[160:163], v3, s[44:47], s84 offen offset:0
buffer_load_dwordx4 v[164:167], v3, s[44:47], s84 offen offset:128
buffer_load_dwordx4 v[168:171], v3, s[44:47], s84 offen offset:256
buffer_load_dwordx4 v[172:175], v3, s[44:47], s84 offen offset:384
s_cmp_lg_u32 s62, 0
s_cbranch_scc1 L_cd_198
v_mbcnt_lo_u32_b32 v17, -1, 0
v_mbcnt_hi_u32_b32 v17, -1, v17
v_lshlrev_b32 v17, 2, v17
L_ct_199:
buffer_load_dword v18, v17, s[40:43], 0 offen sc1
s_mov_b32 s64, 0x10001000
s_mov_b32 s65, 0x10001000
s_waitcnt vmcnt(0)
v_cmp_ne_u32 vcc, 64, v18
s_nop 0
s_and_b64 s[64:65], s[64:65], vcc
s_cbranch_scc0 L_co_200
s_sleep 12
s_add_u32 s63, s63, 1
s_cmp_lt_u32 s63, 0x20000
s_cbranch_scc1 L_ct_199
s_branch L_giveup
L_co_200:
v_cmp_ne_u32 vcc, 32, v18
s_mov_b32 s64, 0x110011
s_mov_b32 s65, 0x110011
s_and_b64 s[64:65], s[64:65], vcc
s_cbranch_scc1 L_recensus
L_sd_201:
v_readlane_b32 s64, v18, 2
s_nop 0
s_cmp_lg_u32 s64, 0
s_cbranch_scc1 L_sk_202
s_sleep 4
buffer_load_dword v18, v17, s[40:43], 0 offen sc1
s_waitcnt vmcnt(0)
s_add_u32 s63, s63, 1
s_cmp_lt_u32 s63, 0x20000
s_cbranch_scc1 L_sd_201
s_branch L_giveup
L_sk_202:
s_cmp_eq_u32 s64, 2
s_cselect_b32 s64, 0x200000, 0
s_add_u32 s64, s64, 0x6000
s_add_u32 s36, s34, s64
s_addc_u32 s37, s35, 0
s_and_b32 s37, s37, 0xffff
L_cd_198:
s_waitcnt vmcnt(0)
L_ln1_top:
s_waitcnt vmcnt(4)
v_lshlrev_b32 v96, 16, v160
v_and_b32 v97, s90, v160
v_lshlrev_b32 v98, 16, v161
v_and_b32 v99, s90, v161
v_lshlrev_b32 v100, 16, v162
v_and_b32 v101, s90, v162
v_lshlrev_b32 v102, 16, v163
v_and_b32 v103, s90, v163
v_lshlrev_b32 v104, 16, v164
v_and_b32 v105, s90, v164
v_lshlrev_b32 v106, 16, v165
v_and_b32 v107, s90, v165
v_lshlrev_b32 v108, 16, v166
v_and_b32 v109, s90, v166
v_lshlrev_b32 v110, 16, v167
v_and_b32 v111, s90, v167
v_lshlrev_b32 v112, 16, v168
v_and_b32 v113, s90, v168
v_lshlrev_b32 v114, 16, v169
v_and_b32 v115, s90, v169
v_lshlrev_b32 v116, 16, v170
v_and_b32 v117, s90, v170
v_lshlrev_b32 v118, 16, v171
v_and_b32 v119, s90, v171
v_lshlrev_b32 v120, 16, v172
v_and_b32 v121, s90, v172
v_lshlrev_b32 v122, 16, v173
v_and_b32 v123, s90, v173
v_lshlrev_b32 v124, 16, v174
v_and_b32 v125, s90, v174
v_lshlrev_b32 v126, 16, v175
v_and_b32 v127, s90, v175
s_lshr_b32 s64, s84, 16
s_lshl_b32 s64, s64, 16
s_bfe_u32 s65, s84, 0x1000f
s_lshl_b32 s65, s65, 15
s_add_u32 s64, s64, s65
s_bfe_u32 s65, s84, 0x1000e
s_lshl_b32 s65, s65, 7
s_add_u32 s64, s64, s65
s_add_u32 s85, s64, 0x400000
s_add_u32 s86, s85, 4096
s_add_u32 s84, s84, 0x20000
buffer_load_dwordx4 v[160:163], v3, s[44:47], s84 offen offset:0
buffer_load_dwordx4 v[164:167], v3, s[44:47], s84 offen offset:128
buffer_load_dwordx4 v[168:171], v3, s[44:47], s84 offen offset:256
buffer_load_dwordx4 v[172:175], v3, s[44:47], s84 offen offset:384
v_add_f32 v128, v96, v100
v_add_f32 v129, v97, v101
v_add_f32 v130, v98, v102
v_add_f32 v131, v99, v103
v_add_f32 v128, v128, v104
v_add_f32 v129, v129, v105
v_add_f32 v130, v130, v106
v_add_f32 v131, v131, v107
v_add_f32 v128, v128, v108
v_add_f32 v129, v129, v109
v_add_f32 v130, v130, v110
v_add_f32 v131, v131, v111
v_add_f32 v128, v128, v112
v_add_f32 v129, v129, v113
v_add_f32 v130, v130, v114
v_add_f32 v131, v131, v115
v_add_f32 v128, v128, v116
v_add_f32 v129, v129, v117
v_add_f32 v130, v130, v118
v_add_f32 v131, v131, v119
v_add_f32 v128, v128, v120
v_add_f32 v129, v129, v121
v_add_f32 v130, v130, v122
v_add_f32 v131, v131, v123
v_add_f32 v128, v128, v124
v_add_f32 v129, v129, v125
v_add_f32 v130, v130, v126
v_add_f32 v131, v131, v127
v_add_f32 v128, v128, v129
v_add_f32 v130, v130, v131
v_add_f32 v128, v128, v130
s_nop 1
v_add_f32_dpp v128, v128, v128 row_ror:8 row_mask:0xf bank_mask:0xf
v_mov_b32 v129, v128
s_nop 1
v_permlane16_swap_b32 v128, v129
v_add_f32 v128, v128, v129
v_mov_b32 v129, v128
s_nop 1
v_permlane32_swap_b32 v128, v129
v_add_f32 v128, v128, v129
v_mul_f32 v132, s91, v128
v_sub_f32 v96, v96, v132
v_sub_f32 v97, v97, v132
v_sub_f32 v98, v98, v132
v_sub_f32 v99, v99, v132
v_sub_f32 v100, v100, v132
v_sub_f32 v101, v101, v132
v_sub_f32 v102, v102, v132
v_sub_f32 v103, v103, v132
v_sub_f32 v104, v104, v132
v_sub_f32 v105, v105, v132
v_sub_f32 v106, v106, v132
v_sub_f32 v107, v107, v132
v_sub_f32 v108, v108, v132
v_sub_f32 v109, v109, v132
v_sub_f32 v110, v110, v132
v_sub_f32 v111, v111, v132
v_sub_f32 v112, v112, v132
v_sub_f32 v113, v113, v132
v_sub_f32 v114, v114, v132
v_sub_f32 v115, v115, v132
v_sub_f32 v116, v116, v132
v_sub_f32 v117, v117, v132
v_sub_f32 v118, v118, v132
v_sub_f32 v119, v119, v132
v_sub_f32 v120, v120, v132
v_sub_f32 v121, v121, v132
v_sub_f32 v122, v122, v132
v_sub_f32 v123, v123, v132
v_sub_f32 v124, v124, v132
v_sub_f32 v125, v125, v132
v_sub_f32 v126, v126, v132
v_sub_f32 v127, v127, v132
v_mul_f32 v128, v96, v96
v_mul_f32 v129, v97, v97
v_mul_f32 v130, v98, v98
v_mul_f32 v131, v99, v99
v_fmac_f32 v128, v100, v100
v_fmac_f32 v129, v101, v101
v_fmac_f32 v130, v102, v102
v_fmac_f32 v131, v103, v103
v_fmac_f32 v128, v104, v104
v_fmac_f32 v129, v105, v105
v_fmac_f32 v130, v106, v106
v_fmac_f32 v131, v107, v107
v_fmac_f32 v128, v108, v108
v_fmac_f32 v129, v109, v109
v_fmac_f32 v130, v110, v110
v_fmac_f32 v131, v111, v111
v_fmac_f32 v128, v112, v112
v_fmac_f32 v129, v113, v113
v_fmac_f32 v130, v114, v114
v_fmac_f32 v131, v115, v115
v_fmac_f32 v128, v116, v116
v_fmac_f32 v129, v117, v117
v_fmac_f32 v130, v118, v118
v_fmac_f32 v131, v119, v119
v_fmac_f32 v128, v120, v120
v_fmac_f32 v129, v121, v121
v_fmac_f32 v130, v122, v122
v_fmac_f32 v131, v123, v123
v_fmac_f32 v128, v124, v124
v_fmac_f32 v129, v125, v125
v_fmac_f32 v130, v126, v126
v_fmac_f32 v131, v127, v127
v_add_f32 v128, v128, v129
v_add_f32 v130, v130, v131
v_add_f32 v128, v128, v130
s_nop 1
v_add_f32_dpp v128, v128, v128 row_ror:8 row_mask:0xf bank_mask:0xf
v_mov_b32 v129, v128
s_nop 1
v_permlane16_swap_b32 v128, v129
v_add_f32 v128, v128, v129
v_mov_b32 v129, v128
s_nop 1
v_permlane32_swap_b32 v128, v129
v_add_f32 v128, v128, v129
v_mov_b32 v133, v128
ds_write_b64 v8, v[132:133]
s_waitcnt lgkmcnt(0)
s_barrier
ds_read_b128 v[136:139], v9
ds_read_b128 v[140:143], v9 offset:16
v_xor_b32 v8, 256, v8
v_xor_b32 v9, 256, v9
s_waitcnt lgkmcnt(0)
v_add_f32 v128, v136, v138
v_add_f32 v129, v140, v142
v_add_f32 v128, v128, v129
v_mul_f32 v128, 0x3e800000, v128
v_add_f32 v129, v137, v139
v_add_f32 v130, v141, v143
v_add_f32 v129, v129, v130
v_mov_b32 v130, 0
v_sub_f32 v131, v136, v128
v_fmac_f32 v130, v131, v131
v_sub_f32 v131, v138, v128
v_fmac_f32 v130, v131, v131
v_sub_f32 v131, v140, v128
v_fmac_f32 v130, v131, v131
v_sub_f32 v131, v142, v128
v_fmac_f32 v130, v131, v131
v_fma_f32 v129, v130, s94, v129
v_mov_b32 v130, s93
v_fma_f32 v129, v129, s92, v130
v_rsq_f32 v129, v129
v_sub_f32 v132, v132, v128
v_mul_f32 v132, v132, v129
v_fma_f32 v96, v96, v129, v132
v_fma_f32 v97, v97, v129, v132
v_cvt_pk_bf16_f32 v144, v96, v97
v_fma_f32 v98, v98, v129, v132
v_fma_f32 v99, v99, v129, v132
v_cvt_pk_bf16_f32 v145, v98, v99
v_fma_f32 v100, v100, v129, v132
v_fma_f32 v101, v101, v129, v132
v_cvt_pk_bf16_f32 v146, v100, v101
v_fma_f32 v102, v102, v129, v132
v_fma_f32 v103, v103, v129, v132
v_cvt_pk_bf16_f32 v147, v102, v103
v_fma_f32 v104, v104, v129, v132
v_fma_f32 v105, v105, v129, v132
v_cvt_pk_bf16_f32 v148, v104, v105
v_fma_f32 v106, v106, v129, v132
v_fma_f32 v107, v107, v129, v132
v_cvt_pk_bf16_f32 v149, v106, v107
v_fma_f32 v108, v108, v129, v132
v_fma_f32 v109, v109, v129, v132
v_cvt_pk_bf16_f32 v150, v108, v109
v_fma_f32 v110, v110, v129, v132
v_fma_f32 v111, v111, v129, v132
v_cvt_pk_bf16_f32 v151, v110, v111
v_fma_f32 v112, v112, v129, v132
v_fma_f32 v113, v113, v129, v132
v_cvt_pk_bf16_f32 v152, v112, v113
v_fma_f32 v114, v114, v129, v132
v_fma_f32 v115, v115, v129, v132
v_cvt_pk_bf16_f32 v153, v114, v115
v_fma_f32 v116, v116, v129, v132
v_fma_f32 v117, v117, v129, v132
v_cvt_pk_bf16_f32 v154, v116, v117
v_fma_f32 v118, v118, v129, v132
v_fma_f32 v119, v119, v129, v132
v_cvt_pk_bf16_f32 v155, v118, v119
v_fma_f32 v120, v120, v129, v132
v_fma_f32 v121, v121, v129, v132
v_cvt_pk_bf16_f32 v156, v120, v121
v_fma_f32 v122, v122, v129, v132
v_fma_f32 v123, v123, v129, v132
v_cvt_pk_bf16_f32 v157, v122, v123
v_fma_f32 v124, v124, v129, v132
v_fma_f32 v125, v125, v129, v132
v_cvt_pk_bf16_f32 v158, v124, v125
v_fma_f32 v126, v126, v129, v132
v_fma_f32 v127, v127, v129, v132
v_cvt_pk_bf16_f32 v159, v126, v127
s_waitcnt vmcnt(4)
v_mov_b32 v128, s59
buffer_store_dword v128, v2, s[36:39], 0 offen offset:64 sc1
s_waitcnt vmcnt(1)
buffer_store_dwordx4 v[144:147], v4, s[36:39], s85 offen offset:0 sc1
buffer_store_dwordx4 v[148:151], v4, s[36:39], s85 offen offset:2048 sc1
buffer_store_dwordx4 v[152:155], v4, s[36:39], s86 offen offset:0 sc1
buffer_store_dwordx4 v[156:159], v4, s[36:39], s86 offen offset:2048 sc1
s_add_u32 s59, s59, 1
s_cmp_gt_u32 s59, 1
s_cbranch_scc1 L_ln1_next
s_waitcnt vmcnt(0)
v_mov_b32 v128, s59
buffer_store_dword v128, v2, s[36:39], 0 offen offset:64 sc1
L_ln1_next:
s_cmp_lt_u32 s59, 32
s_cbranch_scc1 L_ln1_top
s_waitcnt vmcnt(0)
v_mov_b32 v128, s59
buffer_store_dword v128, v2, s[36:39], 0 offen offset:64 sc1
s_endpgm
L_last:
s_endpgm
.section .rodata,"a"
.p2align 6
.amdhsa_kernel sequential_preLN__memory_aug_recurrent_mem_tr__geglu_ffn__prompt_kernel
  .amdhsa_next_free_vgpr 512
  .amdhsa_next_free_sgpr 102
  .amdhsa_accum_offset 256
  .amdhsa_group_segment_fixed_size 0
  .amdhsa_kernarg_size 112
  .amdhsa_user_sgpr_count 2
  .amdhsa_user_sgpr_kernarg_segment_ptr 1
  .amdhsa_system_sgpr_workgroup_id_x 1
  .amdhsa_float_denorm_mode_32 3
.end_amdhsa_kernel
```
